```python
import torch

def _softmax(x, axis=-1):
    return torch.softmax(x, dim=axis)
def _gelu(x):
    return torch.nn.functional.gelu(x, approximate="tanh")
def _silu(x):
    return torch.nn.functional.silu(x)
def _sigmoid(x):
    return torch.sigmoid(x)
def _layernorm(x, axis=-1, eps=1e-5):
    m = x.mean(dim=axis, keepdim=True)
    v = x.var(dim=axis, keepdim=True, unbiased=False)
    return (x - m) / torch.sqrt(v + eps)
def _scatter_add(tgt, idx, src, axis=0):
    return tgt.clone().index_add_(axis, idx, src)
def _segment_sum(src, seg, n):
    out = torch.zeros((n,) + src.shape[1:], dtype=src.dtype)
    return out.index_add_(0, seg, src)
def _pad(x, pw):
    flat = tuple(v for pair in reversed(pw) for v in pair)
    return torch.nn.functional.pad(x, flat)

kernel_name = 'parallel_sum__sliding_block__mixer_token_mlp__prompt'

def setup_inputs():

    _w = (lambda a: (lambda t: t.to(torch.bfloat16) if t.is_floating_point() else t)(torch.as_tensor(a)))
    def _A_setup():
        B, S, D = 1, 2048, 640
        return {
            "x": _w((lambda *s: torch.randn(*s, dtype=torch.bfloat16) * 0.05)(B, S, D)),
            "wqkv": _w((lambda *s: torch.randn(*s, dtype=torch.bfloat16) * 0.05)(D, 3 * D)),
            "wo": _w((lambda *s: torch.randn(*s, dtype=torch.bfloat16) * 0.05)(D, D)),
        }
    _A_in = _A_setup()

    def _B_setup():
        B, S, D, F = 1, 2048, 640, 1728
        return {
            "x": _w((lambda *s: torch.randn(*s, dtype=torch.bfloat16) * 0.05)(B, S, D)),
            "w1": _w((lambda *s: torch.randn(*s, dtype=torch.bfloat16) * 0.8)(S, F) * (S ** -0.5)),
            "b1": _w((lambda *s: torch.randn(*s, dtype=torch.bfloat16) * 0.8)(F) * 0.02),
            "w2": _w((lambda *s: torch.randn(*s, dtype=torch.bfloat16) * 0.8)(F, S) * (F ** -0.5)),
            "b2": _w((lambda *s: torch.randn(*s, dtype=torch.bfloat16) * 0.8)(S) * 0.02),
        }
    _B_in = _B_setup()

    return {
        "A_x": _A_in["x"],
        "A_wqkv": _A_in["wqkv"],
        "A_wo": _A_in["wo"],
        "B_x": _B_in["x"],
        "B_w1": _B_in["w1"],
        "B_b1": _B_in["b1"],
        "B_w2": _B_in["w2"],
        "B_b2": _B_in["b2"],
    }

def reference(A_x, A_wqkv, A_wo, B_x, B_w1, B_b1, B_w2, B_b2):
    def _A_ref(x, wqkv, wo):
        B, S, D = x.shape
        H = 32; Dh = D // H; W = 256
        qkv = (lambda x, *d: x.permute(*d))((x @ wqkv).reshape(B, S, 3, H, Dh), 2, 0, 3, 1, 4)
        q, k, v = qkv[0], qkv[1], qkv[2]
        scores = torch.einsum("bhqd,bhkd->bhqk", q, k) * (Dh ** -0.5)
        idx = torch.arange(S)
        mask = (idx[:, None] - idx[None, :] >= 0) & (idx[:, None] - idx[None, :] < W)
        scores = torch.where(mask[None, None], scores, -1e9)
        p = _softmax(scores, axis=-1)
        o = torch.einsum("bhqk,bhkd->bhqd", p, v)
        return (lambda x, *d: x.permute(*d))(o, 0, 2, 1, 3).reshape(B, S, D) @ wo

    def _B_ref(x, w1, b1, w2, b2):
        B, S, D = x.shape
        h = _layernorm(x, axis=-1)
        u = torch.einsum("bsd,sf->bdf", h, w1) + b1
        u = _gelu(u)
        y = torch.einsum("bdf,fs->bds", u, w2) + b2
        return (lambda x, *d: x.permute(*d))(y, 0, 2, 1)

    x = A_x
    xn = _layernorm(x, axis=-1)
    return x + _A_ref(xn, A_wqkv, A_wo) + _B_ref(xn, B_w1, B_b1, B_w2, B_b2)
```

```asm
; @launch grid=(256,1,1) block=(512,1,1) lds=163840
.amdgcn_target "amdgcn-amd-amdhsa--gfx950"
.text
.globl parallel_sum__sliding_block__mixer_token_mlp__prompt_kernel
.p2align 8
.type parallel_sum__sliding_block__mixer_token_mlp__prompt_kernel,@function
parallel_sum__sliding_block__mixer_token_mlp__prompt_kernel:
    s_load_dwordx4 s[64:67], s[0:1], 0
    s_load_dwordx4 s[68:71], s[0:1], 72
    s_cmp_ge_u32 s2, 256
    s_cbranch_scc1 L_end
    s_getpc_b64 s[50:51]
    s_sub_u32 s50, s50, .-parallel_sum__sliding_block__mixer_token_mlp__prompt_kernel
    s_subb_u32 s51, s51, 0
    s_lshr_b32 s52, s2, 3
    s_and_b32 s52, s52, 3
    s_add_u32 s52, s52, 1
    s_lshl_b32 s52, s52, 13
    v_and_b32 v2, 63, v0
    v_lshlrev_b32 v2, 7, v2
    v_cmp_le_u32 vcc, 256, v0
    v_mov_b32 v3, s52
    v_and_b32 v4, 0xc0, v0
    v_cndmask_b32 v3, 0, v3, vcc
    v_add_u32 v2, v2, v3
    v_cmp_eq_u32 vcc, 0, v4
    s_mov_b32 s54, L_end-parallel_sum__sliding_block__mixer_token_mlp__prompt_kernel
    v_cmp_gt_u32 s[52:53], s54, v2
    s_nop 0
    s_and_b64 vcc, vcc, s[52:53]
    s_and_saveexec_b64 s[52:53], vcc
    s_cbranch_execz L_nocpf
    global_load_dword v255, v2, s[50:51]
L_nocpf:
    s_mov_b64 exec, -1
    s_load_dwordx8 s[56:63], s[0:1], 32
    s_load_dwordx2 s[12:13], s[0:1], 16
    s_load_dwordx2 s[28:29], s[0:1], 64
    v_lshrrev_b32 v2, 6, v0
    v_and_b32 v1, 63, v0
    s_and_b32 s45, s2, 7
    s_lshr_b32 s46, s2, 3
    v_readfirstlane_b32 s44, v2
    s_mov_b32 s6, 2621440
    s_mov_b32 s7, 0x20000
    s_mov_b32 s10, 2457600
    s_mov_b32 s11, 0x20000
    s_mov_b32 s14, 819200
    s_mov_b32 s15, 0x20000
    s_mov_b32 s18, 7077888
    s_mov_b32 s19, 0x20000
    s_mov_b32 s22, 7077888
    s_mov_b32 s23, 0x20000
    s_mov_b32 s26, 23924736
    s_mov_b32 s27, 0x20000
    s_mov_b32 s30, 2621440
    s_mov_b32 s31, 0x20000
    s_mov_b32 s34, 3456
    s_mov_b32 s35, 0x20000
    s_mov_b32 s38, 4096
    s_mov_b32 s39, 0x20000
    s_mov_b32 s42, 256
    s_mov_b32 s43, 0x20000
    s_and_b32 s50, s45, 1
    s_mul_i32 s51, s50, 15
    s_add_u32 s51, s51, s46
    s_lshr_b32 s77, s51, 1
    s_and_b32 s51, s51, 1
    s_and_b32 s76, s45, 6
    s_add_u32 s76, s76, s51
    s_waitcnt lgkmcnt(0)
    s_mov_b64 s[4:5], s[64:65]
    s_mov_b64 s[8:9], s[66:67]
    s_mov_b64 s[40:41], s[68:69]
    s_mov_b64 s[24:25], s[70:71]
    s_mov_b64 s[16:17], s[56:57]
    s_mov_b64 s[32:33], s[58:59]
    s_mov_b64 s[20:21], s[60:61]
    s_mov_b64 s[36:37], s[62:63]
    s_cmp_ge_u32 s46, 15
    s_cbranch_scc1 L_b
    s_cmp_ge_u32 s44, 4
    s_cbranch_scc0 L_cons
    s_sub_u32 s48, s44, 4
    v_lshrrev_b32 v2, 3, v1
    v_mul_u32_u24 v2, 1280, v2
    v_and_b32 v3, 7, v1
    v_lshrrev_b32 v4, 4, v1
    v_xor_b32 v3, v3, v4
    v_lshl_add_u32 v210, v3, 4, v2
    v_xor_b32 v211, 64, v210
    v_mul_u32_u24 v2, 3840, v4
    v_bfe_u32 v3, v1, 2, 2
    v_xor_b32 v3, v3, v4
    v_lshl_add_u32 v2, v3, 6, v2
    v_and_b32 v3, 3, v1
    v_lshl_add_u32 v212, v3, 4, v2
    s_lshl_b32 s49, s76, 8
    s_lshl_b32 s52, s48, 6
    s_add_u32 s49, s49, s52
    s_mul_i32 s49, s49, 1280
    s_mul_i32 s50, s48, 61440
    s_lshl_b32 s52, s77, 8
    s_add_u32 s50, s50, s52
    s_lshl_b32 s51, s48, 13
    s_lshl_b32 s67, s48, 12
    s_sub_u32 s67, 32768, s67
    s_add_u32 s53, s76, s77
    s_mul_i32 s52, s53, 52
    s_lshr_b32 s52, s52, 8
    s_mul_i32 s52, s52, 5
    s_sub_u32 s53, s53, s52
    s_lshl_b32 s53, s53, 1
    s_lshl_b32 s52, s53, 7
    s_add_u32 s49, s49, s52
    s_mul_i32 s52, s53, 245760
    s_add_u32 s50, s50, s52
    s_movk_i32 s65, 128
    s_mov_b32 s66, 245760
    s_mov_b32 s68, 0
    s_mov_b32 s69, 49152
    s_mul_i32 s59, s77, 2560
    s_lshl_b32 s52, s53, 8
    s_add_u32 s59, s59, s52
    s_lshl_b32 s52, s48, 7
    s_add_u32 s59, s59, s52
    s_add_u32 s59, s59, 49152
    s_setprio 2
    s_mov_b32 m0, s51
    s_mov_b32 s52, s49
    buffer_load_dwordx4 v210, s[4:7], s52 offen offset:0 lds
    s_add_u32 s52, s52, 9216
    buffer_load_dwordx4 v211, s[4:7], s52 offen offset:1024 lds
    s_add_u32 s52, s52, 9216
    buffer_load_dwordx4 v210, s[4:7], s52 offen offset:2048 lds
    s_add_u32 s52, s52, 9216
    buffer_load_dwordx4 v211, s[4:7], s52 offen offset:3072 lds
    s_add_u32 s52, s52, 9216
    s_add_u32 m0, s51, 4096
    s_add_u32 s52, s52, 4096
    buffer_load_dwordx4 v210, s[4:7], s52 offen offset:0 lds
    s_add_u32 s52, s52, 9216
    buffer_load_dwordx4 v211, s[4:7], s52 offen offset:1024 lds
    s_add_u32 s52, s52, 9216
    buffer_load_dwordx4 v210, s[4:7], s52 offen offset:2048 lds
    s_add_u32 s52, s52, 9216
    buffer_load_dwordx4 v211, s[4:7], s52 offen offset:3072 lds
    s_add_u32 m0, s51, s67
    s_add_u32 s52, s50, 14336
    buffer_load_dwordx4 v212, s[8:11], s50 offen lds
    buffer_load_dwordx4 v212, s[8:11], s52 offen offset:1024 lds
    s_add_u32 s52, s52, 14336
    s_add_u32 s62, s52, 14336
    s_add_u32 s68, s68, 1
    s_cmp_eq_u32 s68, 3
    s_cselect_b32 s68, 0, s68
    s_cselect_b32 s63, -98304, s69
    s_add_u32 s51, s51, s63
    s_add_u32 s53, s53, 1
    s_cmp_eq_u32 s53, 10
    s_cselect_b32 s63, -1152, s65
    s_cselect_b32 s64, -2211840, s66
    s_add_u32 s49, s49, s63
    s_add_u32 s50, s50, s64
    buffer_load_dwordx4 v212, s[8:11], s52 offen offset:2048 lds
    buffer_load_dwordx4 v212, s[8:11], s62 offen offset:3072 lds
    s_setprio 0
    s_mov_b32 m0, s51
    s_mov_b32 s52, s49
    buffer_load_dwordx4 v210, s[4:7], s52 offen offset:0 lds
    s_add_u32 s52, s52, 9216
    buffer_load_dwordx4 v211, s[4:7], s52 offen offset:1024 lds
    s_add_u32 s52, s52, 9216
    buffer_load_dwordx4 v210, s[4:7], s52 offen offset:2048 lds
    s_add_u32 s52, s52, 9216
    buffer_load_dwordx4 v211, s[4:7], s52 offen offset:3072 lds
    s_add_u32 s52, s52, 9216
    s_add_u32 m0, s51, 4096
    s_add_u32 s52, s52, 4096
    buffer_load_dwordx4 v210, s[4:7], s52 offen offset:0 lds
    s_add_u32 s52, s52, 9216
    buffer_load_dwordx4 v211, s[4:7], s52 offen offset:1024 lds
    s_add_u32 s52, s52, 9216
    buffer_load_dwordx4 v210, s[4:7], s52 offen offset:2048 lds
    s_add_u32 s52, s52, 9216
    buffer_load_dwordx4 v211, s[4:7], s52 offen offset:3072 lds
    s_add_u32 m0, s51, s67
    s_add_u32 s52, s50, 14336
    buffer_load_dwordx4 v212, s[8:11], s50 offen lds
    buffer_load_dwordx4 v212, s[8:11], s52 offen offset:1024 lds
    s_add_u32 s52, s52, 14336
    s_add_u32 s62, s52, 14336
    s_add_u32 s68, s68, 1
    s_cmp_eq_u32 s68, 3
    s_cselect_b32 s68, 0, s68
    s_cselect_b32 s63, -98304, s69
    s_add_u32 s51, s51, s63
    s_add_u32 s53, s53, 1
    s_cmp_eq_u32 s53, 10
    s_cselect_b32 s63, -1152, s65
    s_cselect_b32 s64, -2211840, s66
    s_add_u32 s49, s49, s63
    s_add_u32 s50, s50, s64
    buffer_load_dwordx4 v212, s[8:11], s52 offen offset:2048 lds
    buffer_load_dwordx4 v212, s[8:11], s62 offen offset:3072 lds
    s_mul_i32 s57, s45, 17
    s_add_u32 s57, s57, s46
    s_sub_u32 s57, s57, 15
    s_mul_i32 s80, s57, 205
    s_lshr_b32 s80, s80, 10
    s_mul_i32 s58, s80, 5
    s_sub_u32 s79, s57, s58
    s_and_b32 s56, s45, 1
    s_lshl_b32 s56, s56, 2
    s_lshr_b32 s58, s45, 1
    s_and_b32 s57, s46, 3
    s_add_u32 s82, s56, s57
    s_lshl_b32 s58, s58, 3
    s_lshr_b32 s57, s46, 2
    s_xor_b32 s57, s57, 0
    s_add_u32 s83, s58, s57
    s_mov_b32 s75, s48
    v_mov_b32 v8, 163584
    v_mov_b32 v9, 1
    s_lshl_b32 s54, s48, 12
    s_add_u32 s54, s54, 32768
    v_lshlrev_b32 v2, 4, v1
    v_add_u32 v13, s54, v2
    v_lshrrev_b32 v4, 4, v1
    v_bfe_u32 v3, v1, 2, 2
    v_xor_b32 v3, v3, v4
    v_lshlrev_b32 v3, 7, v3
    v_and_b32 v5, 3, v1
    v_lshl_add_u32 v3, v5, 5, v3
    v_lshl_add_u32 v3, v4, 9, v3
    s_lshl_b32 s54, s48, 11
    s_add_u32 s54, s54, 150016
    v_add_u32 v14, s54, v3
    v_and_b32 v5, 31, v1
    v_lshlrev_b32 v5, 2, v5
    v_lshrrev_b32 v10, 5, v1
    v_lshl_add_u32 v10, v10, 12, v5
    s_lshl_b32 s54, s48, 7
    s_add_u32 s54, s54, 150016
    v_add_u32 v10, s54, v10
    s_waitcnt vmcnt(12)
    s_barrier
    s_mov_b32 m0, s51
    s_mov_b32 s52, s49
    buffer_load_dwordx4 v210, s[4:7], s52 offen offset:0 lds
    s_add_u32 s52, s52, 9216
    buffer_load_dwordx4 v211, s[4:7], s52 offen offset:1024 lds
    s_add_u32 s52, s52, 9216
    buffer_load_dwordx4 v210, s[4:7], s52 offen offset:2048 lds
    s_add_u32 s52, s52, 9216
    buffer_load_dwordx4 v211, s[4:7], s52 offen offset:3072 lds
    s_add_u32 s52, s52, 9216
    s_add_u32 m0, s51, 4096
    s_add_u32 s52, s52, 4096
    buffer_load_dwordx4 v210, s[4:7], s52 offen offset:0 lds
    s_add_u32 s52, s52, 9216
    buffer_load_dwordx4 v211, s[4:7], s52 offen offset:1024 lds
    s_add_u32 s52, s52, 9216
    buffer_load_dwordx4 v210, s[4:7], s52 offen offset:2048 lds
    s_add_u32 s52, s52, 9216
    buffer_load_dwordx4 v211, s[4:7], s52 offen offset:3072 lds
    s_add_u32 m0, s51, s67
    s_add_u32 s52, s50, 14336
    buffer_load_dwordx4 v212, s[8:11], s50 offen lds
    buffer_load_dwordx4 v212, s[8:11], s52 offen offset:1024 lds
    s_add_u32 s52, s52, 14336
    s_add_u32 s62, s52, 14336
    s_add_u32 s68, s68, 1
    s_cmp_eq_u32 s68, 3
    s_cselect_b32 s68, 0, s68
    s_cselect_b32 s63, -98304, s69
    s_add_u32 s51, s51, s63
    s_add_u32 s53, s53, 1
    s_cmp_eq_u32 s53, 10
    s_cselect_b32 s63, -1152, s65
    s_cselect_b32 s64, -2211840, s66
    s_add_u32 s49, s49, s63
    s_add_u32 s50, s50, s64
    buffer_load_dwordx4 v212, s[8:11], s52 offen offset:2048 lds
    buffer_load_dwordx4 v212, s[8:11], s62 offen offset:3072 lds
    s_cmp_ge_u32 s76, 5
    s_cbranch_scc1 cj_1
    ds_read_b128 v[48:51], v13 offset:0
    ds_read_b128 v[52:55], v13 offset:1024
    ds_read_b128 v[56:59], v13 offset:2048
    ds_read_b128 v[60:63], v13 offset:3072
    s_waitcnt lgkmcnt(3)
    v_lshlrev_b32 v16, 16, v48
    v_and_b32 v17, 0xffff0000, v48
    v_lshlrev_b32 v18, 16, v49
    v_and_b32 v19, 0xffff0000, v49
    v_lshlrev_b32 v20, 16, v50
    v_and_b32 v21, 0xffff0000, v50
    v_lshlrev_b32 v22, 16, v51
    v_and_b32 v23, 0xffff0000, v51
    s_waitcnt lgkmcnt(2)
    v_lshlrev_b32 v24, 16, v52
    v_and_b32 v25, 0xffff0000, v52
    v_add_f32 v16, v16, v24
    v_add_f32 v17, v17, v25
    v_lshlrev_b32 v24, 16, v53
    v_and_b32 v25, 0xffff0000, v53
    v_add_f32 v18, v18, v24
    v_add_f32 v19, v19, v25
    v_lshlrev_b32 v24, 16, v54
    v_and_b32 v25, 0xffff0000, v54
    v_add_f32 v20, v20, v24
    v_add_f32 v21, v21, v25
    v_lshlrev_b32 v24, 16, v55
    v_and_b32 v25, 0xffff0000, v55
    v_add_f32 v22, v22, v24
    v_add_f32 v23, v23, v25
    s_waitcnt lgkmcnt(1)
    v_lshlrev_b32 v24, 16, v56
    v_and_b32 v25, 0xffff0000, v56
    v_add_f32 v16, v16, v24
    v_add_f32 v17, v17, v25
    v_lshlrev_b32 v24, 16, v57
    v_and_b32 v25, 0xffff0000, v57
    v_add_f32 v18, v18, v24
    v_add_f32 v19, v19, v25
    v_lshlrev_b32 v24, 16, v58
    v_and_b32 v25, 0xffff0000, v58
    v_add_f32 v20, v20, v24
    v_add_f32 v21, v21, v25
    v_lshlrev_b32 v24, 16, v59
    v_and_b32 v25, 0xffff0000, v59
    v_add_f32 v22, v22, v24
    v_add_f32 v23, v23, v25
    s_waitcnt lgkmcnt(0)
    v_lshlrev_b32 v24, 16, v60
    v_and_b32 v25, 0xffff0000, v60
    v_add_f32 v16, v16, v24
    v_add_f32 v17, v17, v25
    v_lshlrev_b32 v24, 16, v61
    v_and_b32 v25, 0xffff0000, v61
    v_add_f32 v18, v18, v24
    v_add_f32 v19, v19, v25
    v_lshlrev_b32 v24, 16, v62
    v_and_b32 v25, 0xffff0000, v62
    v_add_f32 v20, v20, v24
    v_add_f32 v21, v21, v25
    v_lshlrev_b32 v24, 16, v63
    v_and_b32 v25, 0xffff0000, v63
    v_add_f32 v22, v22, v24
    v_add_f32 v23, v23, v25
cj_1:
    s_waitcnt vmcnt(12)
    s_cmp_ge_u32 s76, 5
    s_cbranch_scc1 cj_2
    ds_read_b128 v[48:51], v13 offset:49152
    ds_read_b128 v[52:55], v13 offset:50176
    ds_read_b128 v[56:59], v13 offset:51200
    ds_read_b128 v[60:63], v13 offset:52224
    s_waitcnt lgkmcnt(3)
    v_lshlrev_b32 v24, 16, v48
    v_and_b32 v25, 0xffff0000, v48
    v_add_f32 v16, v16, v24
    v_add_f32 v17, v17, v25
    v_lshlrev_b32 v24, 16, v49
    v_and_b32 v25, 0xffff0000, v49
    v_add_f32 v18, v18, v24
    v_add_f32 v19, v19, v25
    v_lshlrev_b32 v24, 16, v50
    v_and_b32 v25, 0xffff0000, v50
    v_add_f32 v20, v20, v24
    v_add_f32 v21, v21, v25
    v_lshlrev_b32 v24, 16, v51
    v_and_b32 v25, 0xffff0000, v51
    v_add_f32 v22, v22, v24
    v_add_f32 v23, v23, v25
    s_waitcnt lgkmcnt(2)
    v_lshlrev_b32 v24, 16, v52
    v_and_b32 v25, 0xffff0000, v52
    v_add_f32 v16, v16, v24
    v_add_f32 v17, v17, v25
    v_lshlrev_b32 v24, 16, v53
    v_and_b32 v25, 0xffff0000, v53
    v_add_f32 v18, v18, v24
    v_add_f32 v19, v19, v25
    v_lshlrev_b32 v24, 16, v54
    v_and_b32 v25, 0xffff0000, v54
    v_add_f32 v20, v20, v24
    v_add_f32 v21, v21, v25
    v_lshlrev_b32 v24, 16, v55
    v_and_b32 v25, 0xffff0000, v55
    v_add_f32 v22, v22, v24
    v_add_f32 v23, v23, v25
    s_waitcnt lgkmcnt(1)
    v_lshlrev_b32 v24, 16, v56
    v_and_b32 v25, 0xffff0000, v56
    v_add_f32 v16, v16, v24
    v_add_f32 v17, v17, v25
    v_lshlrev_b32 v24, 16, v57
    v_and_b32 v25, 0xffff0000, v57
    v_add_f32 v18, v18, v24
    v_add_f32 v19, v19, v25
    v_lshlrev_b32 v24, 16, v58
    v_and_b32 v25, 0xffff0000, v58
    v_add_f32 v20, v20, v24
    v_add_f32 v21, v21, v25
    v_lshlrev_b32 v24, 16, v59
    v_and_b32 v25, 0xffff0000, v59
    v_add_f32 v22, v22, v24
    v_add_f32 v23, v23, v25
    s_waitcnt lgkmcnt(0)
    v_lshlrev_b32 v24, 16, v60
    v_and_b32 v25, 0xffff0000, v60
    v_add_f32 v16, v16, v24
    v_add_f32 v17, v17, v25
    v_lshlrev_b32 v24, 16, v61
    v_and_b32 v25, 0xffff0000, v61
    v_add_f32 v18, v18, v24
    v_add_f32 v19, v19, v25
    v_lshlrev_b32 v24, 16, v62
    v_and_b32 v25, 0xffff0000, v62
    v_add_f32 v20, v20, v24
    v_add_f32 v21, v21, v25
    v_lshlrev_b32 v24, 16, v63
    v_and_b32 v25, 0xffff0000, v63
    v_add_f32 v22, v22, v24
    v_add_f32 v23, v23, v25
    ds_write_b128 v14, v[16:19]
    ds_write_b128 v14, v[20:23] offset:16
    s_waitcnt lgkmcnt(0)
cj_2:
    s_barrier
    s_cmp_ge_u32 s76, 5
    s_cbranch_scc1 cb_3
    ds_read_b32 v16, v10 offset:0
    ds_read_b32 v17, v10 offset:512
    ds_read_b32 v18, v10 offset:1024
    ds_read_b32 v19, v10 offset:1536
    ds_read_b32 v20, v10 offset:2048
    ds_read_b32 v21, v10 offset:2560
    ds_read_b32 v22, v10 offset:3072
    ds_read_b32 v23, v10 offset:3584
    s_waitcnt lgkmcnt(0)
    v_add_f32 v16, v16, v17
    v_add_f32 v16, v16, v18
    v_add_f32 v16, v16, v19
    v_add_f32 v16, v16, v20
    v_add_f32 v16, v16, v21
    v_add_f32 v16, v16, v22
    v_add_f32 v16, v16, v23
    v_mov_b32 v17, v16
    s_nop 1
    v_permlane32_swap_b32 v16, v17
    v_add_f32 v16, v16, v17
    s_mov_b32 exec_hi, 0
    buffer_store_dword v16, v5, s[24:27], s59 offen sc1
    s_mov_b64 exec, -1
cb_3:
    s_mov_b32 m0, s51
    s_mov_b32 s52, s49
    buffer_load_dwordx4 v210, s[4:7], s52 offen offset:0 lds
    s_add_u32 s52, s52, 9216
    buffer_load_dwordx4 v211, s[4:7], s52 offen offset:1024 lds
    s_add_u32 s52, s52, 9216
    buffer_load_dwordx4 v210, s[4:7], s52 offen offset:2048 lds
    s_add_u32 s52, s52, 9216
    buffer_load_dwordx4 v211, s[4:7], s52 offen offset:3072 lds
    s_add_u32 s52, s52, 9216
    s_add_u32 m0, s51, 4096
    s_add_u32 s52, s52, 4096
    buffer_load_dwordx4 v210, s[4:7], s52 offen offset:0 lds
    s_add_u32 s52, s52, 9216
    buffer_load_dwordx4 v211, s[4:7], s52 offen offset:1024 lds
    s_add_u32 s52, s52, 9216
    buffer_load_dwordx4 v210, s[4:7], s52 offen offset:2048 lds
    s_add_u32 s52, s52, 9216
    buffer_load_dwordx4 v211, s[4:7], s52 offen offset:3072 lds
    s_add_u32 m0, s51, s67
    s_add_u32 s52, s50, 14336
    buffer_load_dwordx4 v212, s[8:11], s50 offen lds
    buffer_load_dwordx4 v212, s[8:11], s52 offen offset:1024 lds
    s_add_u32 s52, s52, 14336
    s_add_u32 s62, s52, 14336
    s_add_u32 s68, s68, 1
    s_cmp_eq_u32 s68, 3
    s_cselect_b32 s68, 0, s68
    s_cselect_b32 s63, -98304, s69
    s_add_u32 s51, s51, s63
    s_add_u32 s53, s53, 1
    s_cmp_eq_u32 s53, 10
    s_cselect_b32 s63, -1152, s65
    s_cselect_b32 s64, -2211840, s66
    s_add_u32 s49, s49, s63
    s_add_u32 s50, s50, s64
    buffer_load_dwordx4 v212, s[8:11], s52 offen offset:2048 lds
    buffer_load_dwordx4 v212, s[8:11], s62 offen offset:3072 lds
    s_waitcnt vmcnt(12)
    s_barrier
    s_cmp_lg_u32 s48, 3
    s_cbranch_scc1 n1_4
    s_cmp_ge_u32 s76, 5
    s_cbranch_scc1 n1_4
    s_mov_b64 exec, 1
    v_mov_b32 v15, 1
    buffer_atomic_add v15, off, s[40:43], 0 offset:96 sc0 sc1
    s_mov_b64 exec, -1
n1_4:
    s_mov_b32 m0, s51
    s_mov_b32 s52, s49
    buffer_load_dwordx4 v210, s[4:7], s52 offen offset:0 lds
    s_add_u32 s52, s52, 9216
    buffer_load_dwordx4 v211, s[4:7], s52 offen offset:1024 lds
    s_add_u32 s52, s52, 9216
    buffer_load_dwordx4 v210, s[4:7], s52 offen offset:2048 lds
    s_add_u32 s52, s52, 9216
    buffer_load_dwordx4 v211, s[4:7], s52 offen offset:3072 lds
    s_add_u32 s52, s52, 9216
    s_add_u32 m0, s51, 4096
    s_add_u32 s52, s52, 4096
    buffer_load_dwordx4 v210, s[4:7], s52 offen offset:0 lds
    s_add_u32 s52, s52, 9216
    buffer_load_dwordx4 v211, s[4:7], s52 offen offset:1024 lds
    s_add_u32 s52, s52, 9216
    buffer_load_dwordx4 v210, s[4:7], s52 offen offset:2048 lds
    s_add_u32 s52, s52, 9216
    buffer_load_dwordx4 v211, s[4:7], s52 offen offset:3072 lds
    s_add_u32 m0, s51, s67
    s_add_u32 s52, s50, 14336
    buffer_load_dwordx4 v212, s[8:11], s50 offen lds
    buffer_load_dwordx4 v212, s[8:11], s52 offen offset:1024 lds
    s_add_u32 s52, s52, 14336
    s_add_u32 s62, s52, 14336
    s_add_u32 s68, s68, 1
    s_cmp_eq_u32 s68, 3
    s_cselect_b32 s68, 0, s68
    s_cselect_b32 s63, -98304, s69
    s_add_u32 s51, s51, s63
    s_add_u32 s53, s53, 1
    s_cmp_eq_u32 s53, 10
    s_cselect_b32 s63, -1152, s65
    s_cselect_b32 s64, -2211840, s66
    s_add_u32 s49, s49, s63
    s_add_u32 s50, s50, s64
    buffer_load_dwordx4 v212, s[8:11], s52 offen offset:2048 lds
    buffer_load_dwordx4 v212, s[8:11], s62 offen offset:3072 lds
    s_cmp_lg_u32 s48, 3
    s_cbranch_scc1 n3_5
    s_cmp_ge_u32 s76, 5
    s_cbranch_scc1 n3_5
    s_waitcnt vmcnt(12)
    v_readfirstlane_b32 s60, v15
    s_cmp_lg_u32 s60, 74
    s_cbranch_scc1 n3_5
    s_mov_b64 exec, 1
    buffer_store_dword v9, off, s[40:43], 0 offset:136 sc1
    s_mov_b64 exec, -1
n3_5:
    s_waitcnt vmcnt(12)
    s_barrier
    s_mov_b32 m0, s51
    s_mov_b32 s52, s49
    buffer_load_dwordx4 v210, s[4:7], s52 offen offset:0 lds
    s_add_u32 s52, s52, 9216
    buffer_load_dwordx4 v211, s[4:7], s52 offen offset:1024 lds
    s_add_u32 s52, s52, 9216
    buffer_load_dwordx4 v210, s[4:7], s52 offen offset:2048 lds
    s_add_u32 s52, s52, 9216
    buffer_load_dwordx4 v211, s[4:7], s52 offen offset:3072 lds
    s_add_u32 s52, s52, 9216
    s_add_u32 m0, s51, 4096
    s_add_u32 s52, s52, 4096
    buffer_load_dwordx4 v210, s[4:7], s52 offen offset:0 lds
    s_add_u32 s52, s52, 9216
    buffer_load_dwordx4 v211, s[4:7], s52 offen offset:1024 lds
    s_add_u32 s52, s52, 9216
    buffer_load_dwordx4 v210, s[4:7], s52 offen offset:2048 lds
    s_add_u32 s52, s52, 9216
    buffer_load_dwordx4 v211, s[4:7], s52 offen offset:3072 lds
    s_add_u32 m0, s51, s67
    s_add_u32 s52, s50, 14336
    buffer_load_dwordx4 v212, s[8:11], s50 offen lds
    buffer_load_dwordx4 v212, s[8:11], s52 offen offset:1024 lds
    s_add_u32 s52, s52, 14336
    s_add_u32 s62, s52, 14336
    s_add_u32 s68, s68, 1
    s_cmp_eq_u32 s68, 3
    s_cselect_b32 s68, 0, s68
    s_cselect_b32 s63, -98304, s69
    s_add_u32 s51, s51, s63
    s_add_u32 s53, s53, 1
    s_cmp_eq_u32 s53, 10
    s_cselect_b32 s63, -1152, s65
    s_cselect_b32 s64, -2211840, s66
    s_add_u32 s49, s49, s63
    s_add_u32 s50, s50, s64
    buffer_load_dwordx4 v212, s[8:11], s52 offen offset:2048 lds
    buffer_load_dwordx4 v212, s[8:11], s62 offen offset:3072 lds
    s_waitcnt vmcnt(12)
    s_barrier
    s_mov_b32 m0, s51
    s_mov_b32 s52, s49
    buffer_load_dwordx4 v210, s[4:7], s52 offen offset:0 lds
    s_add_u32 s52, s52, 9216
    buffer_load_dwordx4 v211, s[4:7], s52 offen offset:1024 lds
    s_add_u32 s52, s52, 9216
    buffer_load_dwordx4 v210, s[4:7], s52 offen offset:2048 lds
    s_add_u32 s52, s52, 9216
    buffer_load_dwordx4 v211, s[4:7], s52 offen offset:3072 lds
    s_add_u32 s52, s52, 9216
    s_add_u32 m0, s51, 4096
    s_add_u32 s52, s52, 4096
    buffer_load_dwordx4 v210, s[4:7], s52 offen offset:0 lds
    s_add_u32 s52, s52, 9216
    buffer_load_dwordx4 v211, s[4:7], s52 offen offset:1024 lds
    s_add_u32 s52, s52, 9216
    buffer_load_dwordx4 v210, s[4:7], s52 offen offset:2048 lds
    s_add_u32 s52, s52, 9216
    buffer_load_dwordx4 v211, s[4:7], s52 offen offset:3072 lds
    s_add_u32 m0, s51, s67
    s_add_u32 s52, s50, 14336
    buffer_load_dwordx4 v212, s[8:11], s50 offen lds
    buffer_load_dwordx4 v212, s[8:11], s52 offen offset:1024 lds
    s_add_u32 s52, s52, 14336
    s_add_u32 s62, s52, 14336
    s_add_u32 s68, s68, 1
    s_cmp_eq_u32 s68, 3
    s_cselect_b32 s68, 0, s68
    s_cselect_b32 s63, -98304, s69
    s_add_u32 s51, s51, s63
    s_add_u32 s53, s53, 1
    s_cmp_eq_u32 s53, 10
    s_cselect_b32 s63, -1152, s65
    s_cselect_b32 s64, -2211840, s66
    s_add_u32 s49, s49, s63
    s_add_u32 s50, s50, s64
    buffer_load_dwordx4 v212, s[8:11], s52 offen offset:2048 lds
    buffer_load_dwordx4 v212, s[8:11], s62 offen offset:3072 lds
    s_waitcnt vmcnt(12)
    s_barrier
    s_mov_b32 m0, s51
    s_mov_b32 s52, s49
    buffer_load_dwordx4 v210, s[4:7], s52 offen offset:0 lds
    s_add_u32 s52, s52, 9216
    buffer_load_dwordx4 v211, s[4:7], s52 offen offset:1024 lds
    s_add_u32 s52, s52, 9216
    buffer_load_dwordx4 v210, s[4:7], s52 offen offset:2048 lds
    s_add_u32 s52, s52, 9216
    buffer_load_dwordx4 v211, s[4:7], s52 offen offset:3072 lds
    s_add_u32 s52, s52, 9216
    s_add_u32 m0, s51, 4096
    s_add_u32 s52, s52, 4096
    buffer_load_dwordx4 v210, s[4:7], s52 offen offset:0 lds
    s_add_u32 s52, s52, 9216
    buffer_load_dwordx4 v211, s[4:7], s52 offen offset:1024 lds
    s_add_u32 s52, s52, 9216
    buffer_load_dwordx4 v210, s[4:7], s52 offen offset:2048 lds
    s_add_u32 s52, s52, 9216
    buffer_load_dwordx4 v211, s[4:7], s52 offen offset:3072 lds
    s_add_u32 m0, s51, s67
    s_add_u32 s52, s50, 14336
    buffer_load_dwordx4 v212, s[8:11], s50 offen lds
    buffer_load_dwordx4 v212, s[8:11], s52 offen offset:1024 lds
    s_add_u32 s52, s52, 14336
    s_add_u32 s62, s52, 14336
    s_add_u32 s68, s68, 1
    s_cmp_eq_u32 s68, 3
    s_cselect_b32 s68, 0, s68
    s_cselect_b32 s63, -98304, s69
    s_add_u32 s51, s51, s63
    s_add_u32 s53, s53, 1
    s_cmp_eq_u32 s53, 10
    s_cselect_b32 s63, -1152, s65
    s_cselect_b32 s64, -2211840, s66
    s_add_u32 s49, s49, s63
    s_add_u32 s50, s50, s64
    buffer_load_dwordx4 v212, s[8:11], s52 offen offset:2048 lds
    buffer_load_dwordx4 v212, s[8:11], s62 offen offset:3072 lds
    s_waitcnt vmcnt(12)
    s_barrier
    s_cmp_lg_u32 s48, 0
    s_cbranch_scc1 n0_6
    v_lshlrev_b32 v2, 2, v1
    v_add_u32 v2, 128, v2
    s_mov_b64 exec, 7
    buffer_load_dword v3, v2, s[40:43], 0 offen sc1
    s_mov_b64 exec, -1
n0_6:
    s_mov_b32 m0, s51
    s_mov_b32 s52, s49
    buffer_load_dwordx4 v210, s[4:7], s52 offen offset:0 lds
    s_add_u32 s52, s52, 9216
    buffer_load_dwordx4 v211, s[4:7], s52 offen offset:1024 lds
    s_add_u32 s52, s52, 9216
    buffer_load_dwordx4 v210, s[4:7], s52 offen offset:2048 lds
    s_add_u32 s52, s52, 9216
    buffer_load_dwordx4 v211, s[4:7], s52 offen offset:3072 lds
    s_add_u32 s52, s52, 9216
    s_add_u32 m0, s51, 4096
    s_add_u32 s52, s52, 4096
    buffer_load_dwordx4 v210, s[4:7], s52 offen offset:0 lds
    s_add_u32 s52, s52, 9216
    buffer_load_dwordx4 v211, s[4:7], s52 offen offset:1024 lds
    s_add_u32 s52, s52, 9216
    buffer_load_dwordx4 v210, s[4:7], s52 offen offset:2048 lds
    s_add_u32 s52, s52, 9216
    buffer_load_dwordx4 v211, s[4:7], s52 offen offset:3072 lds
    s_add_u32 m0, s51, s67
    s_add_u32 s52, s50, 14336
    buffer_load_dwordx4 v212, s[8:11], s50 offen lds
    buffer_load_dwordx4 v212, s[8:11], s52 offen offset:1024 lds
    s_add_u32 s52, s52, 14336
    s_add_u32 s62, s52, 14336
    s_add_u32 s68, s68, 1
    s_cmp_eq_u32 s68, 3
    s_cselect_b32 s68, 0, s68
    s_cselect_b32 s63, -98304, s69
    s_add_u32 s51, s51, s63
    s_add_u32 s53, s53, 1
    s_cmp_eq_u32 s53, 10
    s_cselect_b32 s63, -1152, s65
    s_cselect_b32 s64, -2211840, s66
    s_add_u32 s49, s49, s63
    s_add_u32 s50, s50, s64
    buffer_load_dwordx4 v212, s[8:11], s52 offen offset:2048 lds
    buffer_load_dwordx4 v212, s[8:11], s62 offen offset:3072 lds
    s_cmp_lg_u32 s48, 0
    s_cbranch_scc1 n0_7
    s_waitcnt vmcnt(12)
    s_mov_b64 exec, 7
    v_cmp_ne_u32 vcc, 1, v3
    s_mov_b64 exec, -1
    s_cbranch_vccz n0_7
    s_mov_b64 exec, 7
    s_mov_b32 s47, 0x8000
gp_8:
    buffer_load_dword v3, v2, s[40:43], 0 offen sc1
    s_sub_u32 s47, s47, 1
    s_cbranch_scc1 gp_8x
    s_waitcnt vmcnt(0)
    v_cmp_ne_u32 vcc, 1, v3
    s_cbranch_vccz gp_8x
    s_sleep 2
    s_branch gp_8
gp_8x:
    s_mov_b64 exec, -1
n0_7:
    s_waitcnt vmcnt(12)
    s_barrier
    v_lshlrev_b32 v4, 4, v1
    s_cmp_eq_u32 s48, 3
    s_cbranch_scc1 nst_9
    s_cmp_eq_u32 s48, 2
    s_cbranch_scc1 ncs_10
    s_lshl_b32 s54, s76, 10
    s_lshl_b32 s55, s48, 13
    s_add_u32 s54, s54, s55
    s_lshl_b32 s55, s48, 10
    s_add_u32 m0, s55, 147456
    s_nop 0
    buffer_load_dwordx4 v4, s[24:27], s54 offen sc1 lds
    s_branch nst_9
ncs_10:
    s_mul_i32 s54, s77, 2560
    s_add_u32 s54, s54, 49152
    v_cmp_gt_u32 vcc, 32, v1
    v_mov_b32 v5, 0x7fff0000
    s_nop 0
    v_cndmask_b32 v5, v5, v4, vcc
    buffer_load_dwordx4 v[16:19], v4, s[24:27], s54 offen offset:0 sc1
    buffer_load_dwordx4 v[20:23], v4, s[24:27], s54 offen offset:1024 sc1
    buffer_load_dwordx4 v[24:27], v5, s[24:27], s54 offen offset:2048 sc1
nst_9:
    s_mov_b32 m0, s51
    s_mov_b32 s52, s49
    buffer_load_dwordx4 v210, s[4:7], s52 offen offset:0 lds
    s_add_u32 s52, s52, 9216
    buffer_load_dwordx4 v211, s[4:7], s52 offen offset:1024 lds
    s_add_u32 s52, s52, 9216
    buffer_load_dwordx4 v210, s[4:7], s52 offen offset:2048 lds
    s_add_u32 s52, s52, 9216
    buffer_load_dwordx4 v211, s[4:7], s52 offen offset:3072 lds
    s_add_u32 s52, s52, 9216
    s_add_u32 m0, s51, 4096
    s_add_u32 s52, s52, 4096
    buffer_load_dwordx4 v210, s[4:7], s52 offen offset:0 lds
    s_add_u32 s52, s52, 9216
    buffer_load_dwordx4 v211, s[4:7], s52 offen offset:1024 lds
    s_add_u32 s52, s52, 9216
    buffer_load_dwordx4 v210, s[4:7], s52 offen offset:2048 lds
    s_add_u32 s52, s52, 9216
    buffer_load_dwordx4 v211, s[4:7], s52 offen offset:3072 lds
    s_add_u32 m0, s51, s67
    s_add_u32 s52, s50, 14336
    buffer_load_dwordx4 v212, s[8:11], s50 offen lds
    buffer_load_dwordx4 v212, s[8:11], s52 offen offset:1024 lds
    s_add_u32 s52, s52, 14336
    s_add_u32 s62, s52, 14336
    s_add_u32 s68, s68, 1
    s_cmp_eq_u32 s68, 3
    s_cselect_b32 s68, 0, s68
    s_cselect_b32 s63, -98304, s69
    s_add_u32 s51, s51, s63
    s_add_u32 s53, s53, 1
    s_cmp_eq_u32 s53, 10
    s_cselect_b32 s63, -1152, s65
    s_cselect_b32 s64, -2211840, s66
    s_add_u32 s49, s49, s63
    s_add_u32 s50, s50, s64
    buffer_load_dwordx4 v212, s[8:11], s52 offen offset:2048 lds
    buffer_load_dwordx4 v212, s[8:11], s62 offen offset:3072 lds
    s_mul_i32 s61, s45, 15
    s_add_u32 s61, s61, s46
    s_lshr_b32 s51, s61, 2
    s_and_b32 s52, s61, 3
    s_mul_i32 s53, s51, 52
    s_lshr_b32 s53, s53, 8
    s_mul_i32 s54, s53, 5
    s_sub_u32 s54, s51, s54
    s_lshl_b32 s56, s53, 4
    s_lshl_b32 s57, s54, 2
    s_add_u32 s56, s56, s57
    s_add_u32 s56, s56, s52
    s_lshr_b32 s57, s56, 1
    s_mul_i32 s57, s57, 20
    s_and_b32 s56, s56, 1
    s_lshl_b32 s56, s56, 2
    s_add_u32 s56, s56, s57
    s_lshl_b32 s57, s53, 3
    s_lshl_b32 s58, s52, 1
    s_add_u32 s57, s57, s58
    s_mul_i32 s57, s57, 20
    s_add_u32 s57, s57, 16
    s_cmp_eq_u32 s54, 4
    s_cselect_b32 s56, s57, s56
    s_cselect_b32 s57, 20, 8
    s_cmp_ge_u32 s75, 2
    s_cselect_b32 s57, s57, 0
    s_add_u32 s56, s56, s57
    s_and_b32 s57, s75, 1
    s_lshl_b32 s57, s57, 1
    s_add_u32 s53, s56, s57
    s_mul_i32 s54, s53, 1280
    v_lshrrev_b32 v2, 5, v1
    v_and_b32 v3, 31, v1
    v_mul_u32_u24 v6, 1280, v2
    v_lshl_add_u32 v7, v3, 3, v6
    v_lshl_add_u32 v6, v3, 4, v6
    buffer_load_dwordx4 v[32:35], v6, s[12:15], s54 offen
    buffer_load_dwordx4 v[36:39], v6, s[12:15], s54 offen offset:512
    buffer_load_dwordx2 v[40:41], v7, s[12:15], s54 offen offset:1024
    s_mul_i32 s55, s51, 5120
    s_lshl_b32 s52, s52, 8
    s_add_u32 s55, s55, s52
    s_add_u32 s62, s55, 5373952
    s_lshr_b32 s51, s20, 7
    s_sub_u32 s51, 3, s51
    s_and_b32 s51, s51, 7
    s_lshl_b32 s51, s51, 7
    v_lshrrev_b32 v2, 3, v1
    v_lshlrev_b32 v2, 12, v2
    v_and_b32 v3, 7, v1
    v_lshl_add_u32 v6, v3, 4, v2
    s_lshl_b32 s52, s61, 2
    s_add_u32 s52, s52, s75
    s_add_u32 s52, s52, 0
    s_lshl_b32 s63, s52, 11
    s_add_u32 s63, s63, 21106688
    s_mul_i32 s53, s52, 4855
    s_lshr_b32 s53, s53, 20
    s_mul_i32 s54, s53, 216
    s_sub_u32 s54, s52, s54
    s_lshl_b32 s54, s54, 15
    s_lshl_b32 s53, s53, 10
    s_add_u32 s54, s54, s53
    s_add_u32 s54, s54, s51
    s_cmp_ge_u32 s52, 864
    s_cselect_b32 s54, 0x7fff0000, s54
    s_cselect_b32 s63, 0x7fff0000, s63
    buffer_load_dwordx4 v[44:47], v6, s[20:23], s54 offen
    s_lshl_b32 s52, s61, 2
    s_add_u32 s52, s52, s75
    s_add_u32 s52, s52, 480
    s_lshl_b32 s64, s52, 11
    s_add_u32 s64, s64, 21106688
    s_mul_i32 s53, s52, 4855
    s_lshr_b32 s53, s53, 20
    s_mul_i32 s54, s53, 216
    s_sub_u32 s54, s52, s54
    s_lshl_b32 s54, s54, 15
    s_lshl_b32 s53, s53, 10
    s_add_u32 s54, s54, s53
    s_add_u32 s54, s54, s51
    s_cmp_ge_u32 s52, 864
    s_cselect_b32 s54, 0x7fff0000, s54
    s_cselect_b32 s64, 0x7fff0000, s64
    buffer_load_dwordx4 v[48:51], v6, s[20:23], s54 offen
    s_waitcnt vmcnt(17)
    s_cmp_lg_u32 s48, 2
    s_cbranch_scc1 sk_11
    v_and_b32 v2, 31, v1
    v_lshlrev_b32 v2, 4, v2
    v_add_u32 v2, 149504, v2
    v_pk_add_f32 v[16:17], v[16:17], v[20:21]
    v_pk_add_f32 v[18:19], v[18:19], v[22:23]
    v_pk_add_f32 v[16:17], v[16:17], v[24:25]
    v_pk_add_f32 v[18:19], v[18:19], v[26:27]
    v_mov_b32 v20, v16
    v_mov_b32 v21, v17
    v_mov_b32 v22, v18
    v_mov_b32 v23, v19
    s_nop 0
    v_permlane32_swap_b32 v16, v20
    v_permlane32_swap_b32 v17, v21
    v_permlane32_swap_b32 v18, v22
    v_permlane32_swap_b32 v19, v23
    v_pk_add_f32 v[16:17], v[16:17], v[20:21]
    v_pk_add_f32 v[18:19], v[18:19], v[22:23]
    ds_write_b128 v2, v[16:19]
    s_waitcnt lgkmcnt(0)
sk_11:
    s_barrier
    s_waitcnt vmcnt(5)
    s_barrier
    v_lshlrev_b32 v10, 4, v1
    v_cmp_le_u32 vcc, 56, v1
    v_add_u32 v10, 512, v10
    v_add_u32 v2, 128, v10
    v_cndmask_b32 v10, v10, v2, vcc
    s_waitcnt vmcnt(0)
    buffer_store_dwordx4 v[44:47], v10, s[24:27], s63 offen sc1
    buffer_store_dwordx4 v[48:51], v10, s[24:27], s64 offen sc1
    s_cmp_ge_u32 s61, 80
    s_cbranch_scc1 L_nowof
    v_lshrrev_b32 v2, 4, v1
    v_and_b32 v3, 15, v1
    v_lshrrev_b32 v4, 2, v3
    v_mul_u32_u24 v4, 1344, v4
    v_lshl_add_u32 v4, v2, 5, v4
    v_and_b32 v5, 3, v3
    v_lshl_add_u32 v4, v5, 3, v4
    s_lshl_b32 s54, s75, 7
    s_add_u32 s54, s54, 150016
    v_add_u32 v214, s54, v4
    s_mov_b32 s55, 97280
    s_lshl_b32 s54, s75, 2
    s_add_u32 s54, s54, 0
    v_add_u32 v5, s54, v2
    v_mul_u32_u24 v6, 52, v5
    v_lshrrev_b32 v6, 8, v6
    v_mul_u32_u24 v6, s55, v6
    v_lshl_add_u32 v6, v5, 10, v6
    v_lshl_add_u32 v215, v3, 4, v6
    s_lshl_b32 s54, s75, 2
    s_add_u32 s54, s54, 16
    v_add_u32 v5, s54, v2
    v_mul_u32_u24 v6, 52, v5
    v_lshrrev_b32 v6, 8, v6
    v_mul_u32_u24 v6, s55, v6
    v_lshl_add_u32 v6, v5, 10, v6
    v_lshl_add_u32 v216, v3, 4, v6
    s_lshl_b32 s54, s75, 2
    s_add_u32 s54, s54, 32
    v_add_u32 v5, s54, v2
    v_mul_u32_u24 v6, 52, v5
    v_lshrrev_b32 v6, 8, v6
    v_mul_u32_u24 v6, s55, v6
    v_lshl_add_u32 v6, v5, 10, v6
    v_lshl_add_u32 v217, v3, 4, v6
    s_cmp_ge_u32 s75, 2
    s_cselect_b64 vcc, -1, 0
    v_mov_b32 v5, 0x7fff0000
    v_cndmask_b32 v217, v217, v5, vcc
    v_lshrrev_b32 v2, 5, v1
    v_and_b32 v3, 31, v1
    s_mul_i32 s54, s75, 2688
    s_add_u32 s54, s54, 150016
    v_mul_u32_u24 v4, 1344, v2
    v_add_u32 v4, s54, v4
    v_lshl_add_u32 v5, v3, 3, v4
    v_lshl_add_u32 v4, v3, 4, v4
    ds_write_b128 v4, v[32:35]
    ds_write_b128 v4, v[36:39] offset:512
    ds_write_b64 v5, v[40:41] offset:1024
    s_waitcnt lgkmcnt(0)
    v_mov_b32 v2, 163792
    v_mov_b32 v3, 1
    s_mov_b64 exec, 1
    ds_add_u32 v2, v3
    s_mov_b64 exec, -1
    s_mov_b32 s47, 0x80000
sync_12:
    ds_read_b32 v3, v2
    s_sub_u32 s47, s47, 1
    s_cbranch_scc1 sync_12x
    s_waitcnt lgkmcnt(0)
    v_readfirstlane_b32 s60, v3
    s_cmp_ge_u32 s60, 4
    s_cbranch_scc1 sync_12x
    s_sleep 1
    s_branch sync_12
sync_12x:
    ds_read_b64_tr_b16 v[16:17], v214 offset:0
    ds_read_b64_tr_b16 v[18:19], v214 offset:5376
    ds_read_b64_tr_b16 v[20:21], v214 offset:512
    ds_read_b64_tr_b16 v[22:23], v214 offset:5888
    ds_read_b64_tr_b16 v[24:25], v214 offset:1024
    ds_read_b64_tr_b16 v[26:27], v214 offset:6400
    s_waitcnt lgkmcnt(4)
    buffer_store_dwordx4 v[16:19], v215, s[24:27], s62 offen sc1
    s_waitcnt lgkmcnt(2)
    buffer_store_dwordx4 v[20:23], v216, s[24:27], s62 offen sc1
    s_cmp_ge_u32 s75, 2
    s_cbranch_scc1 tg_13
    s_waitcnt lgkmcnt(0)
    buffer_store_dwordx4 v[24:27], v217, s[24:27], s62 offen sc1
tg_13:
L_nowof:
    s_mov_b32 s61, 36864
    s_waitcnt vmcnt(0)
    v_mov_b32 v2, 163800
    v_mov_b32 v3, 1
    s_mov_b64 exec, 1
    ds_add_rtn_u32 v14, v2, v3
    s_waitcnt lgkmcnt(0)
    v_readfirstlane_b32 s60, v14
    s_cmp_lg_u32 s60, 3
    s_cbranch_scc1 arr_14
    v_mov_b32 v3, 1
    buffer_atomic_add v3, off, s[24:27], s61 sc0 sc1
    s_waitcnt vmcnt(0)
    v_readfirstlane_b32 s60, v3
    s_cmp_lg_u32 s60, 119
    s_cbranch_scc1 arr_14
    v_mov_b32 v3, 1
    buffer_store_dword v3, off, s[24:27], s61 offset:128 sc1
arr_14:
    s_mov_b64 exec, -1
    v_mov_b32 v2, 163816
    s_mov_b32 s47, 0x80000
lw_15:
    ds_read_b32 v3, v2
    s_sub_u32 s47, s47, 1
    s_cbranch_scc1 lw_15x
    s_waitcnt lgkmcnt(0)
    v_readfirstlane_b32 s60, v3
    s_cmp_ge_u32 s60, 4
    s_cbranch_scc1 lw_15x
    s_sleep 3
    s_branch lw_15
lw_15x:
    s_mul_i32 s67, s45, 15
    s_add_u32 s67, s67, s46
    s_lshl_b32 s67, s67, 2
    s_add_u32 s67, s67, s75
    s_lshr_b32 s51, s20, 7
    s_sub_u32 s51, 3, s51
    s_and_b32 s51, s51, 7
    s_lshl_b32 s51, 0x1010101, s51
    s_not_b32 s60, s51
    v_lshlrev_b32 v4, 7, v1
    s_add_u32 s50, s67, 896
    s_mov_b32 exec_lo, s60
    s_mov_b32 exec_hi, s60
pf_16:
    s_cmp_ge_u32 s50, 1792
    s_cbranch_scc1 pfd_19
    s_cmp_ge_u32 s50, 896
    s_cbranch_scc1 pfw_17
    s_mul_i32 s51, s50, 1171
    s_lshr_b32 s51, s51, 16
    s_mul_i32 s52, s51, 56
    s_sub_u32 s52, s50, s52
    s_mul_i32 s53, s52, 37
    s_lshr_b32 s53, s53, 9
    s_mul_i32 s54, s53, 14
    s_sub_u32 s52, s52, s54
    s_lshl_b32 s53, s53, 4
    s_add_u32 s51, s51, s53
    s_mul_i32 s51, s51, 110592
    s_lshl_b32 s52, s52, 13
    s_add_u32 s51, s51, s52
    buffer_load_dword v255, v4, s[16:19], s51 offen
    s_branch pfn_18
pfw_17:
    s_sub_u32 s51, s50, 896
    s_lshr_b32 s52, s51, 6
    s_bfe_u32 s53, s51, 0x20004
    s_and_b32 s51, s51, 15
    s_mul_i32 s54, s53, 14
    s_cmp_eq_u32 s53, 3
    s_cselect_b32 s54, 41, s54
    s_add_u32 s52, s52, s54
    s_lshl_b32 s52, s52, 4
    s_add_u32 s51, s51, s52
    s_lshl_b32 s51, s51, 13
    buffer_load_dword v255, v4, s[20:23], s51 offen
pfn_18:
    s_add_u32 s50, s50, 480
    s_branch pf_16
pfd_19:
    s_mov_b64 exec, -1
    s_mov_b32 s61, 163776
    s_branch L_m2
L_b:
    s_and_b32 s75, s44, 3
    s_lshr_b32 s64, s44, 2
    s_cmp_eq_u32 s46, 31
    s_cbranch_scc1 L_b_noln
    s_lshr_b32 s63, s45, 1
    s_lshl_b32 s63, s63, 5
    s_and_b32 s51, s45, 1
    s_lshl_b32 s51, s51, 4
    s_add_u32 s63, s63, s51
    s_add_u32 s63, s63, s46
    s_sub_u32 s63, s63, 15
    s_lshl_b32 s50, s63, 1
    s_add_u32 s50, s50, s64
    s_lshr_b32 s51, s50, 2
    s_and_b32 s52, s50, 3
    s_lshl_b32 s53, s51, 5
    s_lshl_b32 s54, s52, 2
    s_add_u32 s53, s53, s54
    s_lshr_b32 s54, s75, 1
    s_lshl_b32 s54, s54, 4
    s_add_u32 s53, s53, s54
    s_and_b32 s54, s75, 1
    s_lshl_b32 s54, s54, 1
    s_add_u32 s53, s53, s54
    v_lshrrev_b32 v2, 5, v1
    v_and_b32 v3, 31, v1
    v_mul_u32_u24 v4, 1280, v2
    v_lshl_add_u32 v5, v3, 3, v4
    v_lshl_add_u32 v4, v3, 4, v4
    s_mul_i32 s54, s53, 1280
    buffer_load_dwordx4 v[16:19], v4, s[4:7], s54 offen
    buffer_load_dwordx4 v[20:23], v4, s[4:7], s54 offen offset:512
    buffer_load_dwordx2 v[24:25], v5, s[4:7], s54 offen offset:1024
    s_lshl_b32 s62, s51, 14
    s_lshl_b32 s52, s52, 8
    s_add_u32 s62, s62, s52
    s_add_u32 s62, s62, 131584
    s_mul_i32 s64, s64, 10752
    s_mul_i32 s57, s45, 17
    s_add_u32 s57, s57, s46
    s_sub_u32 s57, s57, 15
    s_mul_i32 s80, s57, 205
    s_lshr_b32 s80, s80, 10
    s_mul_i32 s58, s80, 5
    s_sub_u32 s79, s57, s58
    s_and_b32 s56, s45, 1
    s_lshl_b32 s56, s56, 2
    s_lshr_b32 s58, s45, 1
    s_and_b32 s57, s46, 3
    s_add_u32 s82, s56, s57
    s_lshl_b32 s58, s58, 3
    s_lshr_b32 s57, s46, 2
    s_xor_b32 s57, s57, 0
    s_add_u32 s83, s58, s57
    v_lshrrev_b32 v2, 4, v1
    v_and_b32 v3, 15, v1
    v_lshrrev_b32 v4, 2, v3
    v_mul_u32_u24 v4, 1344, v4
    v_lshl_add_u32 v4, v2, 5, v4
    v_and_b32 v5, 3, v3
    v_lshl_add_u32 v4, v5, 3, v4
    s_lshl_b32 s54, s75, 7
    s_add_u32 s54, s54, s64
    v_add_u32 v214, s54, v4
    s_cmp_eq_u32 s52, 768
    s_cselect_b32 s54, 128, 0
    v_lshrrev_b32 v7, 3, v3
    v_mul_u32_u24 v7, s54, v7
    v_lshl_add_u32 v7, v3, 4, v7
    s_lshl_b32 s54, s75, 2
    s_add_u32 s54, s54, 0
    v_add_u32 v5, s54, v2
    v_lshrrev_b32 v6, 3, v5
    v_lshlrev_b32 v6, 20, v6
    v_and_b32 v5, 7, v5
    v_lshl_add_u32 v6, v5, 11, v6
    v_add_u32 v215, v7, v6
    s_lshl_b32 s54, s75, 2
    s_add_u32 s54, s54, 16
    v_add_u32 v5, s54, v2
    v_lshrrev_b32 v6, 3, v5
    v_lshlrev_b32 v6, 20, v6
    v_and_b32 v5, 7, v5
    v_lshl_add_u32 v6, v5, 11, v6
    v_add_u32 v216, v7, v6
    s_lshl_b32 s54, s75, 2
    s_add_u32 s54, s54, 32
    v_add_u32 v5, s54, v2
    v_lshrrev_b32 v6, 3, v5
    v_lshlrev_b32 v6, 20, v6
    v_and_b32 v5, 7, v5
    v_lshl_add_u32 v6, v5, 11, v6
    v_add_u32 v217, v7, v6
    s_cmp_lg_u32 s44, 0
    s_cbranch_scc1 ic_20
    v_lshlrev_b32 v6, 2, v1
    v_add_u32 v6, 163584, v6
    v_mov_b32 v7, 0
    ds_write_b32 v6, v7
ic_20:
    v_lshrrev_b32 v2, 5, v1
    v_and_b32 v3, 31, v1
    s_waitcnt vmcnt(0)
    v_lshlrev_b32 v28, 16, v16
    v_and_b32 v29, 0xffff0000, v16
    v_lshlrev_b32 v30, 16, v17
    v_and_b32 v31, 0xffff0000, v17
    v_lshlrev_b32 v32, 16, v18
    v_and_b32 v33, 0xffff0000, v18
    v_lshlrev_b32 v34, 16, v19
    v_and_b32 v35, 0xffff0000, v19
    v_lshlrev_b32 v36, 16, v20
    v_and_b32 v37, 0xffff0000, v20
    v_lshlrev_b32 v38, 16, v21
    v_and_b32 v39, 0xffff0000, v21
    v_lshlrev_b32 v40, 16, v22
    v_and_b32 v41, 0xffff0000, v22
    v_lshlrev_b32 v42, 16, v23
    v_and_b32 v43, 0xffff0000, v23
    v_lshlrev_b32 v44, 16, v24
    v_and_b32 v45, 0xffff0000, v24
    v_lshlrev_b32 v46, 16, v25
    v_and_b32 v47, 0xffff0000, v25
    v_pk_add_f32 v[6:7], v[28:29], v[30:31]
    v_pk_add_f32 v[6:7], v[6:7], v[32:33]
    v_pk_add_f32 v[6:7], v[6:7], v[34:35]
    v_pk_add_f32 v[6:7], v[6:7], v[36:37]
    v_pk_add_f32 v[6:7], v[6:7], v[38:39]
    v_pk_add_f32 v[6:7], v[6:7], v[40:41]
    v_pk_add_f32 v[6:7], v[6:7], v[42:43]
    v_pk_add_f32 v[6:7], v[6:7], v[44:45]
    v_pk_add_f32 v[6:7], v[6:7], v[46:47]
    v_add_f32 v6, v6, v7
    s_nop 1
    v_add_f32_dpp v6, v6, v6 row_ror:8 row_mask:0xf bank_mask:0xf
    s_nop 1
    v_add_f32_dpp v6, v6, v6 row_ror:4 row_mask:0xf bank_mask:0xf
    s_nop 1
    v_add_f32_dpp v6, v6, v6 row_ror:2 row_mask:0xf bank_mask:0xf
    s_nop 1
    v_add_f32_dpp v6, v6, v6 row_ror:1 row_mask:0xf bank_mask:0xf
    v_mov_b32 v7, v6
    s_nop 1
    v_permlane16_swap_b32 v6, v7
    v_add_f32 v6, v6, v7
    v_mul_f32 v6, 0x3acccccd, v6
    v_pk_add_f32 v[28:29], v[28:29], v[6:7] op_sel_hi:[1,0] neg_lo:[0,1] neg_hi:[0,1]
    v_pk_add_f32 v[30:31], v[30:31], v[6:7] op_sel_hi:[1,0] neg_lo:[0,1] neg_hi:[0,1]
    v_pk_add_f32 v[32:33], v[32:33], v[6:7] op_sel_hi:[1,0] neg_lo:[0,1] neg_hi:[0,1]
    v_pk_add_f32 v[34:35], v[34:35], v[6:7] op_sel_hi:[1,0] neg_lo:[0,1] neg_hi:[0,1]
    v_pk_add_f32 v[36:37], v[36:37], v[6:7] op_sel_hi:[1,0] neg_lo:[0,1] neg_hi:[0,1]
    v_pk_add_f32 v[38:39], v[38:39], v[6:7] op_sel_hi:[1,0] neg_lo:[0,1] neg_hi:[0,1]
    v_pk_add_f32 v[40:41], v[40:41], v[6:7] op_sel_hi:[1,0] neg_lo:[0,1] neg_hi:[0,1]
    v_pk_add_f32 v[42:43], v[42:43], v[6:7] op_sel_hi:[1,0] neg_lo:[0,1] neg_hi:[0,1]
    v_pk_add_f32 v[44:45], v[44:45], v[6:7] op_sel_hi:[1,0] neg_lo:[0,1] neg_hi:[0,1]
    v_pk_add_f32 v[46:47], v[46:47], v[6:7] op_sel_hi:[1,0] neg_lo:[0,1] neg_hi:[0,1]
    v_pk_mul_f32 v[8:9], v[28:29], v[28:29]
    v_pk_fma_f32 v[8:9], v[30:31], v[30:31], v[8:9]
    v_pk_fma_f32 v[8:9], v[32:33], v[32:33], v[8:9]
    v_pk_fma_f32 v[8:9], v[34:35], v[34:35], v[8:9]
    v_pk_fma_f32 v[8:9], v[36:37], v[36:37], v[8:9]
    v_pk_fma_f32 v[8:9], v[38:39], v[38:39], v[8:9]
    v_pk_fma_f32 v[8:9], v[40:41], v[40:41], v[8:9]
    v_pk_fma_f32 v[8:9], v[42:43], v[42:43], v[8:9]
    v_pk_fma_f32 v[8:9], v[44:45], v[44:45], v[8:9]
    v_pk_fma_f32 v[8:9], v[46:47], v[46:47], v[8:9]
    v_add_f32 v8, v8, v9
    s_nop 1
    v_add_f32_dpp v8, v8, v8 row_ror:8 row_mask:0xf bank_mask:0xf
    s_nop 1
    v_add_f32_dpp v8, v8, v8 row_ror:4 row_mask:0xf bank_mask:0xf
    s_nop 1
    v_add_f32_dpp v8, v8, v8 row_ror:2 row_mask:0xf bank_mask:0xf
    s_nop 1
    v_add_f32_dpp v8, v8, v8 row_ror:1 row_mask:0xf bank_mask:0xf
    v_mov_b32 v9, v8
    s_nop 1
    v_permlane16_swap_b32 v8, v9
    v_add_f32 v8, v8, v9
    v_mul_f32 v8, 0x3acccccd, v8
    v_add_f32 v9, 0x3727c5ac, v8
    v_rsq_f32 v9, v9
    v_mov_b32 v11, 0x3727c5ac
    v_mul_f32 v10, v9, v9
    v_fma_f32 v10, v10, v8, v11
    v_rsq_f32 v10, v10
    v_mul_f32 v11, v9, v6
    v_mul_f32 v10, v10, v9
    s_lshl_b32 s54, s53, 2
    v_lshlrev_b32 v12, 2, v2
    v_cmp_eq_u32 vcc, 0, v3
    v_mov_b32 v13, 0x7fff0000
    s_nop 0
    v_cndmask_b32 v12, v13, v12, vcc
    buffer_store_dword v9, v12, s[24:27], s54 offen sc1
    s_add_u32 s54, s54, 8192
    buffer_store_dword v11, v12, s[24:27], s54 offen sc1
    v_pk_mul_f32 v[28:29], v[28:29], v[10:11] op_sel_hi:[1,0]
    v_pk_mul_f32 v[30:31], v[30:31], v[10:11] op_sel_hi:[1,0]
    v_pk_mul_f32 v[32:33], v[32:33], v[10:11] op_sel_hi:[1,0]
    v_pk_mul_f32 v[34:35], v[34:35], v[10:11] op_sel_hi:[1,0]
    v_pk_mul_f32 v[36:37], v[36:37], v[10:11] op_sel_hi:[1,0]
    v_pk_mul_f32 v[38:39], v[38:39], v[10:11] op_sel_hi:[1,0]
    v_pk_mul_f32 v[40:41], v[40:41], v[10:11] op_sel_hi:[1,0]
    v_pk_mul_f32 v[42:43], v[42:43], v[10:11] op_sel_hi:[1,0]
    v_pk_mul_f32 v[44:45], v[44:45], v[10:11] op_sel_hi:[1,0]
    v_pk_mul_f32 v[46:47], v[46:47], v[10:11] op_sel_hi:[1,0]
    v_cvt_pk_bf16_f32 v16, v28, v29
    v_cvt_pk_bf16_f32 v17, v30, v31
    v_cvt_pk_bf16_f32 v18, v32, v33
    v_cvt_pk_bf16_f32 v19, v34, v35
    v_cvt_pk_bf16_f32 v20, v36, v37
    v_cvt_pk_bf16_f32 v21, v38, v39
    v_cvt_pk_bf16_f32 v22, v40, v41
    v_cvt_pk_bf16_f32 v23, v42, v43
    v_cvt_pk_bf16_f32 v24, v44, v45
    v_cvt_pk_bf16_f32 v25, v46, v47
    s_mul_i32 s54, s75, 2688
    s_add_u32 s54, s54, s64
    v_mul_u32_u24 v4, 1344, v2
    v_add_u32 v4, s54, v4
    v_lshl_add_u32 v5, v3, 3, v4
    v_lshl_add_u32 v4, v3, 4, v4
    ds_write_b128 v4, v[16:19]
    ds_write_b128 v4, v[20:23] offset:512
    ds_write_b64 v5, v[24:25] offset:1024
    s_cmp_lg_u32 s44, 3
    s_cbranch_scc1 zz_21
    s_cmp_ge_u32 s63, 37
    s_cbranch_scc1 zz_21
    s_lshl_b32 s56, s63, 8
    s_add_u32 s56, s56, 32768
    v_lshlrev_b32 v6, 7, v1
    v_mov_b32 v7, 0
    s_mov_b64 exec, 3
    buffer_store_dword v7, v6, s[24:27], s56 offen sc1
    s_mov_b64 exec, -1
zz_21:
    s_waitcnt lgkmcnt(0)
    s_barrier
    ds_read_b64_tr_b16 v[16:17], v214 offset:0
    ds_read_b64_tr_b16 v[18:19], v214 offset:5376
    ds_read_b64_tr_b16 v[20:21], v214 offset:512
    ds_read_b64_tr_b16 v[22:23], v214 offset:5888
    ds_read_b64_tr_b16 v[24:25], v214 offset:1024
    ds_read_b64_tr_b16 v[26:27], v214 offset:6400
    s_waitcnt lgkmcnt(4)
    buffer_store_dwordx4 v[16:19], v215, s[24:27], s62 offen sc1
    s_waitcnt lgkmcnt(2)
    buffer_store_dwordx4 v[20:23], v216, s[24:27], s62 offen sc1
    s_cmp_ge_u32 s75, 2
    s_cbranch_scc1 tg_22
    s_waitcnt lgkmcnt(0)
    buffer_store_dwordx4 v[24:27], v217, s[24:27], s62 offen sc1
tg_22:
    s_waitcnt vmcnt(0) lgkmcnt(0)
    s_barrier
    s_cmp_lg_u32 s44, 0
    s_cbranch_scc1 L_b_pf
    s_and_b32 s57, s63, 1
    s_lshl_b32 s56, s57, 6
    s_lshl_b32 s57, s57, 2
    s_mov_b64 exec, 1
    s_setprio 3
    v_mov_b32 v15, 1
    buffer_atomic_add v15, off, s[40:43], s56 sc0 sc1
    s_waitcnt vmcnt(0)
    v_readfirstlane_b32 s60, v15
    s_cmp_lg_u32 s60, 63
    s_cbranch_scc1 c1a_23
    v_mov_b32 v15, 1
    buffer_store_dword v15, off, s[40:43], s57 offset:128 sc1
c1a_23:
    s_mov_b64 exec, -1
    s_setprio 0
    v_mov_b32 v2, 163712
    v_mov_b32 v3, 1
    ds_write_b32 v2, v3
    s_branch L_b_pf
L_b_noln:
    s_mul_i32 s57, s45, 17
    s_add_u32 s57, s57, s46
    s_sub_u32 s57, s57, 15
    s_mul_i32 s80, s57, 205
    s_lshr_b32 s80, s80, 10
    s_mul_i32 s58, s80, 5
    s_sub_u32 s79, s57, s58
    s_and_b32 s56, s45, 1
    s_lshl_b32 s56, s56, 2
    s_lshr_b32 s58, s45, 1
    s_and_b32 s57, s46, 3
    s_add_u32 s82, s56, s57
    s_lshl_b32 s58, s58, 3
    s_lshr_b32 s57, s46, 2
    s_xor_b32 s57, s57, 0
    s_add_u32 s83, s58, s57
    s_cmp_lg_u32 s44, 0
    s_cbranch_scc1 ic_24
    v_lshlrev_b32 v6, 2, v1
    v_add_u32 v6, 163584, v6
    v_mov_b32 v7, 0
    ds_write_b32 v6, v7
ic_24:
    s_waitcnt lgkmcnt(0)
    s_barrier
    v_mov_b32 v2, 163712
    v_mov_b32 v3, 1
    ds_write_b32 v2, v3
L_b_pf:
    s_cmp_lt_u32 s80, 27
    s_cselect_b32 s81, 1, 0
    s_cmp_ge_u32 s44, 4
    s_cbranch_scc1 L_b_hi
    v_mov_b32 v2, 163712
    s_mov_b32 s47, 0x80000
lw_25:
    ds_read_b32 v3, v2
    s_sub_u32 s47, s47, 1
    s_cbranch_scc1 lw_25x
    s_waitcnt lgkmcnt(0)
    v_readfirstlane_b32 s60, v3
    s_cmp_ge_u32 s60, 1
    s_cbranch_scc1 lw_25x
    s_sleep 1
    s_branch lw_25
lw_25x:
    s_sub_u32 s62, s46, 15
    s_lshl_b32 s62, s62, 3
    s_add_u32 s62, s62, s45
    s_mul_i32 s61, s44, 136
    s_add_u32 s61, s61, s62
    v_lshlrev_b32 v4, 7, v1
    s_add_u32 s50, s61, 0
pf_26:
    s_cmp_ge_u32 s50, 896
    s_cbranch_scc1 pfd_29
    s_cmp_ge_u32 s50, 896
    s_cbranch_scc1 pfw_27
    s_mul_i32 s51, s50, 1171
    s_lshr_b32 s51, s51, 16
    s_mul_i32 s52, s51, 56
    s_sub_u32 s52, s50, s52
    s_mul_i32 s53, s52, 37
    s_lshr_b32 s53, s53, 9
    s_mul_i32 s54, s53, 14
    s_sub_u32 s52, s52, s54
    s_lshl_b32 s53, s53, 4
    s_add_u32 s51, s51, s53
    s_mul_i32 s51, s51, 110592
    s_lshl_b32 s52, s52, 13
    s_add_u32 s51, s51, s52
    buffer_load_dword v255, v4, s[16:19], s51 offen
    s_branch pfn_28
pfw_27:
    s_sub_u32 s51, s50, 896
    s_lshr_b32 s52, s51, 6
    s_bfe_u32 s53, s51, 0x20004
    s_and_b32 s51, s51, 15
    s_mul_i32 s54, s53, 14
    s_cmp_eq_u32 s53, 3
    s_cselect_b32 s54, 41, s54
    s_add_u32 s52, s52, s54
    s_lshl_b32 s52, s52, 4
    s_add_u32 s51, s51, s52
    s_lshl_b32 s51, s51, 13
    buffer_load_dword v255, v4, s[20:23], s51 offen
pfn_28:
    s_add_u32 s50, s50, 544
    s_branch pf_26
pfd_29:
    s_waitcnt vmcnt(0)
    s_setprio 3
    s_branch L_attn
L_b_hi:
    s_cmp_eq_u32 s81, 0
    s_cbranch_scc1 L_b_c1
    v_lshrrev_b32 v2, 4, v1
    v_lshlrev_b32 v12, 3, v2
    s_lshl_b32 s65, s80, 7
    s_cmp_lg_u32 s75, 0
    s_cbranch_scc1 L_nobias
    buffer_load_dwordx2 v[160:161], v12, s[32:35], s65 offen offset:0
    buffer_load_dwordx2 v[162:163], v12, s[32:35], s65 offen offset:32
    buffer_load_dwordx2 v[164:165], v12, s[32:35], s65 offen offset:64
    buffer_load_dwordx2 v[166:167], v12, s[32:35], s65 offen offset:96
L_nobias:
    s_mul_i32 s66, s75, 24576
    s_add_u32 s66, s66, 49152
    s_and_b32 s67, s75, 2
    s_mov_b32 s52, s16
    s_mov_b32 s53, s17
    s_mov_b32 s54, s18
    s_mov_b32 s55, 0x20000
    s_mov_b32 s57, 26624
    s_mov_b32 s58, 30720
    s_mov_b32 s61, s66
    v_lshrrev_b32 v2, 3, v1
    v_mul_u32_u24 v2, 3456, v2
    v_bfe_u32 v3, v1, 1, 2
    v_lshrrev_b32 v10, 4, v1
    v_xor_b32 v3, v3, v10
    v_lshl_add_u32 v2, v3, 5, v2
    v_and_b32 v3, 1, v1
    v_lshl_add_u32 v8, v3, 4, v2
    v_lshlrev_b32 v9, 4, v1
    v_lshrrev_b32 v2, 2, v1
    v_lshlrev_b32 v2, 7, v2
    v_and_b32 v3, 3, v1
    v_lshl_add_u32 v2, v3, 3, v2
    v_add_u32 v2, s66, v2
    v_bfe_u32 v3, v1, 3, 2
    v_xor_b32 v3, s67, v3
    v_xor_b32 v10, 0, v3
    v_lshl_add_u32 v4, v10, 5, v2
    v_xor_b32 v10, 1, v3
    v_lshl_add_u32 v5, v10, 5, v2
    v_xor_b32 v10, 2, v3
    v_lshl_add_u32 v6, v10, 5, v2
    v_xor_b32 v10, 3, v3
    v_lshl_add_u32 v7, v10, 5, v2
    s_mul_i32 s56, s75, 1769472
    s_lshl_b32 s65, s80, 7
    s_add_u32 s56, s56, s65
    v_lshlrev_b32 v11, 4, v1
    v_cmp_le_u32 vcc, 56, v1
    v_add_u32 v11, 512, v11
    v_add_u32 v2, 128, v11
    v_cndmask_b32 v11, v11, v2, vcc
    s_lshl_b32 s59, s79, 20
    s_lshl_b32 s65, s75, 18
    s_add_u32 s59, s59, s65
    s_and_b32 s65, s75, 1
    s_lshl_b32 s68, s65, 13
    s_add_u32 s59, s59, s68
    s_add_u32 s59, s59, 131072
    s_cmp_eq_u32 s65, 1
    s_movk_i32 s68, 0x1000
    s_cselect_b32 s70, -12288, s68
    s_cselect_b32 s71, 20480, s68
    s_cmp_lg_u32 s75, 0
    s_cbranch_scc1 bz_30
    s_waitcnt vmcnt(0)
    v_lshlrev_b32 v16, 16, v160
    v_and_b32 v17, 0xffff0000, v160
    v_lshlrev_b32 v18, 16, v161
    v_and_b32 v19, 0xffff0000, v161
    v_mov_b32 v20, v16
    v_mov_b32 v21, v17
    v_mov_b32 v22, v18
    v_mov_b32 v23, v19
    v_mov_b32 v24, v16
    v_mov_b32 v25, v17
    v_mov_b32 v26, v18
    v_mov_b32 v27, v19
    v_mov_b32 v28, v16
    v_mov_b32 v29, v17
    v_mov_b32 v30, v18
    v_mov_b32 v31, v19
    v_mov_b32 v32, v16
    v_mov_b32 v33, v17
    v_mov_b32 v34, v18
    v_mov_b32 v35, v19
    v_mov_b32 v36, v16
    v_mov_b32 v37, v17
    v_mov_b32 v38, v18
    v_mov_b32 v39, v19
    v_mov_b32 v40, v16
    v_mov_b32 v41, v17
    v_mov_b32 v42, v18
    v_mov_b32 v43, v19
    v_mov_b32 v44, v16
    v_mov_b32 v45, v17
    v_mov_b32 v46, v18
    v_mov_b32 v47, v19
    v_lshlrev_b32 v48, 16, v162
    v_and_b32 v49, 0xffff0000, v162
    v_lshlrev_b32 v50, 16, v163
    v_and_b32 v51, 0xffff0000, v163
    v_mov_b32 v52, v48
    v_mov_b32 v53, v49
    v_mov_b32 v54, v50
    v_mov_b32 v55, v51
    v_mov_b32 v56, v48
    v_mov_b32 v57, v49
    v_mov_b32 v58, v50
    v_mov_b32 v59, v51
    v_mov_b32 v60, v48
    v_mov_b32 v61, v49
    v_mov_b32 v62, v50
    v_mov_b32 v63, v51
    v_mov_b32 v64, v48
    v_mov_b32 v65, v49
    v_mov_b32 v66, v50
    v_mov_b32 v67, v51
    v_mov_b32 v68, v48
    v_mov_b32 v69, v49
    v_mov_b32 v70, v50
    v_mov_b32 v71, v51
    v_mov_b32 v72, v48
    v_mov_b32 v73, v49
    v_mov_b32 v74, v50
    v_mov_b32 v75, v51
    v_mov_b32 v76, v48
    v_mov_b32 v77, v49
    v_mov_b32 v78, v50
    v_mov_b32 v79, v51
    v_lshlrev_b32 v80, 16, v164
    v_and_b32 v81, 0xffff0000, v164
    v_lshlrev_b32 v82, 16, v165
    v_and_b32 v83, 0xffff0000, v165
    v_mov_b32 v84, v80
    v_mov_b32 v85, v81
    v_mov_b32 v86, v82
    v_mov_b32 v87, v83
    v_mov_b32 v88, v80
    v_mov_b32 v89, v81
    v_mov_b32 v90, v82
    v_mov_b32 v91, v83
    v_mov_b32 v92, v80
    v_mov_b32 v93, v81
    v_mov_b32 v94, v82
    v_mov_b32 v95, v83
    v_mov_b32 v96, v80
    v_mov_b32 v97, v81
    v_mov_b32 v98, v82
    v_mov_b32 v99, v83
    v_mov_b32 v100, v80
    v_mov_b32 v101, v81
    v_mov_b32 v102, v82
    v_mov_b32 v103, v83
    v_mov_b32 v104, v80
    v_mov_b32 v105, v81
    v_mov_b32 v106, v82
    v_mov_b32 v107, v83
    v_mov_b32 v108, v80
    v_mov_b32 v109, v81
    v_mov_b32 v110, v82
    v_mov_b32 v111, v83
    v_lshlrev_b32 v112, 16, v166
    v_and_b32 v113, 0xffff0000, v166
    v_lshlrev_b32 v114, 16, v167
    v_and_b32 v115, 0xffff0000, v167
    v_mov_b32 v116, v112
    v_mov_b32 v117, v113
    v_mov_b32 v118, v114
    v_mov_b32 v119, v115
    v_mov_b32 v120, v112
    v_mov_b32 v121, v113
    v_mov_b32 v122, v114
    v_mov_b32 v123, v115
    v_mov_b32 v124, v112
    v_mov_b32 v125, v113
    v_mov_b32 v126, v114
    v_mov_b32 v127, v115
    v_mov_b32 v128, v112
    v_mov_b32 v129, v113
    v_mov_b32 v130, v114
    v_mov_b32 v131, v115
    v_mov_b32 v132, v112
    v_mov_b32 v133, v113
    v_mov_b32 v134, v114
    v_mov_b32 v135, v115
    v_mov_b32 v136, v112
    v_mov_b32 v137, v113
    v_mov_b32 v138, v114
    v_mov_b32 v139, v115
    v_mov_b32 v140, v112
    v_mov_b32 v141, v113
    v_mov_b32 v142, v114
    v_mov_b32 v143, v115
    s_branch bd_31
bz_30:
    v_mov_b32 v16, 0
    v_mov_b32 v17, 0
    v_mov_b32 v18, 0
    v_mov_b32 v19, 0
    v_mov_b32 v20, 0
    v_mov_b32 v21, 0
    v_mov_b32 v22, 0
    v_mov_b32 v23, 0
    v_mov_b32 v24, 0
    v_mov_b32 v25, 0
    v_mov_b32 v26, 0
    v_mov_b32 v27, 0
    v_mov_b32 v28, 0
    v_mov_b32 v29, 0
    v_mov_b32 v30, 0
    v_mov_b32 v31, 0
    v_mov_b32 v32, 0
    v_mov_b32 v33, 0
    v_mov_b32 v34, 0
    v_mov_b32 v35, 0
    v_mov_b32 v36, 0
    v_mov_b32 v37, 0
    v_mov_b32 v38, 0
    v_mov_b32 v39, 0
    v_mov_b32 v40, 0
    v_mov_b32 v41, 0
    v_mov_b32 v42, 0
    v_mov_b32 v43, 0
    v_mov_b32 v44, 0
    v_mov_b32 v45, 0
    v_mov_b32 v46, 0
    v_mov_b32 v47, 0
    v_mov_b32 v48, 0
    v_mov_b32 v49, 0
    v_mov_b32 v50, 0
    v_mov_b32 v51, 0
    v_mov_b32 v52, 0
    v_mov_b32 v53, 0
    v_mov_b32 v54, 0
    v_mov_b32 v55, 0
    v_mov_b32 v56, 0
    v_mov_b32 v57, 0
    v_mov_b32 v58, 0
    v_mov_b32 v59, 0
    v_mov_b32 v60, 0
    v_mov_b32 v61, 0
    v_mov_b32 v62, 0
    v_mov_b32 v63, 0
    v_mov_b32 v64, 0
    v_mov_b32 v65, 0
    v_mov_b32 v66, 0
    v_mov_b32 v67, 0
    v_mov_b32 v68, 0
    v_mov_b32 v69, 0
    v_mov_b32 v70, 0
    v_mov_b32 v71, 0
    v_mov_b32 v72, 0
    v_mov_b32 v73, 0
    v_mov_b32 v74, 0
    v_mov_b32 v75, 0
    v_mov_b32 v76, 0
    v_mov_b32 v77, 0
    v_mov_b32 v78, 0
    v_mov_b32 v79, 0
    v_mov_b32 v80, 0
    v_mov_b32 v81, 0
    v_mov_b32 v82, 0
    v_mov_b32 v83, 0
    v_mov_b32 v84, 0
    v_mov_b32 v85, 0
    v_mov_b32 v86, 0
    v_mov_b32 v87, 0
    v_mov_b32 v88, 0
    v_mov_b32 v89, 0
    v_mov_b32 v90, 0
    v_mov_b32 v91, 0
    v_mov_b32 v92, 0
    v_mov_b32 v93, 0
    v_mov_b32 v94, 0
    v_mov_b32 v95, 0
    v_mov_b32 v96, 0
    v_mov_b32 v97, 0
    v_mov_b32 v98, 0
    v_mov_b32 v99, 0
    v_mov_b32 v100, 0
    v_mov_b32 v101, 0
    v_mov_b32 v102, 0
    v_mov_b32 v103, 0
    v_mov_b32 v104, 0
    v_mov_b32 v105, 0
    v_mov_b32 v106, 0
    v_mov_b32 v107, 0
    v_mov_b32 v108, 0
    v_mov_b32 v109, 0
    v_mov_b32 v110, 0
    v_mov_b32 v111, 0
    v_mov_b32 v112, 0
    v_mov_b32 v113, 0
    v_mov_b32 v114, 0
    v_mov_b32 v115, 0
    v_mov_b32 v116, 0
    v_mov_b32 v117, 0
    v_mov_b32 v118, 0
    v_mov_b32 v119, 0
    v_mov_b32 v120, 0
    v_mov_b32 v121, 0
    v_mov_b32 v122, 0
    v_mov_b32 v123, 0
    v_mov_b32 v124, 0
    v_mov_b32 v125, 0
    v_mov_b32 v126, 0
    v_mov_b32 v127, 0
    v_mov_b32 v128, 0
    v_mov_b32 v129, 0
    v_mov_b32 v130, 0
    v_mov_b32 v131, 0
    v_mov_b32 v132, 0
    v_mov_b32 v133, 0
    v_mov_b32 v134, 0
    v_mov_b32 v135, 0
    v_mov_b32 v136, 0
    v_mov_b32 v137, 0
    v_mov_b32 v138, 0
    v_mov_b32 v139, 0
    v_mov_b32 v140, 0
    v_mov_b32 v141, 0
    v_mov_b32 v142, 0
    v_mov_b32 v143, 0
bd_31:
    v_mov_b32 v2, 163712
    s_mov_b32 s47, 0x80000
lw_32:
    ds_read_b32 v3, v2
    s_sub_u32 s47, s47, 1
    s_cbranch_scc1 lw_32x
    s_waitcnt lgkmcnt(0)
    v_readfirstlane_b32 s60, v3
    s_cmp_ge_u32 s60, 1
    s_cbranch_scc1 lw_32x
    s_sleep 1
    s_branch lw_32
lw_32x:
    s_add_u32 m0, s61, 8192
    s_nop 0
    buffer_load_dwordx4 v8, s[52:55], s56 offen  lds
    s_add_u32 s56, s56, s57
    buffer_load_dwordx4 v8, s[52:55], s56 offen offset:1024  lds
    s_add_u32 s56, s56, s57
    buffer_load_dwordx4 v8, s[52:55], s56 offen offset:2048  lds
    s_add_u32 s56, s56, s57
    buffer_load_dwordx4 v8, s[52:55], s56 offen offset:3072  lds
    s_add_u32 s56, s56, s58
    s_add_u32 m0, s61, 0
    s_nop 0
    buffer_load_dwordx4 v8, s[52:55], s56 offen  lds
    s_add_u32 s56, s56, s57
    buffer_load_dwordx4 v8, s[52:55], s56 offen offset:1024  lds
    s_add_u32 s56, s56, s57
    buffer_load_dwordx4 v8, s[52:55], s56 offen offset:2048  lds
    s_add_u32 s56, s56, s57
    buffer_load_dwordx4 v8, s[52:55], s56 offen offset:3072  lds
    s_add_u32 s56, s56, s58
    s_add_u32 m0, s61, 4096
    s_nop 0
    buffer_load_dwordx4 v8, s[52:55], s56 offen  lds
    s_add_u32 s56, s56, s57
    buffer_load_dwordx4 v8, s[52:55], s56 offen offset:1024  lds
    s_add_u32 s56, s56, s57
    buffer_load_dwordx4 v8, s[52:55], s56 offen offset:2048  lds
    s_add_u32 s56, s56, s57
    buffer_load_dwordx4 v8, s[52:55], s56 offen offset:3072  lds
    s_add_u32 s56, s56, s58
L_b_c1:
    s_cmp_lg_u32 s75, 0
    s_cbranch_scc1 cw_33
    v_lshlrev_b32 v2, 2, v1
    v_add_u32 v2, 128, v2
    s_mov_b64 exec, 3
    s_mov_b32 s47, 0x8000
gp_35:
    buffer_load_dword v3, v2, s[40:43], 0 offen sc1
    s_sub_u32 s47, s47, 1
    s_cbranch_scc1 gp_35x
    s_waitcnt vmcnt(0)
    v_cmp_ne_u32 vcc, 1, v3
    s_cbranch_vccz gp_35x
    s_sleep 2
    s_branch gp_35
gp_35x:
    s_mov_b64 exec, -1
    v_mov_b32 v2, 163776
    v_mov_b32 v3, 4
    ds_write_b32 v2, v3
    s_branch cg_34
cw_33:
    v_mov_b32 v2, 163776
    s_mov_b32 s47, 0x80000
lw_36:
    ds_read_b32 v3, v2
    s_sub_u32 s47, s47, 1
    s_cbranch_scc1 lw_36x
    s_waitcnt lgkmcnt(0)
    v_readfirstlane_b32 s60, v3
    s_cmp_ge_u32 s60, 4
    s_cbranch_scc1 lw_36x
    s_sleep 1
    s_branch lw_36
lw_36x:
cg_34:
    s_cmp_eq_u32 s81, 0
    s_cselect_b32 s61, 163776, s61
    s_cbranch_scc1 L_m2
    s_setprio 3
    buffer_load_dwordx4 v[224:227], v11, s[24:27], s59 offen offset:0 sc1
    buffer_load_dwordx4 v[228:231], v11, s[24:27], s59 offen offset:2048 sc1
    s_add_u32 s59, s59, 4096
    buffer_load_dwordx4 v[232:235], v11, s[24:27], s59 offen offset:0 sc1
    buffer_load_dwordx4 v[236:239], v11, s[24:27], s59 offen offset:2048 sc1
    s_add_u32 s59, s59, s70
    buffer_load_dwordx4 v[240:243], v11, s[24:27], s59 offen offset:0 sc1
    buffer_load_dwordx4 v[244:247], v11, s[24:27], s59 offen offset:2048 sc1
    s_add_u32 s59, s59, 4096
    buffer_load_dwordx4 v[248:251], v11, s[24:27], s59 offen offset:0 sc1
    buffer_load_dwordx4 v[252:255], v11, s[24:27], s59 offen offset:2048 sc1
    s_add_u32 s59, s59, s71
    s_setprio 2
    buffer_load_dwordx4 v[160:163], v11, s[24:27], s59 offen offset:0 sc1
    buffer_load_dwordx4 v[164:167], v11, s[24:27], s59 offen offset:2048 sc1
    s_add_u32 s59, s59, 4096
    buffer_load_dwordx4 v[168:171], v11, s[24:27], s59 offen offset:0 sc1
    buffer_load_dwordx4 v[172:175], v11, s[24:27], s59 offen offset:2048 sc1
    s_add_u32 s59, s59, s70
    buffer_load_dwordx4 v[176:179], v11, s[24:27], s59 offen offset:0 sc1
    buffer_load_dwordx4 v[180:183], v11, s[24:27], s59 offen offset:2048 sc1
    s_add_u32 s59, s59, 4096
    buffer_load_dwordx4 v[184:187], v11, s[24:27], s59 offen offset:0 sc1
    buffer_load_dwordx4 v[188:191], v11, s[24:27], s59 offen offset:2048 sc1
    s_add_u32 s59, s59, s71
    s_setprio 1
    buffer_load_dwordx4 v[192:195], v11, s[24:27], s59 offen offset:0 sc1
    buffer_load_dwordx4 v[196:199], v11, s[24:27], s59 offen offset:2048 sc1
    s_add_u32 s59, s59, 4096
    buffer_load_dwordx4 v[200:203], v11, s[24:27], s59 offen offset:0 sc1
    buffer_load_dwordx4 v[204:207], v11, s[24:27], s59 offen offset:2048 sc1
    s_add_u32 s59, s59, s70
    buffer_load_dwordx4 v[208:211], v11, s[24:27], s59 offen offset:0 sc1
    buffer_load_dwordx4 v[212:215], v11, s[24:27], s59 offen offset:2048 sc1
    s_add_u32 s59, s59, 4096
    buffer_load_dwordx4 v[216:219], v11, s[24:27], s59 offen offset:0 sc1
    buffer_load_dwordx4 v[220:223], v11, s[24:27], s59 offen offset:2048 sc1
    s_add_u32 s59, s59, s71
    s_mov_b32 s62, 5
    s_setprio 3
    s_waitcnt vmcnt(16)
    ds_read_b64_tr_b16 v[144:145], v4 offset:8192
    ds_read_b64_tr_b16 v[146:147], v4 offset:10240
    ds_read_b64_tr_b16 v[148:149], v5 offset:8192
    ds_read_b64_tr_b16 v[150:151], v5 offset:10240
    ds_read_b64_tr_b16 v[152:153], v6 offset:8192
    ds_read_b64_tr_b16 v[154:155], v6 offset:10240
    ds_read_b64_tr_b16 v[156:157], v7 offset:8192
    ds_read_b64_tr_b16 v[158:159], v7 offset:10240
    s_waitcnt lgkmcnt(0)
    s_add_u32 m0, s61, 8192
    s_nop 0
    buffer_load_dwordx4 v8, s[52:55], s56 offen  lds
    s_add_u32 s56, s56, s57
    buffer_load_dwordx4 v8, s[52:55], s56 offen offset:1024  lds
    s_add_u32 s56, s56, s57
    buffer_load_dwordx4 v8, s[52:55], s56 offen offset:2048  lds
    s_add_u32 s56, s56, s57
    buffer_load_dwordx4 v8, s[52:55], s56 offen offset:3072  lds
    s_add_u32 s56, s56, s58
    v_mfma_f32_16x16x32_bf16 v[16:19], v[144:147], v[224:227], v[16:19]
    v_mfma_f32_16x16x32_bf16 v[48:51], v[148:151], v[224:227], v[48:51]
    v_mfma_f32_16x16x32_bf16 v[80:83], v[152:155], v[224:227], v[80:83]
    v_mfma_f32_16x16x32_bf16 v[112:115], v[156:159], v[224:227], v[112:115]
    buffer_load_dwordx4 v[224:227], v11, s[24:27], s59 offen offset:0 sc1
    v_mfma_f32_16x16x32_bf16 v[20:23], v[144:147], v[228:231], v[20:23]
    v_mfma_f32_16x16x32_bf16 v[52:55], v[148:151], v[228:231], v[52:55]
    v_mfma_f32_16x16x32_bf16 v[84:87], v[152:155], v[228:231], v[84:87]
    v_mfma_f32_16x16x32_bf16 v[116:119], v[156:159], v[228:231], v[116:119]
    buffer_load_dwordx4 v[228:231], v11, s[24:27], s59 offen offset:2048 sc1
    s_add_u32 s59, s59, 4096
    v_mfma_f32_16x16x32_bf16 v[24:27], v[144:147], v[232:235], v[24:27]
    v_mfma_f32_16x16x32_bf16 v[56:59], v[148:151], v[232:235], v[56:59]
    v_mfma_f32_16x16x32_bf16 v[88:91], v[152:155], v[232:235], v[88:91]
    v_mfma_f32_16x16x32_bf16 v[120:123], v[156:159], v[232:235], v[120:123]
    buffer_load_dwordx4 v[232:235], v11, s[24:27], s59 offen offset:0 sc1
    v_mfma_f32_16x16x32_bf16 v[28:31], v[144:147], v[236:239], v[28:31]
    v_mfma_f32_16x16x32_bf16 v[60:63], v[148:151], v[236:239], v[60:63]
    v_mfma_f32_16x16x32_bf16 v[92:95], v[152:155], v[236:239], v[92:95]
    v_mfma_f32_16x16x32_bf16 v[124:127], v[156:159], v[236:239], v[124:127]
    buffer_load_dwordx4 v[236:239], v11, s[24:27], s59 offen offset:2048 sc1
    s_add_u32 s59, s59, s70
    v_mfma_f32_16x16x32_bf16 v[32:35], v[144:147], v[240:243], v[32:35]
    v_mfma_f32_16x16x32_bf16 v[64:67], v[148:151], v[240:243], v[64:67]
    v_mfma_f32_16x16x32_bf16 v[96:99], v[152:155], v[240:243], v[96:99]
    v_mfma_f32_16x16x32_bf16 v[128:131], v[156:159], v[240:243], v[128:131]
    buffer_load_dwordx4 v[240:243], v11, s[24:27], s59 offen offset:0 sc1
    v_mfma_f32_16x16x32_bf16 v[36:39], v[144:147], v[244:247], v[36:39]
    v_mfma_f32_16x16x32_bf16 v[68:71], v[148:151], v[244:247], v[68:71]
    v_mfma_f32_16x16x32_bf16 v[100:103], v[152:155], v[244:247], v[100:103]
    v_mfma_f32_16x16x32_bf16 v[132:135], v[156:159], v[244:247], v[132:135]
    buffer_load_dwordx4 v[244:247], v11, s[24:27], s59 offen offset:2048 sc1
    s_add_u32 s59, s59, 4096
    v_mfma_f32_16x16x32_bf16 v[40:43], v[144:147], v[248:251], v[40:43]
    v_mfma_f32_16x16x32_bf16 v[72:75], v[148:151], v[248:251], v[72:75]
    v_mfma_f32_16x16x32_bf16 v[104:107], v[152:155], v[248:251], v[104:107]
    v_mfma_f32_16x16x32_bf16 v[136:139], v[156:159], v[248:251], v[136:139]
    buffer_load_dwordx4 v[248:251], v11, s[24:27], s59 offen offset:0 sc1
    v_mfma_f32_16x16x32_bf16 v[44:47], v[144:147], v[252:255], v[44:47]
    v_mfma_f32_16x16x32_bf16 v[76:79], v[148:151], v[252:255], v[76:79]
    v_mfma_f32_16x16x32_bf16 v[108:111], v[152:155], v[252:255], v[108:111]
    v_mfma_f32_16x16x32_bf16 v[140:143], v[156:159], v[252:255], v[140:143]
    buffer_load_dwordx4 v[252:255], v11, s[24:27], s59 offen offset:2048 sc1
    s_add_u32 s59, s59, s71
    s_mov_b32 s62, 4
    s_waitcnt vmcnt(20)
    s_branch L_n0
.p2align 3
L_n0:
    s_waitcnt vmcnt(24)
    ds_read_b64_tr_b16 v[144:145], v4 offset:0
    ds_read_b64_tr_b16 v[146:147], v4 offset:2048
    ds_read_b64_tr_b16 v[148:149], v5 offset:0
    ds_read_b64_tr_b16 v[150:151], v5 offset:2048
    ds_read_b64_tr_b16 v[152:153], v6 offset:0
    ds_read_b64_tr_b16 v[154:155], v6 offset:2048
    ds_read_b64_tr_b16 v[156:157], v7 offset:0
    ds_read_b64_tr_b16 v[158:159], v7 offset:2048
    s_waitcnt lgkmcnt(0)
    s_add_u32 m0, s61, 0
    s_nop 0
    buffer_load_dwordx4 v8, s[52:55], s56 offen  lds
    s_add_u32 s56, s56, s57
    buffer_load_dwordx4 v8, s[52:55], s56 offen offset:1024  lds
    s_add_u32 s56, s56, s57
    buffer_load_dwordx4 v8, s[52:55], s56 offen offset:2048  lds
    s_add_u32 s56, s56, s57
    buffer_load_dwordx4 v8, s[52:55], s56 offen offset:3072  lds
    s_add_u32 s56, s56, s58
    v_mfma_f32_16x16x32_bf16 v[16:19], v[144:147], v[160:163], v[16:19]
    v_mfma_f32_16x16x32_bf16 v[48:51], v[148:151], v[160:163], v[48:51]
    v_mfma_f32_16x16x32_bf16 v[80:83], v[152:155], v[160:163], v[80:83]
    v_mfma_f32_16x16x32_bf16 v[112:115], v[156:159], v[160:163], v[112:115]
    buffer_load_dwordx4 v[160:163], v11, s[24:27], s59 offen offset:0 sc1
    v_mfma_f32_16x16x32_bf16 v[20:23], v[144:147], v[164:167], v[20:23]
    v_mfma_f32_16x16x32_bf16 v[52:55], v[148:151], v[164:167], v[52:55]
    v_mfma_f32_16x16x32_bf16 v[84:87], v[152:155], v[164:167], v[84:87]
    v_mfma_f32_16x16x32_bf16 v[116:119], v[156:159], v[164:167], v[116:119]
    buffer_load_dwordx4 v[164:167], v11, s[24:27], s59 offen offset:2048 sc1
    s_add_u32 s59, s59, 4096
    v_mfma_f32_16x16x32_bf16 v[24:27], v[144:147], v[168:171], v[24:27]
    v_mfma_f32_16x16x32_bf16 v[56:59], v[148:151], v[168:171], v[56:59]
    v_mfma_f32_16x16x32_bf16 v[88:91], v[152:155], v[168:171], v[88:91]
    v_mfma_f32_16x16x32_bf16 v[120:123], v[156:159], v[168:171], v[120:123]
    buffer_load_dwordx4 v[168:171], v11, s[24:27], s59 offen offset:0 sc1
    v_mfma_f32_16x16x32_bf16 v[28:31], v[144:147], v[172:175], v[28:31]
    v_mfma_f32_16x16x32_bf16 v[60:63], v[148:151], v[172:175], v[60:63]
    v_mfma_f32_16x16x32_bf16 v[92:95], v[152:155], v[172:175], v[92:95]
    v_mfma_f32_16x16x32_bf16 v[124:127], v[156:159], v[172:175], v[124:127]
    buffer_load_dwordx4 v[172:175], v11, s[24:27], s59 offen offset:2048 sc1
    s_add_u32 s59, s59, s70
    v_mfma_f32_16x16x32_bf16 v[32:35], v[144:147], v[176:179], v[32:35]
    v_mfma_f32_16x16x32_bf16 v[64:67], v[148:151], v[176:179], v[64:67]
    v_mfma_f32_16x16x32_bf16 v[96:99], v[152:155], v[176:179], v[96:99]
    v_mfma_f32_16x16x32_bf16 v[128:131], v[156:159], v[176:179], v[128:131]
    buffer_load_dwordx4 v[176:179], v11, s[24:27], s59 offen offset:0 sc1
    v_mfma_f32_16x16x32_bf16 v[36:39], v[144:147], v[180:183], v[36:39]
    v_mfma_f32_16x16x32_bf16 v[68:71], v[148:151], v[180:183], v[68:71]
    v_mfma_f32_16x16x32_bf16 v[100:103], v[152:155], v[180:183], v[100:103]
    v_mfma_f32_16x16x32_bf16 v[132:135], v[156:159], v[180:183], v[132:135]
    buffer_load_dwordx4 v[180:183], v11, s[24:27], s59 offen offset:2048 sc1
    s_add_u32 s59, s59, 4096
    v_mfma_f32_16x16x32_bf16 v[40:43], v[144:147], v[184:187], v[40:43]
    v_mfma_f32_16x16x32_bf16 v[72:75], v[148:151], v[184:187], v[72:75]
    v_mfma_f32_16x16x32_bf16 v[104:107], v[152:155], v[184:187], v[104:107]
    v_mfma_f32_16x16x32_bf16 v[136:139], v[156:159], v[184:187], v[136:139]
    buffer_load_dwordx4 v[184:187], v11, s[24:27], s59 offen offset:0 sc1
    v_mfma_f32_16x16x32_bf16 v[44:47], v[144:147], v[188:191], v[44:47]
    v_mfma_f32_16x16x32_bf16 v[76:79], v[148:151], v[188:191], v[76:79]
    v_mfma_f32_16x16x32_bf16 v[108:111], v[152:155], v[188:191], v[108:111]
    v_mfma_f32_16x16x32_bf16 v[140:143], v[156:159], v[188:191], v[140:143]
    buffer_load_dwordx4 v[188:191], v11, s[24:27], s59 offen offset:2048 sc1
    s_add_u32 s59, s59, s71
L_n1:
    s_waitcnt vmcnt(24)
    ds_read_b64_tr_b16 v[144:145], v4 offset:4096
    ds_read_b64_tr_b16 v[146:147], v4 offset:6144
    ds_read_b64_tr_b16 v[148:149], v5 offset:4096
    ds_read_b64_tr_b16 v[150:151], v5 offset:6144
    ds_read_b64_tr_b16 v[152:153], v6 offset:4096
    ds_read_b64_tr_b16 v[154:155], v6 offset:6144
    ds_read_b64_tr_b16 v[156:157], v7 offset:4096
    ds_read_b64_tr_b16 v[158:159], v7 offset:6144
    s_waitcnt lgkmcnt(0)
    s_add_u32 m0, s61, 4096
    s_nop 0
    buffer_load_dwordx4 v8, s[52:55], s56 offen  lds
    s_add_u32 s56, s56, s57
    buffer_load_dwordx4 v8, s[52:55], s56 offen offset:1024  lds
    s_add_u32 s56, s56, s57
    buffer_load_dwordx4 v8, s[52:55], s56 offen offset:2048  lds
    s_add_u32 s56, s56, s57
    buffer_load_dwordx4 v8, s[52:55], s56 offen offset:3072  lds
    s_add_u32 s56, s56, s58
    v_mfma_f32_16x16x32_bf16 v[16:19], v[144:147], v[192:195], v[16:19]
    v_mfma_f32_16x16x32_bf16 v[48:51], v[148:151], v[192:195], v[48:51]
    v_mfma_f32_16x16x32_bf16 v[80:83], v[152:155], v[192:195], v[80:83]
    v_mfma_f32_16x16x32_bf16 v[112:115], v[156:159], v[192:195], v[112:115]
    buffer_load_dwordx4 v[192:195], v11, s[24:27], s59 offen offset:0 sc1
    v_mfma_f32_16x16x32_bf16 v[20:23], v[144:147], v[196:199], v[20:23]
    v_mfma_f32_16x16x32_bf16 v[52:55], v[148:151], v[196:199], v[52:55]
    v_mfma_f32_16x16x32_bf16 v[84:87], v[152:155], v[196:199], v[84:87]
    v_mfma_f32_16x16x32_bf16 v[116:119], v[156:159], v[196:199], v[116:119]
    buffer_load_dwordx4 v[196:199], v11, s[24:27], s59 offen offset:2048 sc1
    s_add_u32 s59, s59, 4096
    v_mfma_f32_16x16x32_bf16 v[24:27], v[144:147], v[200:203], v[24:27]
    v_mfma_f32_16x16x32_bf16 v[56:59], v[148:151], v[200:203], v[56:59]
    v_mfma_f32_16x16x32_bf16 v[88:91], v[152:155], v[200:203], v[88:91]
    v_mfma_f32_16x16x32_bf16 v[120:123], v[156:159], v[200:203], v[120:123]
    buffer_load_dwordx4 v[200:203], v11, s[24:27], s59 offen offset:0 sc1
    v_mfma_f32_16x16x32_bf16 v[28:31], v[144:147], v[204:207], v[28:31]
    v_mfma_f32_16x16x32_bf16 v[60:63], v[148:151], v[204:207], v[60:63]
    v_mfma_f32_16x16x32_bf16 v[92:95], v[152:155], v[204:207], v[92:95]
    v_mfma_f32_16x16x32_bf16 v[124:127], v[156:159], v[204:207], v[124:127]
    buffer_load_dwordx4 v[204:207], v11, s[24:27], s59 offen offset:2048 sc1
    s_add_u32 s59, s59, s70
    v_mfma_f32_16x16x32_bf16 v[32:35], v[144:147], v[208:211], v[32:35]
    v_mfma_f32_16x16x32_bf16 v[64:67], v[148:151], v[208:211], v[64:67]
    v_mfma_f32_16x16x32_bf16 v[96:99], v[152:155], v[208:211], v[96:99]
    v_mfma_f32_16x16x32_bf16 v[128:131], v[156:159], v[208:211], v[128:131]
    buffer_load_dwordx4 v[208:211], v11, s[24:27], s59 offen offset:0 sc1
    v_mfma_f32_16x16x32_bf16 v[36:39], v[144:147], v[212:215], v[36:39]
    v_mfma_f32_16x16x32_bf16 v[68:71], v[148:151], v[212:215], v[68:71]
    v_mfma_f32_16x16x32_bf16 v[100:103], v[152:155], v[212:215], v[100:103]
    v_mfma_f32_16x16x32_bf16 v[132:135], v[156:159], v[212:215], v[132:135]
    buffer_load_dwordx4 v[212:215], v11, s[24:27], s59 offen offset:2048 sc1
    s_add_u32 s59, s59, 4096
    v_mfma_f32_16x16x32_bf16 v[40:43], v[144:147], v[216:219], v[40:43]
    v_mfma_f32_16x16x32_bf16 v[72:75], v[148:151], v[216:219], v[72:75]
    v_mfma_f32_16x16x32_bf16 v[104:107], v[152:155], v[216:219], v[104:107]
    v_mfma_f32_16x16x32_bf16 v[136:139], v[156:159], v[216:219], v[136:139]
    buffer_load_dwordx4 v[216:219], v11, s[24:27], s59 offen offset:0 sc1
    v_mfma_f32_16x16x32_bf16 v[44:47], v[144:147], v[220:223], v[44:47]
    v_mfma_f32_16x16x32_bf16 v[76:79], v[148:151], v[220:223], v[76:79]
    v_mfma_f32_16x16x32_bf16 v[108:111], v[152:155], v[220:223], v[108:111]
    v_mfma_f32_16x16x32_bf16 v[140:143], v[156:159], v[220:223], v[140:143]
    buffer_load_dwordx4 v[220:223], v11, s[24:27], s59 offen offset:2048 sc1
    s_add_u32 s59, s59, s71
L_n2:
    s_waitcnt vmcnt(24)
    ds_read_b64_tr_b16 v[144:145], v4 offset:8192
    ds_read_b64_tr_b16 v[146:147], v4 offset:10240
    ds_read_b64_tr_b16 v[148:149], v5 offset:8192
    ds_read_b64_tr_b16 v[150:151], v5 offset:10240
    ds_read_b64_tr_b16 v[152:153], v6 offset:8192
    ds_read_b64_tr_b16 v[154:155], v6 offset:10240
    ds_read_b64_tr_b16 v[156:157], v7 offset:8192
    ds_read_b64_tr_b16 v[158:159], v7 offset:10240
    s_waitcnt lgkmcnt(0)
    s_add_u32 m0, s61, 8192
    s_nop 0
    buffer_load_dwordx4 v8, s[52:55], s56 offen  lds
    s_add_u32 s56, s56, s57
    buffer_load_dwordx4 v8, s[52:55], s56 offen offset:1024  lds
    s_add_u32 s56, s56, s57
    buffer_load_dwordx4 v8, s[52:55], s56 offen offset:2048  lds
    s_add_u32 s56, s56, s57
    buffer_load_dwordx4 v8, s[52:55], s56 offen offset:3072  lds
    s_add_u32 s56, s56, s58
    v_mfma_f32_16x16x32_bf16 v[16:19], v[144:147], v[224:227], v[16:19]
    v_mfma_f32_16x16x32_bf16 v[48:51], v[148:151], v[224:227], v[48:51]
    v_mfma_f32_16x16x32_bf16 v[80:83], v[152:155], v[224:227], v[80:83]
    v_mfma_f32_16x16x32_bf16 v[112:115], v[156:159], v[224:227], v[112:115]
    buffer_load_dwordx4 v[224:227], v11, s[24:27], s59 offen offset:0 sc1
    v_mfma_f32_16x16x32_bf16 v[20:23], v[144:147], v[228:231], v[20:23]
    v_mfma_f32_16x16x32_bf16 v[52:55], v[148:151], v[228:231], v[52:55]
    v_mfma_f32_16x16x32_bf16 v[84:87], v[152:155], v[228:231], v[84:87]
    v_mfma_f32_16x16x32_bf16 v[116:119], v[156:159], v[228:231], v[116:119]
    buffer_load_dwordx4 v[228:231], v11, s[24:27], s59 offen offset:2048 sc1
    s_add_u32 s59, s59, 4096
    v_mfma_f32_16x16x32_bf16 v[24:27], v[144:147], v[232:235], v[24:27]
    v_mfma_f32_16x16x32_bf16 v[56:59], v[148:151], v[232:235], v[56:59]
    v_mfma_f32_16x16x32_bf16 v[88:91], v[152:155], v[232:235], v[88:91]
    v_mfma_f32_16x16x32_bf16 v[120:123], v[156:159], v[232:235], v[120:123]
    buffer_load_dwordx4 v[232:235], v11, s[24:27], s59 offen offset:0 sc1
    v_mfma_f32_16x16x32_bf16 v[28:31], v[144:147], v[236:239], v[28:31]
    v_mfma_f32_16x16x32_bf16 v[60:63], v[148:151], v[236:239], v[60:63]
    v_mfma_f32_16x16x32_bf16 v[92:95], v[152:155], v[236:239], v[92:95]
    v_mfma_f32_16x16x32_bf16 v[124:127], v[156:159], v[236:239], v[124:127]
    buffer_load_dwordx4 v[236:239], v11, s[24:27], s59 offen offset:2048 sc1
    s_add_u32 s59, s59, s70
    v_mfma_f32_16x16x32_bf16 v[32:35], v[144:147], v[240:243], v[32:35]
    v_mfma_f32_16x16x32_bf16 v[64:67], v[148:151], v[240:243], v[64:67]
    v_mfma_f32_16x16x32_bf16 v[96:99], v[152:155], v[240:243], v[96:99]
    v_mfma_f32_16x16x32_bf16 v[128:131], v[156:159], v[240:243], v[128:131]
    buffer_load_dwordx4 v[240:243], v11, s[24:27], s59 offen offset:0 sc1
    v_mfma_f32_16x16x32_bf16 v[36:39], v[144:147], v[244:247], v[36:39]
    v_mfma_f32_16x16x32_bf16 v[68:71], v[148:151], v[244:247], v[68:71]
    v_mfma_f32_16x16x32_bf16 v[100:103], v[152:155], v[244:247], v[100:103]
    v_mfma_f32_16x16x32_bf16 v[132:135], v[156:159], v[244:247], v[132:135]
    buffer_load_dwordx4 v[244:247], v11, s[24:27], s59 offen offset:2048 sc1
    s_add_u32 s59, s59, 4096
    v_mfma_f32_16x16x32_bf16 v[40:43], v[144:147], v[248:251], v[40:43]
    v_mfma_f32_16x16x32_bf16 v[72:75], v[148:151], v[248:251], v[72:75]
    v_mfma_f32_16x16x32_bf16 v[104:107], v[152:155], v[248:251], v[104:107]
    v_mfma_f32_16x16x32_bf16 v[136:139], v[156:159], v[248:251], v[136:139]
    buffer_load_dwordx4 v[248:251], v11, s[24:27], s59 offen offset:0 sc1
    v_mfma_f32_16x16x32_bf16 v[44:47], v[144:147], v[252:255], v[44:47]
    v_mfma_f32_16x16x32_bf16 v[76:79], v[148:151], v[252:255], v[76:79]
    v_mfma_f32_16x16x32_bf16 v[108:111], v[152:155], v[252:255], v[108:111]
    v_mfma_f32_16x16x32_bf16 v[140:143], v[156:159], v[252:255], v[140:143]
    buffer_load_dwordx4 v[252:255], v11, s[24:27], s59 offen offset:2048 sc1
    s_add_u32 s59, s59, s71
    s_sub_u32 s62, s62, 1
    s_cmp_lg_u32 s62, 0
    s_cbranch_scc1 L_n0
    v_mov_b32 v2, 163720
    v_mov_b32 v3, 1
    s_mov_b64 exec, 1
    ds_add_u32 v2, v3
    s_mov_b64 exec, -1
    s_waitcnt vmcnt(24)
    ds_read_b64_tr_b16 v[144:145], v4 offset:0
    ds_read_b64_tr_b16 v[146:147], v4 offset:2048
    ds_read_b64_tr_b16 v[148:149], v5 offset:0
    ds_read_b64_tr_b16 v[150:151], v5 offset:2048
    ds_read_b64_tr_b16 v[152:153], v6 offset:0
    ds_read_b64_tr_b16 v[154:155], v6 offset:2048
    ds_read_b64_tr_b16 v[156:157], v7 offset:0
    ds_read_b64_tr_b16 v[158:159], v7 offset:2048
    s_waitcnt lgkmcnt(0)
    v_mfma_f32_16x16x32_bf16 v[16:19], v[144:147], v[160:163], v[16:19]
    v_mfma_f32_16x16x32_bf16 v[48:51], v[148:151], v[160:163], v[48:51]
    v_mfma_f32_16x16x32_bf16 v[80:83], v[152:155], v[160:163], v[80:83]
    v_mfma_f32_16x16x32_bf16 v[112:115], v[156:159], v[160:163], v[112:115]
    v_mfma_f32_16x16x32_bf16 v[20:23], v[144:147], v[164:167], v[20:23]
    v_mfma_f32_16x16x32_bf16 v[52:55], v[148:151], v[164:167], v[52:55]
    v_mfma_f32_16x16x32_bf16 v[84:87], v[152:155], v[164:167], v[84:87]
    v_mfma_f32_16x16x32_bf16 v[116:119], v[156:159], v[164:167], v[116:119]
    v_mfma_f32_16x16x32_bf16 v[24:27], v[144:147], v[168:171], v[24:27]
    v_mfma_f32_16x16x32_bf16 v[56:59], v[148:151], v[168:171], v[56:59]
    v_mfma_f32_16x16x32_bf16 v[88:91], v[152:155], v[168:171], v[88:91]
    v_mfma_f32_16x16x32_bf16 v[120:123], v[156:159], v[168:171], v[120:123]
    v_mfma_f32_16x16x32_bf16 v[28:31], v[144:147], v[172:175], v[28:31]
    v_mfma_f32_16x16x32_bf16 v[60:63], v[148:151], v[172:175], v[60:63]
    v_mfma_f32_16x16x32_bf16 v[92:95], v[152:155], v[172:175], v[92:95]
    v_mfma_f32_16x16x32_bf16 v[124:127], v[156:159], v[172:175], v[124:127]
    v_mfma_f32_16x16x32_bf16 v[32:35], v[144:147], v[176:179], v[32:35]
    v_mfma_f32_16x16x32_bf16 v[64:67], v[148:151], v[176:179], v[64:67]
    v_mfma_f32_16x16x32_bf16 v[96:99], v[152:155], v[176:179], v[96:99]
    v_mfma_f32_16x16x32_bf16 v[128:131], v[156:159], v[176:179], v[128:131]
    v_mfma_f32_16x16x32_bf16 v[36:39], v[144:147], v[180:183], v[36:39]
    v_mfma_f32_16x16x32_bf16 v[68:71], v[148:151], v[180:183], v[68:71]
    v_mfma_f32_16x16x32_bf16 v[100:103], v[152:155], v[180:183], v[100:103]
    v_mfma_f32_16x16x32_bf16 v[132:135], v[156:159], v[180:183], v[132:135]
    v_mfma_f32_16x16x32_bf16 v[40:43], v[144:147], v[184:187], v[40:43]
    v_mfma_f32_16x16x32_bf16 v[72:75], v[148:151], v[184:187], v[72:75]
    v_mfma_f32_16x16x32_bf16 v[104:107], v[152:155], v[184:187], v[104:107]
    v_mfma_f32_16x16x32_bf16 v[136:139], v[156:159], v[184:187], v[136:139]
    v_mfma_f32_16x16x32_bf16 v[44:47], v[144:147], v[188:191], v[44:47]
    v_mfma_f32_16x16x32_bf16 v[76:79], v[148:151], v[188:191], v[76:79]
    v_mfma_f32_16x16x32_bf16 v[108:111], v[152:155], v[188:191], v[108:111]
    v_mfma_f32_16x16x32_bf16 v[140:143], v[156:159], v[188:191], v[140:143]
    s_waitcnt vmcnt(12)
    ds_read_b64_tr_b16 v[144:145], v4 offset:4096
    ds_read_b64_tr_b16 v[146:147], v4 offset:6144
    ds_read_b64_tr_b16 v[148:149], v5 offset:4096
    ds_read_b64_tr_b16 v[150:151], v5 offset:6144
    ds_read_b64_tr_b16 v[152:153], v6 offset:4096
    ds_read_b64_tr_b16 v[154:155], v6 offset:6144
    ds_read_b64_tr_b16 v[156:157], v7 offset:4096
    ds_read_b64_tr_b16 v[158:159], v7 offset:6144
    s_waitcnt lgkmcnt(0)
    v_mfma_f32_16x16x32_bf16 v[16:19], v[144:147], v[192:195], v[16:19]
    v_mfma_f32_16x16x32_bf16 v[48:51], v[148:151], v[192:195], v[48:51]
    v_mfma_f32_16x16x32_bf16 v[80:83], v[152:155], v[192:195], v[80:83]
    v_mfma_f32_16x16x32_bf16 v[112:115], v[156:159], v[192:195], v[112:115]
    v_mfma_f32_16x16x32_bf16 v[20:23], v[144:147], v[196:199], v[20:23]
    v_mfma_f32_16x16x32_bf16 v[52:55], v[148:151], v[196:199], v[52:55]
    v_mfma_f32_16x16x32_bf16 v[84:87], v[152:155], v[196:199], v[84:87]
    v_mfma_f32_16x16x32_bf16 v[116:119], v[156:159], v[196:199], v[116:119]
    v_mfma_f32_16x16x32_bf16 v[24:27], v[144:147], v[200:203], v[24:27]
    v_mfma_f32_16x16x32_bf16 v[56:59], v[148:151], v[200:203], v[56:59]
    v_mfma_f32_16x16x32_bf16 v[88:91], v[152:155], v[200:203], v[88:91]
    v_mfma_f32_16x16x32_bf16 v[120:123], v[156:159], v[200:203], v[120:123]
    v_mfma_f32_16x16x32_bf16 v[28:31], v[144:147], v[204:207], v[28:31]
    v_mfma_f32_16x16x32_bf16 v[60:63], v[148:151], v[204:207], v[60:63]
    v_mfma_f32_16x16x32_bf16 v[92:95], v[152:155], v[204:207], v[92:95]
    v_mfma_f32_16x16x32_bf16 v[124:127], v[156:159], v[204:207], v[124:127]
    v_mfma_f32_16x16x32_bf16 v[32:35], v[144:147], v[208:211], v[32:35]
    v_mfma_f32_16x16x32_bf16 v[64:67], v[148:151], v[208:211], v[64:67]
    v_mfma_f32_16x16x32_bf16 v[96:99], v[152:155], v[208:211], v[96:99]
    v_mfma_f32_16x16x32_bf16 v[128:131], v[156:159], v[208:211], v[128:131]
    v_mfma_f32_16x16x32_bf16 v[36:39], v[144:147], v[212:215], v[36:39]
    v_mfma_f32_16x16x32_bf16 v[68:71], v[148:151], v[212:215], v[68:71]
    v_mfma_f32_16x16x32_bf16 v[100:103], v[152:155], v[212:215], v[100:103]
    v_mfma_f32_16x16x32_bf16 v[132:135], v[156:159], v[212:215], v[132:135]
    v_mfma_f32_16x16x32_bf16 v[40:43], v[144:147], v[216:219], v[40:43]
    v_mfma_f32_16x16x32_bf16 v[72:75], v[148:151], v[216:219], v[72:75]
    v_mfma_f32_16x16x32_bf16 v[104:107], v[152:155], v[216:219], v[104:107]
    v_mfma_f32_16x16x32_bf16 v[136:139], v[156:159], v[216:219], v[136:139]
    v_mfma_f32_16x16x32_bf16 v[44:47], v[144:147], v[220:223], v[44:47]
    v_mfma_f32_16x16x32_bf16 v[76:79], v[148:151], v[220:223], v[76:79]
    v_mfma_f32_16x16x32_bf16 v[108:111], v[152:155], v[220:223], v[108:111]
    v_mfma_f32_16x16x32_bf16 v[140:143], v[156:159], v[220:223], v[140:143]
    s_waitcnt vmcnt(0)
    ds_read_b64_tr_b16 v[144:145], v4 offset:8192
    ds_read_b64_tr_b16 v[146:147], v4 offset:10240
    ds_read_b64_tr_b16 v[148:149], v5 offset:8192
    ds_read_b64_tr_b16 v[150:151], v5 offset:10240
    ds_read_b64_tr_b16 v[152:153], v6 offset:8192
    ds_read_b64_tr_b16 v[154:155], v6 offset:10240
    ds_read_b64_tr_b16 v[156:157], v7 offset:8192
    ds_read_b64_tr_b16 v[158:159], v7 offset:10240
    v_add_u32 v10, s66, v9
    s_setprio 3
    s_waitcnt lgkmcnt(0)
    v_mfma_f32_16x16x32_bf16 v[32:35], v[144:147], v[240:243], v[32:35]
    v_mfma_f32_16x16x32_bf16 v[36:39], v[144:147], v[244:247], v[36:39]
    v_mfma_f32_16x16x32_bf16 v[40:43], v[144:147], v[248:251], v[40:43]
    v_mfma_f32_16x16x32_bf16 v[44:47], v[144:147], v[252:255], v[44:47]
    v_mfma_f32_16x16x32_bf16 v[64:67], v[148:151], v[240:243], v[64:67]
    v_mfma_f32_16x16x32_bf16 v[68:71], v[148:151], v[244:247], v[68:71]
    s_nop 3
    ds_write_b128 v10, v[32:35] offset:0
    v_mfma_f32_16x16x32_bf16 v[72:75], v[148:151], v[248:251], v[72:75]
    ds_write_b128 v10, v[36:39] offset:1024
    v_mfma_f32_16x16x32_bf16 v[76:79], v[148:151], v[252:255], v[76:79]
    ds_write_b128 v10, v[40:43] offset:2048
    v_mfma_f32_16x16x32_bf16 v[80:83], v[152:155], v[224:227], v[80:83]
    ds_write_b128 v10, v[44:47] offset:3072
    v_mfma_f32_16x16x32_bf16 v[84:87], v[152:155], v[228:231], v[84:87]
    ds_write_b128 v10, v[64:67] offset:4096
    v_mfma_f32_16x16x32_bf16 v[88:91], v[152:155], v[232:235], v[88:91]
    ds_write_b128 v10, v[68:71] offset:5120
    v_mfma_f32_16x16x32_bf16 v[92:95], v[152:155], v[236:239], v[92:95]
    ds_write_b128 v10, v[72:75] offset:6144
    v_mfma_f32_16x16x32_bf16 v[96:99], v[152:155], v[240:243], v[96:99]
    ds_write_b128 v10, v[76:79] offset:7168
    v_mfma_f32_16x16x32_bf16 v[100:103], v[152:155], v[244:247], v[100:103]
    ds_write_b128 v10, v[80:83] offset:8192
    v_mfma_f32_16x16x32_bf16 v[104:107], v[152:155], v[248:251], v[104:107]
    ds_write_b128 v10, v[84:87] offset:9216
    v_mfma_f32_16x16x32_bf16 v[108:111], v[152:155], v[252:255], v[108:111]
    ds_write_b128 v10, v[88:91] offset:10240
    v_mfma_f32_16x16x32_bf16 v[112:115], v[156:159], v[224:227], v[112:115]
    ds_write_b128 v10, v[92:95] offset:11264
    v_mfma_f32_16x16x32_bf16 v[116:119], v[156:159], v[228:231], v[116:119]
    ds_write_b128 v10, v[96:99] offset:12288
    v_mfma_f32_16x16x32_bf16 v[120:123], v[156:159], v[232:235], v[120:123]
    ds_write_b128 v10, v[100:103] offset:13312
    v_mfma_f32_16x16x32_bf16 v[124:127], v[156:159], v[236:239], v[124:127]
    ds_write_b128 v10, v[104:107] offset:14336
    v_mfma_f32_16x16x32_bf16 v[128:131], v[156:159], v[240:243], v[128:131]
    ds_write_b128 v10, v[108:111] offset:15360
    v_mfma_f32_16x16x32_bf16 v[132:135], v[156:159], v[244:247], v[132:135]
    ds_write_b128 v10, v[112:115] offset:16384
    v_mfma_f32_16x16x32_bf16 v[136:139], v[156:159], v[248:251], v[136:139]
    ds_write_b128 v10, v[116:119] offset:17408
    v_mfma_f32_16x16x32_bf16 v[140:143], v[156:159], v[252:255], v[140:143]
    ds_write_b128 v10, v[120:123] offset:18432
    v_mfma_f32_16x16x32_bf16 v[16:19], v[144:147], v[224:227], v[16:19]
    ds_write_b128 v10, v[124:127] offset:19456
    v_mfma_f32_16x16x32_bf16 v[20:23], v[144:147], v[228:231], v[20:23]
    ds_write_b128 v10, v[128:131] offset:20480
    v_mfma_f32_16x16x32_bf16 v[24:27], v[144:147], v[232:235], v[24:27]
    ds_write_b128 v10, v[132:135] offset:21504
    v_mfma_f32_16x16x32_bf16 v[28:31], v[144:147], v[236:239], v[28:31]
    ds_write_b128 v10, v[136:139] offset:22528
    v_mfma_f32_16x16x32_bf16 v[48:51], v[148:151], v[224:227], v[48:51]
    ds_write_b128 v10, v[140:143] offset:23552
    v_mfma_f32_16x16x32_bf16 v[52:55], v[148:151], v[228:231], v[52:55]
    v_mfma_f32_16x16x32_bf16 v[56:59], v[148:151], v[232:235], v[56:59]
    v_mfma_f32_16x16x32_bf16 v[60:63], v[148:151], v[236:239], v[60:63]
    s_setprio 3
    v_mov_b32 v8, v11
    s_xor_b32 s68, s75, 1
    s_mul_i32 s68, s68, 24576
    s_add_u32 s68, s68, 49152
    v_add_u32 v11, s68, v9
    s_xor_b32 s68, s75, 2
    s_mul_i32 s68, s68, 24576
    s_add_u32 s68, s68, 57344
    v_add_u32 v12, s68, v9
    s_xor_b32 s68, s75, 3
    s_mul_i32 s68, s68, 24576
    s_add_u32 s68, s68, 61440
    v_add_u32 v13, s68, v9
    s_lshl_b32 s65, s80, 1
    s_lshr_b32 s69, s75, 1
    s_add_u32 s65, s65, s69
    s_mul_i32 s65, s65, 10240
    s_add_u32 s65, s65, 16683008
    s_lshl_b32 s69, s79, 3
    s_and_b32 s68, s75, 1
    s_lshl_b32 s68, s68, 2
    s_add_u32 s69, s69, s68
    s_add_u32 s68, s69, 0
    s_mul_i32 s70, s68, 52
    s_lshr_b32 s70, s70, 8
    s_mul_i32 s70, s70, 542720
    s_lshl_b32 s68, s68, 11
    s_add_u32 s70, s70, s68
    s_add_u32 s50, s70, s65
    s_add_u32 s68, s69, 1
    s_mul_i32 s70, s68, 52
    s_lshr_b32 s70, s70, 8
    s_mul_i32 s70, s70, 542720
    s_lshl_b32 s68, s68, 11
    s_add_u32 s70, s70, s68
    s_add_u32 s51, s70, s65
    s_add_u32 s68, s69, 2
    s_mul_i32 s70, s68, 52
    s_lshr_b32 s70, s70, 8
    s_mul_i32 s70, s70, 542720
    s_lshl_b32 s68, s68, 11
    s_add_u32 s70, s70, s68
    s_add_u32 s52, s70, s65
    s_add_u32 s68, s69, 3
    s_mul_i32 s70, s68, 52
    s_lshr_b32 s70, s70, 8
    s_mul_i32 s70, s70, 542720
    s_lshl_b32 s68, s68, 11
    s_add_u32 s70, s70, s68
    s_add_u32 s53, s70, s65
    s_mov_b32 s72, 0xbdd2d3e8
    s_mov_b32 s73, 0xbdd2d3e8
    v_mov_b32 v14, 0xc0135761
    v_mov_b32 v15, v14
    s_waitcnt lgkmcnt(0)
    v_mov_b32 v2, 163792
    v_mov_b32 v3, 1
    s_mov_b64 exec, 1
    ds_add_u32 v2, v3
    s_mov_b64 exec, -1
    s_mov_b32 s47, 0x80000
sync_37:
    ds_read_b32 v3, v2
    s_sub_u32 s47, s47, 1
    s_cbranch_scc1 sync_37x
    s_waitcnt lgkmcnt(0)
    v_readfirstlane_b32 s60, v3
    s_cmp_ge_u32 s60, 4
    s_cbranch_scc1 sync_37x
    s_sleep 0
    s_branch sync_37
sync_37x:
    ds_read_b128 v[160:163], v11 offset:0
    ds_read_b128 v[164:167], v11 offset:4096
    ds_read_b128 v[168:171], v12 offset:0
    ds_read_b128 v[172:175], v12 offset:8192
    ds_read_b128 v[176:179], v13 offset:0
    ds_read_b128 v[180:183], v13 offset:8192
    ds_read_b128 v[184:187], v11 offset:1024
    ds_read_b128 v[188:191], v11 offset:5120
    ds_read_b128 v[192:195], v12 offset:1024
    ds_read_b128 v[196:199], v12 offset:9216
    ds_read_b128 v[200:203], v13 offset:1024
    ds_read_b128 v[204:207], v13 offset:9216
    ds_read_b128 v[208:211], v11 offset:2048
    ds_read_b128 v[212:215], v11 offset:6144
    ds_read_b128 v[216:219], v12 offset:2048
    ds_read_b128 v[220:223], v12 offset:10240
    ds_read_b128 v[224:227], v13 offset:2048
    ds_read_b128 v[228:231], v13 offset:10240
    s_waitcnt lgkmcnt(12)
    v_pk_add_f32 v[16:17], v[16:17], v[160:161]
    v_pk_add_f32 v[18:19], v[18:19], v[162:163]
    v_pk_add_f32 v[48:49], v[48:49], v[164:165]
    v_pk_add_f32 v[50:51], v[50:51], v[166:167]
    v_pk_add_f32 v[16:17], v[16:17], v[168:169]
    v_pk_add_f32 v[18:19], v[18:19], v[170:171]
    v_pk_add_f32 v[48:49], v[48:49], v[172:173]
    v_pk_add_f32 v[50:51], v[50:51], v[174:175]
    v_pk_add_f32 v[16:17], v[16:17], v[176:177]
    v_pk_add_f32 v[18:19], v[18:19], v[178:179]
    v_pk_add_f32 v[48:49], v[48:49], v[180:181]
    v_pk_add_f32 v[50:51], v[50:51], v[182:183]
    v_pk_mul_f32 v[144:145], v[16:17], v[16:17]
    v_pk_mul_f32 v[146:147], v[18:19], v[18:19]
    v_pk_mul_f32 v[148:149], v[48:49], v[48:49]
    v_pk_mul_f32 v[150:151], v[50:51], v[50:51]
    v_pk_fma_f32 v[144:145], v[144:145], s[72:73], v[14:15]
    v_pk_fma_f32 v[146:147], v[146:147], s[72:73], v[14:15]
    v_pk_fma_f32 v[148:149], v[148:149], s[72:73], v[14:15]
    v_pk_fma_f32 v[150:151], v[150:151], s[72:73], v[14:15]
    v_pk_mul_f32 v[144:145], v[144:145], v[16:17]
    v_pk_mul_f32 v[146:147], v[146:147], v[18:19]
    v_pk_mul_f32 v[148:149], v[148:149], v[48:49]
    v_pk_mul_f32 v[150:151], v[150:151], v[50:51]
    v_exp_f32 v144, v144
    v_exp_f32 v145, v145
    v_exp_f32 v146, v146
    v_exp_f32 v147, v147
    v_exp_f32 v148, v148
    v_exp_f32 v149, v149
    v_exp_f32 v150, v150
    v_exp_f32 v151, v151
    s_nop 0
    v_pk_add_f32 v[144:145], v[144:145], 1.0 op_sel_hi:[1,0]
    v_pk_add_f32 v[146:147], v[146:147], 1.0 op_sel_hi:[1,0]
    v_pk_add_f32 v[148:149], v[148:149], 1.0 op_sel_hi:[1,0]
    v_pk_add_f32 v[150:151], v[150:151], 1.0 op_sel_hi:[1,0]
    v_rcp_f32 v144, v144
    v_rcp_f32 v145, v145
    v_rcp_f32 v146, v146
    v_rcp_f32 v147, v147
    v_rcp_f32 v148, v148
    v_rcp_f32 v149, v149
    v_rcp_f32 v150, v150
    v_rcp_f32 v151, v151
    s_nop 0
    v_pk_mul_f32 v[144:145], v[144:145], v[16:17]
    v_pk_mul_f32 v[146:147], v[146:147], v[18:19]
    v_pk_mul_f32 v[148:149], v[148:149], v[48:49]
    v_pk_mul_f32 v[150:151], v[150:151], v[50:51]
    v_cvt_pk_bf16_f32 v152, v144, v145
    v_cvt_pk_bf16_f32 v153, v146, v147
    v_cvt_pk_bf16_f32 v154, v148, v149
    v_cvt_pk_bf16_f32 v155, v150, v151
    buffer_store_dwordx4 v[152:155], v8, s[24:27], s50 offen sc1
    ds_read_b128 v[232:235], v11 offset:3072
    ds_read_b128 v[236:239], v11 offset:7168
    ds_read_b128 v[240:243], v12 offset:3072
    ds_read_b128 v[244:247], v12 offset:11264
    ds_read_b128 v[248:251], v13 offset:3072
    ds_read_b128 v[252:255], v13 offset:11264
    s_waitcnt lgkmcnt(12)
    v_pk_add_f32 v[20:21], v[20:21], v[184:185]
    v_pk_add_f32 v[22:23], v[22:23], v[186:187]
    v_pk_add_f32 v[52:53], v[52:53], v[188:189]
    v_pk_add_f32 v[54:55], v[54:55], v[190:191]
    v_pk_add_f32 v[20:21], v[20:21], v[192:193]
    v_pk_add_f32 v[22:23], v[22:23], v[194:195]
    v_pk_add_f32 v[52:53], v[52:53], v[196:197]
    v_pk_add_f32 v[54:55], v[54:55], v[198:199]
    v_pk_add_f32 v[20:21], v[20:21], v[200:201]
    v_pk_add_f32 v[22:23], v[22:23], v[202:203]
    v_pk_add_f32 v[52:53], v[52:53], v[204:205]
    v_pk_add_f32 v[54:55], v[54:55], v[206:207]
    v_pk_mul_f32 v[144:145], v[20:21], v[20:21]
    v_pk_mul_f32 v[146:147], v[22:23], v[22:23]
    v_pk_mul_f32 v[148:149], v[52:53], v[52:53]
    v_pk_mul_f32 v[150:151], v[54:55], v[54:55]
    v_pk_fma_f32 v[144:145], v[144:145], s[72:73], v[14:15]
    v_pk_fma_f32 v[146:147], v[146:147], s[72:73], v[14:15]
    v_pk_fma_f32 v[148:149], v[148:149], s[72:73], v[14:15]
    v_pk_fma_f32 v[150:151], v[150:151], s[72:73], v[14:15]
    v_pk_mul_f32 v[144:145], v[144:145], v[20:21]
    v_pk_mul_f32 v[146:147], v[146:147], v[22:23]
    v_pk_mul_f32 v[148:149], v[148:149], v[52:53]
    v_pk_mul_f32 v[150:151], v[150:151], v[54:55]
    v_exp_f32 v144, v144
    v_exp_f32 v145, v145
    v_exp_f32 v146, v146
    v_exp_f32 v147, v147
    v_exp_f32 v148, v148
    v_exp_f32 v149, v149
    v_exp_f32 v150, v150
    v_exp_f32 v151, v151
    s_nop 0
    v_pk_add_f32 v[144:145], v[144:145], 1.0 op_sel_hi:[1,0]
    v_pk_add_f32 v[146:147], v[146:147], 1.0 op_sel_hi:[1,0]
    v_pk_add_f32 v[148:149], v[148:149], 1.0 op_sel_hi:[1,0]
    v_pk_add_f32 v[150:151], v[150:151], 1.0 op_sel_hi:[1,0]
    v_rcp_f32 v144, v144
    v_rcp_f32 v145, v145
    v_rcp_f32 v146, v146
    v_rcp_f32 v147, v147
    v_rcp_f32 v148, v148
    v_rcp_f32 v149, v149
    v_rcp_f32 v150, v150
    v_rcp_f32 v151, v151
    s_nop 0
    v_pk_mul_f32 v[144:145], v[144:145], v[20:21]
    v_pk_mul_f32 v[146:147], v[146:147], v[22:23]
    v_pk_mul_f32 v[148:149], v[148:149], v[52:53]
    v_pk_mul_f32 v[150:151], v[150:151], v[54:55]
    v_cvt_pk_bf16_f32 v156, v144, v145
    v_cvt_pk_bf16_f32 v157, v146, v147
    v_cvt_pk_bf16_f32 v158, v148, v149
    v_cvt_pk_bf16_f32 v159, v150, v151
    buffer_store_dwordx4 v[156:159], v8, s[24:27], s51 offen sc1
    s_waitcnt lgkmcnt(6)
    v_pk_add_f32 v[24:25], v[24:25], v[208:209]
    v_pk_add_f32 v[26:27], v[26:27], v[210:211]
    v_pk_add_f32 v[56:57], v[56:57], v[212:213]
    v_pk_add_f32 v[58:59], v[58:59], v[214:215]
    v_pk_add_f32 v[24:25], v[24:25], v[216:217]
    v_pk_add_f32 v[26:27], v[26:27], v[218:219]
    v_pk_add_f32 v[56:57], v[56:57], v[220:221]
    v_pk_add_f32 v[58:59], v[58:59], v[222:223]
    v_pk_add_f32 v[24:25], v[24:25], v[224:225]
    v_pk_add_f32 v[26:27], v[26:27], v[226:227]
    v_pk_add_f32 v[56:57], v[56:57], v[228:229]
    v_pk_add_f32 v[58:59], v[58:59], v[230:231]
    v_pk_mul_f32 v[144:145], v[24:25], v[24:25]
    v_pk_mul_f32 v[146:147], v[26:27], v[26:27]
    v_pk_mul_f32 v[148:149], v[56:57], v[56:57]
    v_pk_mul_f32 v[150:151], v[58:59], v[58:59]
    v_pk_fma_f32 v[144:145], v[144:145], s[72:73], v[14:15]
    v_pk_fma_f32 v[146:147], v[146:147], s[72:73], v[14:15]
    v_pk_fma_f32 v[148:149], v[148:149], s[72:73], v[14:15]
    v_pk_fma_f32 v[150:151], v[150:151], s[72:73], v[14:15]
    v_pk_mul_f32 v[144:145], v[144:145], v[24:25]
    v_pk_mul_f32 v[146:147], v[146:147], v[26:27]
    v_pk_mul_f32 v[148:149], v[148:149], v[56:57]
    v_pk_mul_f32 v[150:151], v[150:151], v[58:59]
    v_exp_f32 v144, v144
    v_exp_f32 v145, v145
    v_exp_f32 v146, v146
    v_exp_f32 v147, v147
    v_exp_f32 v148, v148
    v_exp_f32 v149, v149
    v_exp_f32 v150, v150
    v_exp_f32 v151, v151
    s_nop 0
    v_pk_add_f32 v[144:145], v[144:145], 1.0 op_sel_hi:[1,0]
    v_pk_add_f32 v[146:147], v[146:147], 1.0 op_sel_hi:[1,0]
    v_pk_add_f32 v[148:149], v[148:149], 1.0 op_sel_hi:[1,0]
    v_pk_add_f32 v[150:151], v[150:151], 1.0 op_sel_hi:[1,0]
    v_rcp_f32 v144, v144
    v_rcp_f32 v145, v145
    v_rcp_f32 v146, v146
    v_rcp_f32 v147, v147
    v_rcp_f32 v148, v148
    v_rcp_f32 v149, v149
    v_rcp_f32 v150, v150
    v_rcp_f32 v151, v151
    s_nop 0
    v_pk_mul_f32 v[144:145], v[144:145], v[24:25]
    v_pk_mul_f32 v[146:147], v[146:147], v[26:27]
    v_pk_mul_f32 v[148:149], v[148:149], v[56:57]
    v_pk_mul_f32 v[150:151], v[150:151], v[58:59]
    v_cvt_pk_bf16_f32 v152, v144, v145
    v_cvt_pk_bf16_f32 v153, v146, v147
    v_cvt_pk_bf16_f32 v154, v148, v149
    v_cvt_pk_bf16_f32 v155, v150, v151
    buffer_store_dwordx4 v[152:155], v8, s[24:27], s52 offen sc1
    s_waitcnt lgkmcnt(0)
    v_pk_add_f32 v[28:29], v[28:29], v[232:233]
    v_pk_add_f32 v[30:31], v[30:31], v[234:235]
    v_pk_add_f32 v[60:61], v[60:61], v[236:237]
    v_pk_add_f32 v[62:63], v[62:63], v[238:239]
    v_pk_add_f32 v[28:29], v[28:29], v[240:241]
    v_pk_add_f32 v[30:31], v[30:31], v[242:243]
    v_pk_add_f32 v[60:61], v[60:61], v[244:245]
    v_pk_add_f32 v[62:63], v[62:63], v[246:247]
    v_pk_add_f32 v[28:29], v[28:29], v[248:249]
    v_pk_add_f32 v[30:31], v[30:31], v[250:251]
    v_pk_add_f32 v[60:61], v[60:61], v[252:253]
    v_pk_add_f32 v[62:63], v[62:63], v[254:255]
    v_pk_mul_f32 v[144:145], v[28:29], v[28:29]
    v_pk_mul_f32 v[146:147], v[30:31], v[30:31]
    v_pk_mul_f32 v[148:149], v[60:61], v[60:61]
    v_pk_mul_f32 v[150:151], v[62:63], v[62:63]
    v_pk_fma_f32 v[144:145], v[144:145], s[72:73], v[14:15]
    v_pk_fma_f32 v[146:147], v[146:147], s[72:73], v[14:15]
    v_pk_fma_f32 v[148:149], v[148:149], s[72:73], v[14:15]
    v_pk_fma_f32 v[150:151], v[150:151], s[72:73], v[14:15]
    v_pk_mul_f32 v[144:145], v[144:145], v[28:29]
    v_pk_mul_f32 v[146:147], v[146:147], v[30:31]
    v_pk_mul_f32 v[148:149], v[148:149], v[60:61]
    v_pk_mul_f32 v[150:151], v[150:151], v[62:63]
    v_exp_f32 v144, v144
    v_exp_f32 v145, v145
    v_exp_f32 v146, v146
    v_exp_f32 v147, v147
    v_exp_f32 v148, v148
    v_exp_f32 v149, v149
    v_exp_f32 v150, v150
    v_exp_f32 v151, v151
    s_nop 0
    v_pk_add_f32 v[144:145], v[144:145], 1.0 op_sel_hi:[1,0]
    v_pk_add_f32 v[146:147], v[146:147], 1.0 op_sel_hi:[1,0]
    v_pk_add_f32 v[148:149], v[148:149], 1.0 op_sel_hi:[1,0]
    v_pk_add_f32 v[150:151], v[150:151], 1.0 op_sel_hi:[1,0]
    v_rcp_f32 v144, v144
    v_rcp_f32 v145, v145
    v_rcp_f32 v146, v146
    v_rcp_f32 v147, v147
    v_rcp_f32 v148, v148
    v_rcp_f32 v149, v149
    v_rcp_f32 v150, v150
    v_rcp_f32 v151, v151
    s_nop 0
    v_pk_mul_f32 v[144:145], v[144:145], v[28:29]
    v_pk_mul_f32 v[146:147], v[146:147], v[30:31]
    v_pk_mul_f32 v[148:149], v[148:149], v[60:61]
    v_pk_mul_f32 v[150:151], v[150:151], v[62:63]
    v_cvt_pk_bf16_f32 v156, v144, v145
    v_cvt_pk_bf16_f32 v157, v146, v147
    v_cvt_pk_bf16_f32 v158, v148, v149
    v_cvt_pk_bf16_f32 v159, v150, v151
    buffer_store_dwordx4 v[156:159], v8, s[24:27], s53 offen sc1
    s_lshl_b32 s61, s79, 10
    s_add_u32 s61, s61, 37120
    s_waitcnt vmcnt(0)
    v_mov_b32 v2, 163796
    v_mov_b32 v3, 1
    s_mov_b64 exec, 1
    ds_add_rtn_u32 v14, v2, v3
    s_waitcnt lgkmcnt(0)
    v_readfirstlane_b32 s60, v14
    s_cmp_lg_u32 s60, 3
    s_cbranch_scc1 arr_38
    v_mov_b32 v3, 1
    buffer_atomic_add v3, off, s[24:27], s61 sc0 sc1
    s_waitcnt vmcnt(0)
    v_readfirstlane_b32 s60, v3
    s_cmp_lg_u32 s60, 26
    s_cbranch_scc1 arr_38
    v_mov_b32 v3, 1
    buffer_store_dword v3, off, s[24:27], s61 offset:128 sc1
arr_38:
    s_mov_b64 exec, -1
    s_mov_b32 s61, 163796
L_m2:
    s_setprio 2
    s_mul_i32 s66, s75, 20480
    s_add_u32 s66, s66, 65536
    v_mov_b32 v12, s61
    s_mov_b32 s52, s20
    s_mov_b32 s53, s21
    s_mov_b32 s54, s22
    s_mov_b32 s55, 0x20000
    s_mov_b32 s57, 31744
    s_mov_b32 s58, 35840
    s_mov_b32 s61, s66
    v_lshrrev_b32 v2, 3, v1
    v_mul_u32_u24 v2, 4096, v2
    v_bfe_u32 v3, v1, 1, 2
    v_lshrrev_b32 v10, 4, v1
    v_xor_b32 v3, v3, v10
    v_lshl_add_u32 v2, v3, 5, v2
    v_and_b32 v3, 1, v1
    v_lshl_add_u32 v8, v3, 4, v2
    v_lshlrev_b32 v9, 4, v1
    v_lshrrev_b32 v2, 2, v1
    v_lshlrev_b32 v2, 7, v2
    v_and_b32 v3, 3, v1
    v_lshl_add_u32 v2, v3, 3, v2
    v_add_u32 v2, s66, v2
    v_bfe_u32 v3, v1, 3, 2
    v_xor_b32 v10, 0, v3
    v_lshl_add_u32 v4, v10, 5, v2
    v_xor_b32 v10, 1, v3
    v_lshl_add_u32 v5, v10, 5, v2
    v_xor_b32 v10, 2, v3
    v_lshl_add_u32 v6, v10, 5, v2
    v_xor_b32 v10, 3, v3
    v_lshl_add_u32 v7, v10, 5, v2
    s_mul_i32 s67, s75, 14
    s_cmp_eq_u32 s75, 3
    s_cselect_b32 s67, 41, s67
    s_lshl_b32 s56, s67, 17
    s_lshl_b32 s65, s83, 7
    s_add_u32 s56, s56, s65
    v_lshlrev_b32 v11, 4, v1
    v_cmp_le_u32 vcc, 56, v1
    v_add_u32 v11, 512, v11
    v_add_u32 v2, 128, v11
    v_cndmask_b32 v11, v11, v2, vcc
    s_mul_i32 s59, s82, 552960
    s_mul_i32 s65, s67, 10240
    s_add_u32 s59, s59, s65
    s_add_u32 s59, s59, 16683008
    v_mov_b32 v16, 0
    v_mov_b32 v17, 0
    v_mov_b32 v18, 0
    v_mov_b32 v19, 0
    v_mov_b32 v20, 0
    v_mov_b32 v21, 0
    v_mov_b32 v22, 0
    v_mov_b32 v23, 0
    v_mov_b32 v24, 0
    v_mov_b32 v25, 0
    v_mov_b32 v26, 0
    v_mov_b32 v27, 0
    v_mov_b32 v28, 0
    v_mov_b32 v29, 0
    v_mov_b32 v30, 0
    v_mov_b32 v31, 0
    v_mov_b32 v32, 0
    v_mov_b32 v33, 0
    v_mov_b32 v34, 0
    v_mov_b32 v35, 0
    v_mov_b32 v36, 0
    v_mov_b32 v37, 0
    v_mov_b32 v38, 0
    v_mov_b32 v39, 0
    v_mov_b32 v40, 0
    v_mov_b32 v41, 0
    v_mov_b32 v42, 0
    v_mov_b32 v43, 0
    v_mov_b32 v44, 0
    v_mov_b32 v45, 0
    v_mov_b32 v46, 0
    v_mov_b32 v47, 0
    v_mov_b32 v48, 0
    v_mov_b32 v49, 0
    v_mov_b32 v50, 0
    v_mov_b32 v51, 0
    v_mov_b32 v52, 0
    v_mov_b32 v53, 0
    v_mov_b32 v54, 0
    v_mov_b32 v55, 0
    v_mov_b32 v56, 0
    v_mov_b32 v57, 0
    v_mov_b32 v58, 0
    v_mov_b32 v59, 0
    v_mov_b32 v60, 0
    v_mov_b32 v61, 0
    v_mov_b32 v62, 0
    v_mov_b32 v63, 0
    v_mov_b32 v64, 0
    v_mov_b32 v65, 0
    v_mov_b32 v66, 0
    v_mov_b32 v67, 0
    v_mov_b32 v68, 0
    v_mov_b32 v69, 0
    v_mov_b32 v70, 0
    v_mov_b32 v71, 0
    v_mov_b32 v72, 0
    v_mov_b32 v73, 0
    v_mov_b32 v74, 0
    v_mov_b32 v75, 0
    v_mov_b32 v76, 0
    v_mov_b32 v77, 0
    v_mov_b32 v78, 0
    v_mov_b32 v79, 0
    v_mov_b32 v80, 0
    v_mov_b32 v81, 0
    v_mov_b32 v82, 0
    v_mov_b32 v83, 0
    v_mov_b32 v84, 0
    v_mov_b32 v85, 0
    v_mov_b32 v86, 0
    v_mov_b32 v87, 0
    v_mov_b32 v88, 0
    v_mov_b32 v89, 0
    v_mov_b32 v90, 0
    v_mov_b32 v91, 0
    v_mov_b32 v92, 0
    v_mov_b32 v93, 0
    v_mov_b32 v94, 0
    v_mov_b32 v95, 0
    s_cmp_lg_u32 s75, 0
    s_cbranch_scc1 ww_39
    s_mov_b32 s51, 36992
    v_mov_b32 v2, 0
    s_mov_b64 exec, 1
    s_mov_b32 s47, 0x8000
gp_41:
    buffer_load_dword v3, v2, s[24:27], s51 offen sc1
    s_sub_u32 s47, s47, 1
    s_cbranch_scc1 gp_41x
    s_waitcnt vmcnt(0)
    v_cmp_ne_u32 vcc, 1, v3
    s_cbranch_vccz gp_41x
    s_sleep 2
    s_branch gp_41
gp_41x:
    s_mov_b64 exec, -1
    v_mov_b32 v2, 163804
    v_mov_b32 v3, 1
    ds_write_b32 v2, v3
    s_branch wg_40
ww_39:
    v_mov_b32 v2, 163804
    s_mov_b32 s47, 0x80000
lw_42:
    ds_read_b32 v3, v2
    s_sub_u32 s47, s47, 1
    s_cbranch_scc1 lw_42x
    s_waitcnt lgkmcnt(0)
    v_readfirstlane_b32 s60, v3
    s_cmp_ge_u32 s60, 1
    s_cbranch_scc1 lw_42x
    s_sleep 1
    s_branch lw_42
lw_42x:
wg_40:
    s_lshr_b32 s51, s20, 7
    s_add_u32 s51, s51, s83
    s_and_b32 s51, s51, 7
    s_cmp_lg_u32 s51, 3
    s_cbranch_scc1 L_now2c
    s_mov_b32 s52, s24
    s_mov_b32 s53, s25
    s_mov_b32 s54, s26
    s_movk_i32 s57, 1024
    s_movk_i32 s58, 5120
    s_lshr_b32 s51, s83, 3
    s_mul_i32 s51, s51, 54
    s_add_u32 s51, s51, s67
    s_lshl_b32 s56, s51, 13
    s_add_u32 s56, s56, 21106688
    v_and_b32 v2, 127, v8
    v_and_b32 v3, 0xffffff80, v11
    v_or_b32 v8, v2, v3
L_now2c:
    s_mov_b32 s47, 0x80000
lw_43:
    ds_read_b32 v3, v12
    s_sub_u32 s47, s47, 1
    s_cbranch_scc1 lw_43x
    s_waitcnt lgkmcnt(0)
    v_readfirstlane_b32 s60, v3
    s_cmp_ge_u32 s60, 4
    s_cbranch_scc1 lw_43x
    s_sleep 3
    s_branch lw_43
lw_43x:
    s_cmp_ge_u32 s75, 2
    s_cbranch_scc1 L_p3
    s_add_u32 m0, s61, 8192
    s_nop 0
    buffer_load_dwordx4 v8, s[52:55], s56 offen  lds
    s_add_u32 s56, s56, s57
    buffer_load_dwordx4 v8, s[52:55], s56 offen offset:1024  lds
    s_add_u32 s56, s56, s57
    buffer_load_dwordx4 v8, s[52:55], s56 offen offset:2048  lds
    s_add_u32 s56, s56, s57
    buffer_load_dwordx4 v8, s[52:55], s56 offen offset:3072  lds
    s_add_u32 s56, s56, s58
L_p3:
    s_add_u32 m0, s61, 12288
    s_nop 0
    buffer_load_dwordx4 v8, s[52:55], s56 offen  lds
    s_add_u32 s56, s56, s57
    buffer_load_dwordx4 v8, s[52:55], s56 offen offset:1024  lds
    s_add_u32 s56, s56, s57
    buffer_load_dwordx4 v8, s[52:55], s56 offen offset:2048  lds
    s_add_u32 s56, s56, s57
    buffer_load_dwordx4 v8, s[52:55], s56 offen offset:3072  lds
    s_add_u32 s56, s56, s58
    s_add_u32 m0, s61, 0
    s_nop 0
    buffer_load_dwordx4 v8, s[52:55], s56 offen  lds
    s_add_u32 s56, s56, s57
    buffer_load_dwordx4 v8, s[52:55], s56 offen offset:1024  lds
    s_add_u32 s56, s56, s57
    buffer_load_dwordx4 v8, s[52:55], s56 offen offset:2048  lds
    s_add_u32 s56, s56, s57
    buffer_load_dwordx4 v8, s[52:55], s56 offen offset:3072  lds
    s_add_u32 s56, s56, s58
    s_add_u32 m0, s61, 4096
    s_nop 0
    buffer_load_dwordx4 v8, s[52:55], s56 offen  lds
    s_add_u32 s56, s56, s57
    buffer_load_dwordx4 v8, s[52:55], s56 offen offset:1024  lds
    s_add_u32 s56, s56, s57
    buffer_load_dwordx4 v8, s[52:55], s56 offen offset:2048  lds
    s_add_u32 s56, s56, s57
    buffer_load_dwordx4 v8, s[52:55], s56 offen offset:3072  lds
    s_add_u32 s56, s56, s58
    s_cmp_ge_u32 s75, 2
    s_cbranch_scc0 L_p3b
    s_add_u32 m0, s61, 8192
    s_nop 0
    buffer_load_dwordx4 v8, s[52:55], s56 offen  lds
    s_add_u32 s56, s56, s57
    buffer_load_dwordx4 v8, s[52:55], s56 offen offset:1024  lds
    s_add_u32 s56, s56, s57
    buffer_load_dwordx4 v8, s[52:55], s56 offen offset:2048  lds
    s_add_u32 s56, s56, s57
    buffer_load_dwordx4 v8, s[52:55], s56 offen offset:3072  lds
    s_add_u32 s56, s56, s58
L_p3b:
    v_and_b32 v2, 15, v1
    v_mul_u32_u24 v12, 10, v2
    v_lshrrev_b32 v3, 5, v1
    v_add_u32 v12, v12, v3
    v_bfe_u32 v2, v1, 2, 1
    v_xor_b32 v12, v12, v2
    v_lshlrev_b32 v12, 4, v12
    v_bfe_u32 v2, v1, 4, 1
    v_mul_u32_u24 v2, 2560, v2
    v_add3_u32 v12, v12, v2, s66
    v_lshrrev_b32 v2, 4, v1
    v_and_b32 v3, 15, v1
    v_lshlrev_b32 v13, 4, v3
    v_lshl_add_u32 v13, v2, 9, v13
    v_lshlrev_b32 v14, 3, v3
    v_lshl_add_u32 v14, v2, 9, v14
    s_lshl_b32 s70, s83, 16
    s_lshl_b32 s51, s75, 13
    s_add_u32 s70, s70, s51
    s_add_u32 s70, s70, 14061568
    s_add_u32 s71, s70, 32768
    s_add_u32 s72, s70, 4096
    s_add_u32 s73, s71, 4096
    s_lshl_b32 s49, s83, 14
    s_lshl_b32 s51, s75, 11
    s_add_u32 s49, s49, s51
    s_add_u32 s49, s49, 16158720
    s_add_u32 s50, s49, 8192
    s_mul_i32 s48, s82, 102400
    s_mul_i32 s51, s75, 25600
    s_add_u32 s48, s48, s51
    s_add_u32 s48, s48, 5373952
    buffer_load_dwordx4 v[192:195], v9, s[24:27], s48 offen offset:0 sc1
    buffer_load_dwordx4 v[196:199], v9, s[24:27], s48 offen offset:1024 sc1
    buffer_load_dwordx4 v[200:203], v9, s[24:27], s48 offen offset:2048 sc1
    buffer_load_dwordx4 v[204:207], v9, s[24:27], s48 offen offset:3072 sc1
    s_add_u32 s48, s48, 4096
    buffer_load_dwordx4 v[208:211], v9, s[24:27], s48 offen offset:0 sc1
    s_add_u32 s48, s48, 1024
    buffer_load_dwordx4 v[212:215], v9, s[24:27], s48 offen offset:0 sc1
    buffer_load_dwordx4 v[216:219], v9, s[24:27], s48 offen offset:1024 sc1
    buffer_load_dwordx4 v[220:223], v9, s[24:27], s48 offen offset:2048 sc1
    buffer_load_dwordx4 v[224:227], v9, s[24:27], s48 offen offset:3072 sc1
    s_add_u32 s48, s48, 4096
    buffer_load_dwordx4 v[228:231], v9, s[24:27], s48 offen offset:0 sc1
    s_add_u32 s48, s48, 1024
    buffer_load_dwordx4 v[232:235], v9, s[24:27], s48 offen offset:0 sc1
    buffer_load_dwordx4 v[236:239], v9, s[24:27], s48 offen offset:1024 sc1
    buffer_load_dwordx4 v[240:243], v9, s[24:27], s48 offen offset:2048 sc1
    buffer_load_dwordx4 v[244:247], v9, s[24:27], s48 offen offset:3072 sc1
    s_add_u32 s48, s48, 4096
    buffer_load_dwordx4 v[248:251], v9, s[24:27], s48 offen offset:0 sc1
    s_add_u32 s48, s48, 1024
L_a_pfd:
    s_cmp_lg_u32 s75, 0
    s_cbranch_scc1 gw_44
    s_mul_i32 s51, s82, 5
    v_lshlrev_b32 v2, 2, v1
    v_add_u32 v2, s51, v2
    v_lshrrev_b32 v2, 3, v2
    v_lshlrev_b32 v2, 10, v2
    s_mov_b32 s51, 37248
    s_setprio 3
    s_mov_b64 exec, 3
    s_mov_b32 s47, 0x8000
gp_46:
    buffer_load_dword v3, v2, s[24:27], s51 offen sc1
    s_sub_u32 s47, s47, 1
    s_cbranch_scc1 gp_46x
    s_waitcnt vmcnt(0)
    v_cmp_ne_u32 vcc, 1, v3
    s_cbranch_vccz gp_46x
    s_sleep 2
    s_branch gp_46
gp_46x:
    s_mov_b64 exec, -1
    v_mov_b32 v2, 163808
    v_mov_b32 v3, 1
    ds_write_b32 v2, v3
    s_setprio 2
    s_branch gg_45
gw_44:
    v_mov_b32 v2, 163808
    s_mov_b32 s47, 0x80000
lw_47:
    ds_read_b32 v3, v2
    s_sub_u32 s47, s47, 1
    s_cbranch_scc1 lw_47x
    s_waitcnt lgkmcnt(0)
    v_readfirstlane_b32 s60, v3
    s_cmp_ge_u32 s60, 1
    s_cbranch_scc1 lw_47x
    s_sleep 1
    s_branch lw_47
lw_47x:
gg_45:
    s_mov_b32 s62, 3
    s_mov_b32 s69, 3
    s_cmp_ge_u32 s75, 2
    s_cbranch_scc1 L_d3
    s_setprio 3
    buffer_load_dwordx4 v[152:155], v11, s[24:27], s59 offen offset:0 sc1
    buffer_load_dwordx4 v[156:159], v11, s[24:27], s59 offen offset:2048 sc1
    s_add_u32 s59, s59, 4096
    buffer_load_dwordx4 v[160:163], v11, s[24:27], s59 offen offset:0 sc1
    buffer_load_dwordx4 v[164:167], v11, s[24:27], s59 offen offset:2048 sc1
    s_add_u32 s59, s59, 4096
    buffer_load_dwordx4 v[168:171], v11, s[24:27], s59 offen offset:0 sc1
    s_add_u32 s59, s59, 2048
    s_setprio 2
    buffer_load_dwordx4 v[172:175], v11, s[24:27], s59 offen offset:0 sc1
    buffer_load_dwordx4 v[176:179], v11, s[24:27], s59 offen offset:2048 sc1
    s_add_u32 s59, s59, 4096
    buffer_load_dwordx4 v[180:183], v11, s[24:27], s59 offen offset:0 sc1
    buffer_load_dwordx4 v[184:187], v11, s[24:27], s59 offen offset:2048 sc1
    s_add_u32 s59, s59, 4096
    buffer_load_dwordx4 v[188:191], v11, s[24:27], s59 offen offset:0 sc1
    s_add_u32 s59, s59, 2048
    s_setprio 1
    buffer_load_dwordx4 v[112:115], v11, s[24:27], s59 offen offset:0 sc1
    buffer_load_dwordx4 v[116:119], v11, s[24:27], s59 offen offset:2048 sc1
    s_add_u32 s59, s59, 4096
    buffer_load_dwordx4 v[120:123], v11, s[24:27], s59 offen offset:0 sc1
    buffer_load_dwordx4 v[124:127], v11, s[24:27], s59 offen offset:2048 sc1
    s_add_u32 s59, s59, 4096
    buffer_load_dwordx4 v[128:131], v11, s[24:27], s59 offen offset:0 sc1
    s_add_u32 s59, s59, 2048
    s_setprio 0
    buffer_load_dwordx4 v[132:135], v11, s[24:27], s59 offen offset:0 sc1
    buffer_load_dwordx4 v[136:139], v11, s[24:27], s59 offen offset:2048 sc1
    s_add_u32 s59, s59, 4096
    buffer_load_dwordx4 v[140:143], v11, s[24:27], s59 offen offset:0 sc1
    buffer_load_dwordx4 v[144:147], v11, s[24:27], s59 offen offset:2048 sc1
    s_add_u32 s59, s59, 4096
    buffer_load_dwordx4 v[148:151], v11, s[24:27], s59 offen offset:0 sc1
    s_add_u32 s59, s59, 2048
    s_setprio 2
    s_branch L_mb2
L_d3:
    s_setprio 3
    buffer_load_dwordx4 v[172:175], v11, s[24:27], s59 offen offset:0 sc1
    buffer_load_dwordx4 v[176:179], v11, s[24:27], s59 offen offset:2048 sc1
    s_add_u32 s59, s59, 4096
    buffer_load_dwordx4 v[180:183], v11, s[24:27], s59 offen offset:0 sc1
    buffer_load_dwordx4 v[184:187], v11, s[24:27], s59 offen offset:2048 sc1
    s_add_u32 s59, s59, 4096
    buffer_load_dwordx4 v[188:191], v11, s[24:27], s59 offen offset:0 sc1
    s_add_u32 s59, s59, 2048
    s_setprio 2
    buffer_load_dwordx4 v[112:115], v11, s[24:27], s59 offen offset:0 sc1
    buffer_load_dwordx4 v[116:119], v11, s[24:27], s59 offen offset:2048 sc1
    s_add_u32 s59, s59, 4096
    buffer_load_dwordx4 v[120:123], v11, s[24:27], s59 offen offset:0 sc1
    buffer_load_dwordx4 v[124:127], v11, s[24:27], s59 offen offset:2048 sc1
    s_add_u32 s59, s59, 4096
    buffer_load_dwordx4 v[128:131], v11, s[24:27], s59 offen offset:0 sc1
    s_add_u32 s59, s59, 2048
    s_setprio 1
    buffer_load_dwordx4 v[132:135], v11, s[24:27], s59 offen offset:0 sc1
    buffer_load_dwordx4 v[136:139], v11, s[24:27], s59 offen offset:2048 sc1
    s_add_u32 s59, s59, 4096
    buffer_load_dwordx4 v[140:143], v11, s[24:27], s59 offen offset:0 sc1
    buffer_load_dwordx4 v[144:147], v11, s[24:27], s59 offen offset:2048 sc1
    s_add_u32 s59, s59, 4096
    buffer_load_dwordx4 v[148:151], v11, s[24:27], s59 offen offset:0 sc1
    s_add_u32 s59, s59, 2048
    s_setprio 0
    buffer_load_dwordx4 v[152:155], v11, s[24:27], s59 offen offset:0 sc1
    buffer_load_dwordx4 v[156:159], v11, s[24:27], s59 offen offset:2048 sc1
    s_add_u32 s59, s59, 4096
    buffer_load_dwordx4 v[160:163], v11, s[24:27], s59 offen offset:0 sc1
    buffer_load_dwordx4 v[164:167], v11, s[24:27], s59 offen offset:2048 sc1
    s_add_u32 s59, s59, 4096
    buffer_load_dwordx4 v[168:171], v11, s[24:27], s59 offen offset:0 sc1
    s_add_u32 s59, s59, 2048
    s_setprio 2
    s_branch L_mb3
L_fw0:
    s_sub_u32 s69, s69, 1
    s_cmp_eq_u32 s69, 0
    s_cbranch_scc1 L_fw0c
    s_cmp_eq_u32 s69, 1
    s_cbranch_scc1 L_fw0b
    s_waitcnt vmcnt(15)
    s_branch L_fb0
L_fw0b:
    s_waitcnt vmcnt(19)
    s_branch L_fb0
L_fw0c:
    s_waitcnt vmcnt(23)
    s_branch L_fb0
L_fw1:
    s_sub_u32 s69, s69, 1
    s_cmp_eq_u32 s69, 0
    s_cbranch_scc1 L_fw1c
    s_cmp_eq_u32 s69, 1
    s_cbranch_scc1 L_fw1b
    s_waitcnt vmcnt(15)
    s_branch L_fb1
L_fw1b:
    s_waitcnt vmcnt(19)
    s_branch L_fb1
L_fw1c:
    s_waitcnt vmcnt(23)
    s_branch L_fb1
L_fw2:
    s_sub_u32 s69, s69, 1
    s_cmp_eq_u32 s69, 0
    s_cbranch_scc1 L_fw2c
    s_cmp_eq_u32 s69, 1
    s_cbranch_scc1 L_fw2b
    s_waitcnt vmcnt(15)
    s_branch L_fb2
L_fw2b:
    s_waitcnt vmcnt(19)
    s_branch L_fb2
L_fw2c:
    s_waitcnt vmcnt(23)
    s_branch L_fb2
L_fw3:
    s_sub_u32 s69, s69, 1
    s_cmp_eq_u32 s69, 0
    s_cbranch_scc1 L_fw3c
    s_cmp_eq_u32 s69, 1
    s_cbranch_scc1 L_fw3b
    s_waitcnt vmcnt(15)
    s_branch L_fb3
L_fw3b:
    s_waitcnt vmcnt(19)
    s_branch L_fb3
L_fw3c:
    s_waitcnt vmcnt(23)
    s_branch L_fb3
.p2align 3
L_mb0:
    s_cmp_lg_u32 s69, 0
    s_cbranch_scc1 L_fw0
L_fb0:
    s_waitcnt vmcnt(27)
    ds_read_b64_tr_b16 v[96:97], v4 offset:0
    ds_read_b64_tr_b16 v[98:99], v4 offset:2048
    ds_read_b64_tr_b16 v[100:101], v5 offset:0
    ds_read_b64_tr_b16 v[102:103], v5 offset:2048
    ds_read_b64_tr_b16 v[104:105], v6 offset:0
    ds_read_b64_tr_b16 v[106:107], v6 offset:2048
    ds_read_b64_tr_b16 v[108:109], v7 offset:0
    ds_read_b64_tr_b16 v[110:111], v7 offset:2048
    s_waitcnt lgkmcnt(0)
    s_add_u32 m0, s61, 0
    s_nop 0
    buffer_load_dwordx4 v8, s[52:55], s56 offen  lds
    s_add_u32 s56, s56, s57
    buffer_load_dwordx4 v8, s[52:55], s56 offen offset:1024  lds
    s_add_u32 s56, s56, s57
    buffer_load_dwordx4 v8, s[52:55], s56 offen offset:2048  lds
    s_add_u32 s56, s56, s57
    buffer_load_dwordx4 v8, s[52:55], s56 offen offset:3072  lds
    s_add_u32 s56, s56, s58
    v_mfma_f32_16x16x32_bf16 v[16:19], v[112:115], v[96:99], v[16:19]
    v_mfma_f32_16x16x32_bf16 v[36:39], v[112:115], v[100:103], v[36:39]
    v_mfma_f32_16x16x32_bf16 v[56:59], v[112:115], v[104:107], v[56:59]
    v_mfma_f32_16x16x32_bf16 v[76:79], v[112:115], v[108:111], v[76:79]
    buffer_load_dwordx4 v[112:115], v11, s[24:27], s59 offen offset:0 sc1
    v_mfma_f32_16x16x32_bf16 v[20:23], v[116:119], v[96:99], v[20:23]
    v_mfma_f32_16x16x32_bf16 v[40:43], v[116:119], v[100:103], v[40:43]
    v_mfma_f32_16x16x32_bf16 v[60:63], v[116:119], v[104:107], v[60:63]
    v_mfma_f32_16x16x32_bf16 v[80:83], v[116:119], v[108:111], v[80:83]
    buffer_load_dwordx4 v[116:119], v11, s[24:27], s59 offen offset:2048 sc1
    s_add_u32 s59, s59, 4096
    v_mfma_f32_16x16x32_bf16 v[24:27], v[120:123], v[96:99], v[24:27]
    v_mfma_f32_16x16x32_bf16 v[44:47], v[120:123], v[100:103], v[44:47]
    v_mfma_f32_16x16x32_bf16 v[64:67], v[120:123], v[104:107], v[64:67]
    v_mfma_f32_16x16x32_bf16 v[84:87], v[120:123], v[108:111], v[84:87]
    buffer_load_dwordx4 v[120:123], v11, s[24:27], s59 offen offset:0 sc1
    v_mfma_f32_16x16x32_bf16 v[28:31], v[124:127], v[96:99], v[28:31]
    v_mfma_f32_16x16x32_bf16 v[48:51], v[124:127], v[100:103], v[48:51]
    v_mfma_f32_16x16x32_bf16 v[68:71], v[124:127], v[104:107], v[68:71]
    v_mfma_f32_16x16x32_bf16 v[88:91], v[124:127], v[108:111], v[88:91]
    buffer_load_dwordx4 v[124:127], v11, s[24:27], s59 offen offset:2048 sc1
    s_add_u32 s59, s59, 4096
    v_mfma_f32_16x16x32_bf16 v[32:35], v[128:131], v[96:99], v[32:35]
    v_mfma_f32_16x16x32_bf16 v[52:55], v[128:131], v[100:103], v[52:55]
    v_mfma_f32_16x16x32_bf16 v[72:75], v[128:131], v[104:107], v[72:75]
    v_mfma_f32_16x16x32_bf16 v[92:95], v[128:131], v[108:111], v[92:95]
    buffer_load_dwordx4 v[128:131], v11, s[24:27], s59 offen offset:0 sc1
    s_add_u32 s59, s59, 2048
L_mb1:
    s_cmp_lg_u32 s69, 0
    s_cbranch_scc1 L_fw1
L_fb1:
    s_waitcnt vmcnt(27)
    ds_read_b64_tr_b16 v[96:97], v4 offset:4096
    ds_read_b64_tr_b16 v[98:99], v4 offset:6144
    ds_read_b64_tr_b16 v[100:101], v5 offset:4096
    ds_read_b64_tr_b16 v[102:103], v5 offset:6144
    ds_read_b64_tr_b16 v[104:105], v6 offset:4096
    ds_read_b64_tr_b16 v[106:107], v6 offset:6144
    ds_read_b64_tr_b16 v[108:109], v7 offset:4096
    ds_read_b64_tr_b16 v[110:111], v7 offset:6144
    s_waitcnt lgkmcnt(0)
    s_add_u32 m0, s61, 4096
    s_nop 0
    buffer_load_dwordx4 v8, s[52:55], s56 offen  lds
    s_add_u32 s56, s56, s57
    buffer_load_dwordx4 v8, s[52:55], s56 offen offset:1024  lds
    s_add_u32 s56, s56, s57
    buffer_load_dwordx4 v8, s[52:55], s56 offen offset:2048  lds
    s_add_u32 s56, s56, s57
    buffer_load_dwordx4 v8, s[52:55], s56 offen offset:3072  lds
    s_add_u32 s56, s56, s58
    v_mfma_f32_16x16x32_bf16 v[16:19], v[132:135], v[96:99], v[16:19]
    v_mfma_f32_16x16x32_bf16 v[36:39], v[132:135], v[100:103], v[36:39]
    v_mfma_f32_16x16x32_bf16 v[56:59], v[132:135], v[104:107], v[56:59]
    v_mfma_f32_16x16x32_bf16 v[76:79], v[132:135], v[108:111], v[76:79]
    buffer_load_dwordx4 v[132:135], v11, s[24:27], s59 offen offset:0 sc1
    v_mfma_f32_16x16x32_bf16 v[20:23], v[136:139], v[96:99], v[20:23]
    v_mfma_f32_16x16x32_bf16 v[40:43], v[136:139], v[100:103], v[40:43]
    v_mfma_f32_16x16x32_bf16 v[60:63], v[136:139], v[104:107], v[60:63]
    v_mfma_f32_16x16x32_bf16 v[80:83], v[136:139], v[108:111], v[80:83]
    buffer_load_dwordx4 v[136:139], v11, s[24:27], s59 offen offset:2048 sc1
    s_add_u32 s59, s59, 4096
    v_mfma_f32_16x16x32_bf16 v[24:27], v[140:143], v[96:99], v[24:27]
    v_mfma_f32_16x16x32_bf16 v[44:47], v[140:143], v[100:103], v[44:47]
    v_mfma_f32_16x16x32_bf16 v[64:67], v[140:143], v[104:107], v[64:67]
    v_mfma_f32_16x16x32_bf16 v[84:87], v[140:143], v[108:111], v[84:87]
    buffer_load_dwordx4 v[140:143], v11, s[24:27], s59 offen offset:0 sc1
    v_mfma_f32_16x16x32_bf16 v[28:31], v[144:147], v[96:99], v[28:31]
    v_mfma_f32_16x16x32_bf16 v[48:51], v[144:147], v[100:103], v[48:51]
    v_mfma_f32_16x16x32_bf16 v[68:71], v[144:147], v[104:107], v[68:71]
    v_mfma_f32_16x16x32_bf16 v[88:91], v[144:147], v[108:111], v[88:91]
    buffer_load_dwordx4 v[144:147], v11, s[24:27], s59 offen offset:2048 sc1
    s_add_u32 s59, s59, 4096
    v_mfma_f32_16x16x32_bf16 v[32:35], v[148:151], v[96:99], v[32:35]
    v_mfma_f32_16x16x32_bf16 v[52:55], v[148:151], v[100:103], v[52:55]
    v_mfma_f32_16x16x32_bf16 v[72:75], v[148:151], v[104:107], v[72:75]
    v_mfma_f32_16x16x32_bf16 v[92:95], v[148:151], v[108:111], v[92:95]
    buffer_load_dwordx4 v[148:151], v11, s[24:27], s59 offen offset:0 sc1
    s_add_u32 s59, s59, 2048
L_mb2:
    s_cmp_lg_u32 s69, 0
    s_cbranch_scc1 L_fw2
L_fb2:
    s_waitcnt vmcnt(27)
    ds_read_b64_tr_b16 v[96:97], v4 offset:8192
    ds_read_b64_tr_b16 v[98:99], v4 offset:10240
    ds_read_b64_tr_b16 v[100:101], v5 offset:8192
    ds_read_b64_tr_b16 v[102:103], v5 offset:10240
    ds_read_b64_tr_b16 v[104:105], v6 offset:8192
    ds_read_b64_tr_b16 v[106:107], v6 offset:10240
    ds_read_b64_tr_b16 v[108:109], v7 offset:8192
    ds_read_b64_tr_b16 v[110:111], v7 offset:10240
    s_waitcnt lgkmcnt(0)
    s_add_u32 m0, s61, 8192
    s_nop 0
    buffer_load_dwordx4 v8, s[52:55], s56 offen  lds
    s_add_u32 s56, s56, s57
    buffer_load_dwordx4 v8, s[52:55], s56 offen offset:1024  lds
    s_add_u32 s56, s56, s57
    buffer_load_dwordx4 v8, s[52:55], s56 offen offset:2048  lds
    s_add_u32 s56, s56, s57
    buffer_load_dwordx4 v8, s[52:55], s56 offen offset:3072  lds
    s_add_u32 s56, s56, s58
    v_mfma_f32_16x16x32_bf16 v[16:19], v[152:155], v[96:99], v[16:19]
    v_mfma_f32_16x16x32_bf16 v[36:39], v[152:155], v[100:103], v[36:39]
    v_mfma_f32_16x16x32_bf16 v[56:59], v[152:155], v[104:107], v[56:59]
    v_mfma_f32_16x16x32_bf16 v[76:79], v[152:155], v[108:111], v[76:79]
    buffer_load_dwordx4 v[152:155], v11, s[24:27], s59 offen offset:0 sc1
    v_mfma_f32_16x16x32_bf16 v[20:23], v[156:159], v[96:99], v[20:23]
    v_mfma_f32_16x16x32_bf16 v[40:43], v[156:159], v[100:103], v[40:43]
    v_mfma_f32_16x16x32_bf16 v[60:63], v[156:159], v[104:107], v[60:63]
    v_mfma_f32_16x16x32_bf16 v[80:83], v[156:159], v[108:111], v[80:83]
    buffer_load_dwordx4 v[156:159], v11, s[24:27], s59 offen offset:2048 sc1
    s_add_u32 s59, s59, 4096
    v_mfma_f32_16x16x32_bf16 v[24:27], v[160:163], v[96:99], v[24:27]
    v_mfma_f32_16x16x32_bf16 v[44:47], v[160:163], v[100:103], v[44:47]
    v_mfma_f32_16x16x32_bf16 v[64:67], v[160:163], v[104:107], v[64:67]
    v_mfma_f32_16x16x32_bf16 v[84:87], v[160:163], v[108:111], v[84:87]
    buffer_load_dwordx4 v[160:163], v11, s[24:27], s59 offen offset:0 sc1
    v_mfma_f32_16x16x32_bf16 v[28:31], v[164:167], v[96:99], v[28:31]
    v_mfma_f32_16x16x32_bf16 v[48:51], v[164:167], v[100:103], v[48:51]
    v_mfma_f32_16x16x32_bf16 v[68:71], v[164:167], v[104:107], v[68:71]
    v_mfma_f32_16x16x32_bf16 v[88:91], v[164:167], v[108:111], v[88:91]
    buffer_load_dwordx4 v[164:167], v11, s[24:27], s59 offen offset:2048 sc1
    s_add_u32 s59, s59, 4096
    v_mfma_f32_16x16x32_bf16 v[32:35], v[168:171], v[96:99], v[32:35]
    v_mfma_f32_16x16x32_bf16 v[52:55], v[168:171], v[100:103], v[52:55]
    v_mfma_f32_16x16x32_bf16 v[72:75], v[168:171], v[104:107], v[72:75]
    v_mfma_f32_16x16x32_bf16 v[92:95], v[168:171], v[108:111], v[92:95]
    buffer_load_dwordx4 v[168:171], v11, s[24:27], s59 offen offset:0 sc1
    s_add_u32 s59, s59, 2048
L_mb3:
    s_cmp_lg_u32 s69, 0
    s_cbranch_scc1 L_fw3
L_fb3:
    s_waitcnt vmcnt(27)
    ds_read_b64_tr_b16 v[96:97], v4 offset:12288
    ds_read_b64_tr_b16 v[98:99], v4 offset:14336
    ds_read_b64_tr_b16 v[100:101], v5 offset:12288
    ds_read_b64_tr_b16 v[102:103], v5 offset:14336
    ds_read_b64_tr_b16 v[104:105], v6 offset:12288
    ds_read_b64_tr_b16 v[106:107], v6 offset:14336
    ds_read_b64_tr_b16 v[108:109], v7 offset:12288
    ds_read_b64_tr_b16 v[110:111], v7 offset:14336
    s_waitcnt lgkmcnt(0)
    s_add_u32 m0, s61, 12288
    s_nop 0
    buffer_load_dwordx4 v8, s[52:55], s56 offen  lds
    s_add_u32 s56, s56, s57
    buffer_load_dwordx4 v8, s[52:55], s56 offen offset:1024  lds
    s_add_u32 s56, s56, s57
    buffer_load_dwordx4 v8, s[52:55], s56 offen offset:2048  lds
    s_add_u32 s56, s56, s57
    buffer_load_dwordx4 v8, s[52:55], s56 offen offset:3072  lds
    s_add_u32 s56, s56, s58
    v_mfma_f32_16x16x32_bf16 v[16:19], v[172:175], v[96:99], v[16:19]
    v_mfma_f32_16x16x32_bf16 v[36:39], v[172:175], v[100:103], v[36:39]
    v_mfma_f32_16x16x32_bf16 v[56:59], v[172:175], v[104:107], v[56:59]
    v_mfma_f32_16x16x32_bf16 v[76:79], v[172:175], v[108:111], v[76:79]
    buffer_load_dwordx4 v[172:175], v11, s[24:27], s59 offen offset:0 sc1
    v_mfma_f32_16x16x32_bf16 v[20:23], v[176:179], v[96:99], v[20:23]
    v_mfma_f32_16x16x32_bf16 v[40:43], v[176:179], v[100:103], v[40:43]
    v_mfma_f32_16x16x32_bf16 v[60:63], v[176:179], v[104:107], v[60:63]
    v_mfma_f32_16x16x32_bf16 v[80:83], v[176:179], v[108:111], v[80:83]
    buffer_load_dwordx4 v[176:179], v11, s[24:27], s59 offen offset:2048 sc1
    s_add_u32 s59, s59, 4096
    v_mfma_f32_16x16x32_bf16 v[24:27], v[180:183], v[96:99], v[24:27]
    v_mfma_f32_16x16x32_bf16 v[44:47], v[180:183], v[100:103], v[44:47]
    v_mfma_f32_16x16x32_bf16 v[64:67], v[180:183], v[104:107], v[64:67]
    v_mfma_f32_16x16x32_bf16 v[84:87], v[180:183], v[108:111], v[84:87]
    buffer_load_dwordx4 v[180:183], v11, s[24:27], s59 offen offset:0 sc1
    v_mfma_f32_16x16x32_bf16 v[28:31], v[184:187], v[96:99], v[28:31]
    v_mfma_f32_16x16x32_bf16 v[48:51], v[184:187], v[100:103], v[48:51]
    v_mfma_f32_16x16x32_bf16 v[68:71], v[184:187], v[104:107], v[68:71]
    v_mfma_f32_16x16x32_bf16 v[88:91], v[184:187], v[108:111], v[88:91]
    buffer_load_dwordx4 v[184:187], v11, s[24:27], s59 offen offset:2048 sc1
    s_add_u32 s59, s59, 4096
    v_mfma_f32_16x16x32_bf16 v[32:35], v[188:191], v[96:99], v[32:35]
    v_mfma_f32_16x16x32_bf16 v[52:55], v[188:191], v[100:103], v[52:55]
    v_mfma_f32_16x16x32_bf16 v[72:75], v[188:191], v[104:107], v[72:75]
    v_mfma_f32_16x16x32_bf16 v[92:95], v[188:191], v[108:111], v[92:95]
    buffer_load_dwordx4 v[188:191], v11, s[24:27], s59 offen offset:0 sc1
    s_add_u32 s59, s59, 2048
    s_sub_u32 s62, s62, 1
    s_cmp_lg_u32 s62, 0
    s_cbranch_scc1 L_mb0
    v_mov_b32 v2, 163812
    ds_read_b32 v15, v2
    s_waitcnt vmcnt(27)
    ds_read_b64_tr_b16 v[96:97], v4 offset:0
    ds_read_b64_tr_b16 v[98:99], v4 offset:2048
    ds_read_b64_tr_b16 v[100:101], v5 offset:0
    ds_read_b64_tr_b16 v[102:103], v5 offset:2048
    ds_read_b64_tr_b16 v[104:105], v6 offset:0
    ds_read_b64_tr_b16 v[106:107], v6 offset:2048
    ds_read_b64_tr_b16 v[108:109], v7 offset:0
    ds_read_b64_tr_b16 v[110:111], v7 offset:2048
    s_waitcnt lgkmcnt(0)
    v_mfma_f32_16x16x32_bf16 v[16:19], v[112:115], v[96:99], v[16:19]
    v_mfma_f32_16x16x32_bf16 v[36:39], v[112:115], v[100:103], v[36:39]
    v_mfma_f32_16x16x32_bf16 v[56:59], v[112:115], v[104:107], v[56:59]
    v_mfma_f32_16x16x32_bf16 v[76:79], v[112:115], v[108:111], v[76:79]
    v_mfma_f32_16x16x32_bf16 v[20:23], v[116:119], v[96:99], v[20:23]
    v_mfma_f32_16x16x32_bf16 v[40:43], v[116:119], v[100:103], v[40:43]
    v_mfma_f32_16x16x32_bf16 v[60:63], v[116:119], v[104:107], v[60:63]
    v_mfma_f32_16x16x32_bf16 v[80:83], v[116:119], v[108:111], v[80:83]
    v_mfma_f32_16x16x32_bf16 v[24:27], v[120:123], v[96:99], v[24:27]
    v_mfma_f32_16x16x32_bf16 v[44:47], v[120:123], v[100:103], v[44:47]
    v_mfma_f32_16x16x32_bf16 v[64:67], v[120:123], v[104:107], v[64:67]
    v_mfma_f32_16x16x32_bf16 v[84:87], v[120:123], v[108:111], v[84:87]
    v_mfma_f32_16x16x32_bf16 v[28:31], v[124:127], v[96:99], v[28:31]
    v_mfma_f32_16x16x32_bf16 v[48:51], v[124:127], v[100:103], v[48:51]
    v_mfma_f32_16x16x32_bf16 v[68:71], v[124:127], v[104:107], v[68:71]
    v_mfma_f32_16x16x32_bf16 v[88:91], v[124:127], v[108:111], v[88:91]
    v_mfma_f32_16x16x32_bf16 v[32:35], v[128:131], v[96:99], v[32:35]
    v_mfma_f32_16x16x32_bf16 v[52:55], v[128:131], v[100:103], v[52:55]
    v_mfma_f32_16x16x32_bf16 v[72:75], v[128:131], v[104:107], v[72:75]
    v_mfma_f32_16x16x32_bf16 v[92:95], v[128:131], v[108:111], v[92:95]
    v_readfirstlane_b32 s60, v15
    s_cmp_eq_u32 s60, 0
    s_cbranch_scc1 L_olate
    buffer_load_dwordx4 v[112:115], v13, s[24:27], s70 offen offset:0 sc1
    buffer_load_dwordx4 v[116:119], v13, s[24:27], s70 offen offset:256 sc1
    buffer_load_dwordx4 v[120:123], v13, s[24:27], s71 offen offset:0 sc1
    buffer_load_dwordx4 v[124:127], v13, s[24:27], s71 offen offset:256 sc1
    s_waitcnt vmcnt(22)
    ds_read_b64_tr_b16 v[96:97], v4 offset:4096
    ds_read_b64_tr_b16 v[98:99], v4 offset:6144
    ds_read_b64_tr_b16 v[100:101], v5 offset:4096
    ds_read_b64_tr_b16 v[102:103], v5 offset:6144
    ds_read_b64_tr_b16 v[104:105], v6 offset:4096
    ds_read_b64_tr_b16 v[106:107], v6 offset:6144
    ds_read_b64_tr_b16 v[108:109], v7 offset:4096
    ds_read_b64_tr_b16 v[110:111], v7 offset:6144
    s_waitcnt lgkmcnt(0)
    v_mfma_f32_16x16x32_bf16 v[16:19], v[132:135], v[96:99], v[16:19]
    v_mfma_f32_16x16x32_bf16 v[36:39], v[132:135], v[100:103], v[36:39]
    v_mfma_f32_16x16x32_bf16 v[56:59], v[132:135], v[104:107], v[56:59]
    v_mfma_f32_16x16x32_bf16 v[76:79], v[132:135], v[108:111], v[76:79]
    v_mfma_f32_16x16x32_bf16 v[20:23], v[136:139], v[96:99], v[20:23]
    v_mfma_f32_16x16x32_bf16 v[40:43], v[136:139], v[100:103], v[40:43]
    v_mfma_f32_16x16x32_bf16 v[60:63], v[136:139], v[104:107], v[60:63]
    v_mfma_f32_16x16x32_bf16 v[80:83], v[136:139], v[108:111], v[80:83]
    v_mfma_f32_16x16x32_bf16 v[24:27], v[140:143], v[96:99], v[24:27]
    v_mfma_f32_16x16x32_bf16 v[44:47], v[140:143], v[100:103], v[44:47]
    v_mfma_f32_16x16x32_bf16 v[64:67], v[140:143], v[104:107], v[64:67]
    v_mfma_f32_16x16x32_bf16 v[84:87], v[140:143], v[108:111], v[84:87]
    v_mfma_f32_16x16x32_bf16 v[28:31], v[144:147], v[96:99], v[28:31]
    v_mfma_f32_16x16x32_bf16 v[48:51], v[144:147], v[100:103], v[48:51]
    v_mfma_f32_16x16x32_bf16 v[68:71], v[144:147], v[104:107], v[68:71]
    v_mfma_f32_16x16x32_bf16 v[88:91], v[144:147], v[108:111], v[88:91]
    v_mfma_f32_16x16x32_bf16 v[32:35], v[148:151], v[96:99], v[32:35]
    v_mfma_f32_16x16x32_bf16 v[52:55], v[148:151], v[100:103], v[52:55]
    v_mfma_f32_16x16x32_bf16 v[72:75], v[148:151], v[104:107], v[72:75]
    v_mfma_f32_16x16x32_bf16 v[92:95], v[148:151], v[108:111], v[92:95]
    buffer_load_dwordx4 v[132:135], v13, s[24:27], s70 offen offset:2048 sc1
    buffer_load_dwordx4 v[136:139], v13, s[24:27], s70 offen offset:2304 sc1
    buffer_load_dwordx4 v[140:143], v13, s[24:27], s71 offen offset:2048 sc1
    buffer_load_dwordx4 v[144:147], v13, s[24:27], s71 offen offset:2304 sc1
    s_waitcnt vmcnt(17)
    ds_read_b64_tr_b16 v[96:97], v4 offset:8192
    ds_read_b64_tr_b16 v[98:99], v4 offset:10240
    ds_read_b64_tr_b16 v[100:101], v5 offset:8192
    ds_read_b64_tr_b16 v[102:103], v5 offset:10240
    ds_read_b64_tr_b16 v[104:105], v6 offset:8192
    ds_read_b64_tr_b16 v[106:107], v6 offset:10240
    ds_read_b64_tr_b16 v[108:109], v7 offset:8192
    ds_read_b64_tr_b16 v[110:111], v7 offset:10240
    s_waitcnt lgkmcnt(0)
    v_mfma_f32_16x16x32_bf16 v[16:19], v[152:155], v[96:99], v[16:19]
    v_mfma_f32_16x16x32_bf16 v[36:39], v[152:155], v[100:103], v[36:39]
    v_mfma_f32_16x16x32_bf16 v[56:59], v[152:155], v[104:107], v[56:59]
    v_mfma_f32_16x16x32_bf16 v[76:79], v[152:155], v[108:111], v[76:79]
    v_mfma_f32_16x16x32_bf16 v[20:23], v[156:159], v[96:99], v[20:23]
    v_mfma_f32_16x16x32_bf16 v[40:43], v[156:159], v[100:103], v[40:43]
    v_mfma_f32_16x16x32_bf16 v[60:63], v[156:159], v[104:107], v[60:63]
    v_mfma_f32_16x16x32_bf16 v[80:83], v[156:159], v[108:111], v[80:83]
    v_mfma_f32_16x16x32_bf16 v[24:27], v[160:163], v[96:99], v[24:27]
    v_mfma_f32_16x16x32_bf16 v[44:47], v[160:163], v[100:103], v[44:47]
    v_mfma_f32_16x16x32_bf16 v[64:67], v[160:163], v[104:107], v[64:67]
    v_mfma_f32_16x16x32_bf16 v[84:87], v[160:163], v[108:111], v[84:87]
    v_mfma_f32_16x16x32_bf16 v[28:31], v[164:167], v[96:99], v[28:31]
    v_mfma_f32_16x16x32_bf16 v[48:51], v[164:167], v[100:103], v[48:51]
    v_mfma_f32_16x16x32_bf16 v[68:71], v[164:167], v[104:107], v[68:71]
    v_mfma_f32_16x16x32_bf16 v[88:91], v[164:167], v[108:111], v[88:91]
    v_mfma_f32_16x16x32_bf16 v[32:35], v[168:171], v[96:99], v[32:35]
    v_mfma_f32_16x16x32_bf16 v[52:55], v[168:171], v[100:103], v[52:55]
    v_mfma_f32_16x16x32_bf16 v[72:75], v[168:171], v[104:107], v[72:75]
    v_mfma_f32_16x16x32_bf16 v[92:95], v[168:171], v[108:111], v[92:95]
    buffer_load_dwordx4 v[152:155], v13, s[24:27], s72 offen offset:0 sc1
    buffer_load_dwordx4 v[156:159], v13, s[24:27], s72 offen offset:256 sc1
    buffer_load_dwordx4 v[160:163], v13, s[24:27], s73 offen offset:0 sc1
    buffer_load_dwordx4 v[164:167], v13, s[24:27], s73 offen offset:256 sc1
    s_waitcnt vmcnt(12)
    ds_read_b64_tr_b16 v[96:97], v4 offset:12288
    ds_read_b64_tr_b16 v[98:99], v4 offset:14336
    ds_read_b64_tr_b16 v[100:101], v5 offset:12288
    ds_read_b64_tr_b16 v[102:103], v5 offset:14336
    ds_read_b64_tr_b16 v[104:105], v6 offset:12288
    ds_read_b64_tr_b16 v[106:107], v6 offset:14336
    ds_read_b64_tr_b16 v[108:109], v7 offset:12288
    ds_read_b64_tr_b16 v[110:111], v7 offset:14336
    s_waitcnt lgkmcnt(0)
    v_mfma_f32_16x16x32_bf16 v[16:19], v[172:175], v[96:99], v[16:19]
    v_mfma_f32_16x16x32_bf16 v[36:39], v[172:175], v[100:103], v[36:39]
    v_mfma_f32_16x16x32_bf16 v[56:59], v[172:175], v[104:107], v[56:59]
    v_mfma_f32_16x16x32_bf16 v[76:79], v[172:175], v[108:111], v[76:79]
    v_mfma_f32_16x16x32_bf16 v[20:23], v[176:179], v[96:99], v[20:23]
    v_mfma_f32_16x16x32_bf16 v[40:43], v[176:179], v[100:103], v[40:43]
    v_mfma_f32_16x16x32_bf16 v[60:63], v[176:179], v[104:107], v[60:63]
    v_mfma_f32_16x16x32_bf16 v[80:83], v[176:179], v[108:111], v[80:83]
    v_mfma_f32_16x16x32_bf16 v[24:27], v[180:183], v[96:99], v[24:27]
    v_mfma_f32_16x16x32_bf16 v[44:47], v[180:183], v[100:103], v[44:47]
    v_mfma_f32_16x16x32_bf16 v[64:67], v[180:183], v[104:107], v[64:67]
    v_mfma_f32_16x16x32_bf16 v[84:87], v[180:183], v[108:111], v[84:87]
    v_mfma_f32_16x16x32_bf16 v[28:31], v[184:187], v[96:99], v[28:31]
    v_mfma_f32_16x16x32_bf16 v[48:51], v[184:187], v[100:103], v[48:51]
    v_mfma_f32_16x16x32_bf16 v[68:71], v[184:187], v[104:107], v[68:71]
    v_mfma_f32_16x16x32_bf16 v[88:91], v[184:187], v[108:111], v[88:91]
    v_mfma_f32_16x16x32_bf16 v[32:35], v[188:191], v[96:99], v[32:35]
    v_mfma_f32_16x16x32_bf16 v[52:55], v[188:191], v[100:103], v[52:55]
    v_mfma_f32_16x16x32_bf16 v[72:75], v[188:191], v[104:107], v[72:75]
    v_mfma_f32_16x16x32_bf16 v[92:95], v[188:191], v[108:111], v[92:95]
    buffer_load_dwordx4 v[172:175], v13, s[24:27], s72 offen offset:2048 sc1
    buffer_load_dwordx4 v[176:179], v13, s[24:27], s72 offen offset:2304 sc1
    buffer_load_dwordx4 v[180:183], v13, s[24:27], s73 offen offset:2048 sc1
    buffer_load_dwordx4 v[184:187], v13, s[24:27], s73 offen offset:2304 sc1
L_wo:
    s_waitcnt vmcnt(12)
    v_mfma_f32_16x16x32_bf16 v[16:19], v[192:195], v[112:115], v[16:19]
    v_mfma_f32_16x16x32_bf16 v[36:39], v[192:195], v[116:119], v[36:39]
    v_mfma_f32_16x16x32_bf16 v[56:59], v[192:195], v[120:123], v[56:59]
    v_mfma_f32_16x16x32_bf16 v[76:79], v[192:195], v[124:127], v[76:79]
    v_mfma_f32_16x16x32_bf16 v[20:23], v[196:199], v[112:115], v[20:23]
    v_mfma_f32_16x16x32_bf16 v[40:43], v[196:199], v[116:119], v[40:43]
    v_mfma_f32_16x16x32_bf16 v[60:63], v[196:199], v[120:123], v[60:63]
    v_mfma_f32_16x16x32_bf16 v[80:83], v[196:199], v[124:127], v[80:83]
    v_mfma_f32_16x16x32_bf16 v[24:27], v[200:203], v[112:115], v[24:27]
    v_mfma_f32_16x16x32_bf16 v[44:47], v[200:203], v[116:119], v[44:47]
    v_mfma_f32_16x16x32_bf16 v[64:67], v[200:203], v[120:123], v[64:67]
    v_mfma_f32_16x16x32_bf16 v[84:87], v[200:203], v[124:127], v[84:87]
    v_mfma_f32_16x16x32_bf16 v[28:31], v[204:207], v[112:115], v[28:31]
    v_mfma_f32_16x16x32_bf16 v[48:51], v[204:207], v[116:119], v[48:51]
    v_mfma_f32_16x16x32_bf16 v[68:71], v[204:207], v[120:123], v[68:71]
    v_mfma_f32_16x16x32_bf16 v[88:91], v[204:207], v[124:127], v[88:91]
    v_mfma_f32_16x16x32_bf16 v[32:35], v[208:211], v[112:115], v[32:35]
    v_mfma_f32_16x16x32_bf16 v[52:55], v[208:211], v[116:119], v[52:55]
    v_mfma_f32_16x16x32_bf16 v[72:75], v[208:211], v[120:123], v[72:75]
    v_mfma_f32_16x16x32_bf16 v[92:95], v[208:211], v[124:127], v[92:95]
    buffer_load_dwordx4 v[192:195], v9, s[24:27], s48 offen offset:0 sc1
    buffer_load_dwordx4 v[196:199], v9, s[24:27], s48 offen offset:1024 sc1
    buffer_load_dwordx4 v[200:203], v9, s[24:27], s48 offen offset:2048 sc1
    buffer_load_dwordx4 v[204:207], v9, s[24:27], s48 offen offset:3072 sc1
    s_add_u32 s48, s48, 4096
    buffer_load_dwordx4 v[208:211], v9, s[24:27], s48 offen offset:0 sc1
    s_add_u32 s48, s48, 1024
    buffer_load_dwordx2 v[112:113], v14, s[24:27], s49 offen offset:0 sc1
    buffer_load_dwordx2 v[114:115], v14, s[24:27], s49 offen offset:256 sc1
    buffer_load_dwordx2 v[116:117], v14, s[24:27], s49 offen offset:128 sc1
    buffer_load_dwordx2 v[118:119], v14, s[24:27], s49 offen offset:384 sc1
    buffer_load_dwordx2 v[120:121], v14, s[24:27], s50 offen offset:0 sc1
    buffer_load_dwordx2 v[122:123], v14, s[24:27], s50 offen offset:256 sc1
    buffer_load_dwordx2 v[124:125], v14, s[24:27], s50 offen offset:128 sc1
    buffer_load_dwordx2 v[126:127], v14, s[24:27], s50 offen offset:384 sc1
    s_waitcnt vmcnt(21)
    v_mfma_f32_16x16x32_bf16 v[16:19], v[212:215], v[132:135], v[16:19]
    v_mfma_f32_16x16x32_bf16 v[36:39], v[212:215], v[136:139], v[36:39]
    v_mfma_f32_16x16x32_bf16 v[56:59], v[212:215], v[140:143], v[56:59]
    v_mfma_f32_16x16x32_bf16 v[76:79], v[212:215], v[144:147], v[76:79]
    v_mfma_f32_16x16x32_bf16 v[20:23], v[216:219], v[132:135], v[20:23]
    v_mfma_f32_16x16x32_bf16 v[40:43], v[216:219], v[136:139], v[40:43]
    v_mfma_f32_16x16x32_bf16 v[60:63], v[216:219], v[140:143], v[60:63]
    v_mfma_f32_16x16x32_bf16 v[80:83], v[216:219], v[144:147], v[80:83]
    v_mfma_f32_16x16x32_bf16 v[24:27], v[220:223], v[132:135], v[24:27]
    v_mfma_f32_16x16x32_bf16 v[44:47], v[220:223], v[136:139], v[44:47]
    v_mfma_f32_16x16x32_bf16 v[64:67], v[220:223], v[140:143], v[64:67]
    v_mfma_f32_16x16x32_bf16 v[84:87], v[220:223], v[144:147], v[84:87]
    v_mfma_f32_16x16x32_bf16 v[28:31], v[224:227], v[132:135], v[28:31]
    v_mfma_f32_16x16x32_bf16 v[48:51], v[224:227], v[136:139], v[48:51]
    v_mfma_f32_16x16x32_bf16 v[68:71], v[224:227], v[140:143], v[68:71]
    v_mfma_f32_16x16x32_bf16 v[88:91], v[224:227], v[144:147], v[88:91]
    v_mfma_f32_16x16x32_bf16 v[32:35], v[228:231], v[132:135], v[32:35]
    v_mfma_f32_16x16x32_bf16 v[52:55], v[228:231], v[136:139], v[52:55]
    v_mfma_f32_16x16x32_bf16 v[72:75], v[228:231], v[140:143], v[72:75]
    v_mfma_f32_16x16x32_bf16 v[92:95], v[228:231], v[144:147], v[92:95]
    buffer_load_dwordx4 v[212:215], v9, s[24:27], s48 offen offset:0 sc1
    buffer_load_dwordx4 v[216:219], v9, s[24:27], s48 offen offset:1024 sc1
    buffer_load_dwordx4 v[220:223], v9, s[24:27], s48 offen offset:2048 sc1
    buffer_load_dwordx4 v[224:227], v9, s[24:27], s48 offen offset:3072 sc1
    s_add_u32 s48, s48, 4096
    buffer_load_dwordx4 v[228:231], v9, s[24:27], s48 offen offset:0 sc1
    s_add_u32 s48, s48, 1024
    s_waitcnt vmcnt(22)
    v_mfma_f32_16x16x32_bf16 v[16:19], v[232:235], v[152:155], v[16:19]
    v_mfma_f32_16x16x32_bf16 v[36:39], v[232:235], v[156:159], v[36:39]
    v_mfma_f32_16x16x32_bf16 v[56:59], v[232:235], v[160:163], v[56:59]
    v_mfma_f32_16x16x32_bf16 v[76:79], v[232:235], v[164:167], v[76:79]
    v_mfma_f32_16x16x32_bf16 v[20:23], v[236:239], v[152:155], v[20:23]
    v_mfma_f32_16x16x32_bf16 v[40:43], v[236:239], v[156:159], v[40:43]
    v_mfma_f32_16x16x32_bf16 v[60:63], v[236:239], v[160:163], v[60:63]
    v_mfma_f32_16x16x32_bf16 v[80:83], v[236:239], v[164:167], v[80:83]
    v_mfma_f32_16x16x32_bf16 v[24:27], v[240:243], v[152:155], v[24:27]
    v_mfma_f32_16x16x32_bf16 v[44:47], v[240:243], v[156:159], v[44:47]
    v_mfma_f32_16x16x32_bf16 v[64:67], v[240:243], v[160:163], v[64:67]
    v_mfma_f32_16x16x32_bf16 v[84:87], v[240:243], v[164:167], v[84:87]
    v_mfma_f32_16x16x32_bf16 v[28:31], v[244:247], v[152:155], v[28:31]
    v_mfma_f32_16x16x32_bf16 v[48:51], v[244:247], v[156:159], v[48:51]
    v_mfma_f32_16x16x32_bf16 v[68:71], v[244:247], v[160:163], v[68:71]
    v_mfma_f32_16x16x32_bf16 v[88:91], v[244:247], v[164:167], v[88:91]
    v_mfma_f32_16x16x32_bf16 v[32:35], v[248:251], v[152:155], v[32:35]
    v_mfma_f32_16x16x32_bf16 v[52:55], v[248:251], v[156:159], v[52:55]
    v_mfma_f32_16x16x32_bf16 v[72:75], v[248:251], v[160:163], v[72:75]
    v_mfma_f32_16x16x32_bf16 v[92:95], v[248:251], v[164:167], v[92:95]
    s_waitcnt vmcnt(13)
    v_mfma_f32_16x16x32_bf16 v[16:19], v[192:195], v[172:175], v[16:19]
    v_mfma_f32_16x16x32_bf16 v[36:39], v[192:195], v[176:179], v[36:39]
    v_mfma_f32_16x16x32_bf16 v[56:59], v[192:195], v[180:183], v[56:59]
    v_mfma_f32_16x16x32_bf16 v[76:79], v[192:195], v[184:187], v[76:79]
    v_mfma_f32_16x16x32_bf16 v[20:23], v[196:199], v[172:175], v[20:23]
    v_mfma_f32_16x16x32_bf16 v[40:43], v[196:199], v[176:179], v[40:43]
    v_mfma_f32_16x16x32_bf16 v[60:63], v[196:199], v[180:183], v[60:63]
    v_mfma_f32_16x16x32_bf16 v[80:83], v[196:199], v[184:187], v[80:83]
    v_mfma_f32_16x16x32_bf16 v[24:27], v[200:203], v[172:175], v[24:27]
    v_mfma_f32_16x16x32_bf16 v[44:47], v[200:203], v[176:179], v[44:47]
    v_mfma_f32_16x16x32_bf16 v[64:67], v[200:203], v[180:183], v[64:67]
    v_mfma_f32_16x16x32_bf16 v[84:87], v[200:203], v[184:187], v[84:87]
    v_mfma_f32_16x16x32_bf16 v[28:31], v[204:207], v[172:175], v[28:31]
    v_mfma_f32_16x16x32_bf16 v[48:51], v[204:207], v[176:179], v[48:51]
    v_mfma_f32_16x16x32_bf16 v[68:71], v[204:207], v[180:183], v[68:71]
    v_mfma_f32_16x16x32_bf16 v[88:91], v[204:207], v[184:187], v[88:91]
    v_mfma_f32_16x16x32_bf16 v[32:35], v[208:211], v[172:175], v[32:35]
    v_mfma_f32_16x16x32_bf16 v[52:55], v[208:211], v[176:179], v[52:55]
    v_mfma_f32_16x16x32_bf16 v[72:75], v[208:211], v[180:183], v[72:75]
    v_mfma_f32_16x16x32_bf16 v[92:95], v[208:211], v[184:187], v[92:95]
    s_waitcnt vmcnt(0)
    s_setprio 3
    v_mfma_f32_16x16x32_bf16 v[16:19], v[212:215], v[112:115], v[16:19]
    v_mfma_f32_16x16x32_bf16 v[36:39], v[212:215], v[116:119], v[36:39]
    v_mfma_f32_16x16x32_bf16 v[56:59], v[212:215], v[120:123], v[56:59]
    v_mfma_f32_16x16x32_bf16 v[76:79], v[212:215], v[124:127], v[76:79]
    v_mfma_f32_16x16x32_bf16 v[20:23], v[216:219], v[112:115], v[20:23]
    v_mfma_f32_16x16x32_bf16 v[40:43], v[216:219], v[116:119], v[40:43]
    s_nop 3
    ds_write_b128 v12, v[16:19] offset:0
    v_mfma_f32_16x16x32_bf16 v[60:63], v[216:219], v[120:123], v[60:63]
    ds_write_b128 v12, v[36:39] offset:5120
    v_mfma_f32_16x16x32_bf16 v[80:83], v[216:219], v[124:127], v[80:83]
    ds_write_b128 v12, v[56:59] offset:10240
    v_mfma_f32_16x16x32_bf16 v[24:27], v[220:223], v[112:115], v[24:27]
    ds_write_b128 v12, v[76:79] offset:15360
    v_mfma_f32_16x16x32_bf16 v[44:47], v[220:223], v[116:119], v[44:47]
    ds_write_b128 v12, v[20:23] offset:32
    v_mfma_f32_16x16x32_bf16 v[64:67], v[220:223], v[120:123], v[64:67]
    ds_write_b128 v12, v[40:43] offset:5152
    v_mfma_f32_16x16x32_bf16 v[84:87], v[220:223], v[124:127], v[84:87]
    ds_write_b128 v12, v[60:63] offset:10272
    v_mfma_f32_16x16x32_bf16 v[28:31], v[224:227], v[112:115], v[28:31]
    ds_write_b128 v12, v[80:83] offset:15392
    v_mfma_f32_16x16x32_bf16 v[48:51], v[224:227], v[116:119], v[48:51]
    ds_write_b128 v12, v[24:27] offset:64
    v_mfma_f32_16x16x32_bf16 v[68:71], v[224:227], v[120:123], v[68:71]
    ds_write_b128 v12, v[44:47] offset:5184
    v_mfma_f32_16x16x32_bf16 v[88:91], v[224:227], v[124:127], v[88:91]
    ds_write_b128 v12, v[64:67] offset:10304
    v_mfma_f32_16x16x32_bf16 v[32:35], v[228:231], v[112:115], v[32:35]
    ds_write_b128 v12, v[84:87] offset:15424
    v_mfma_f32_16x16x32_bf16 v[52:55], v[228:231], v[116:119], v[52:55]
    ds_write_b128 v12, v[28:31] offset:96
    v_mfma_f32_16x16x32_bf16 v[72:75], v[228:231], v[120:123], v[72:75]
    ds_write_b128 v12, v[48:51] offset:5216
    v_mfma_f32_16x16x32_bf16 v[92:95], v[228:231], v[124:127], v[92:95]
    ds_write_b128 v12, v[68:71] offset:10336
    s_nop 0
    ds_write_b128 v12, v[88:91] offset:15456
    s_nop 0
    ds_write_b128 v12, v[32:35] offset:128
    s_nop 0
    ds_write_b128 v12, v[52:55] offset:5248
    s_nop 0
    ds_write_b128 v12, v[72:75] offset:10368
    s_nop 0
    ds_write_b128 v12, v[92:95] offset:15488
    s_waitcnt lgkmcnt(0)
    s_barrier
    s_endpgm
L_olate:
    s_waitcnt vmcnt(18)
    ds_read_b64_tr_b16 v[96:97], v4 offset:4096
    ds_read_b64_tr_b16 v[98:99], v4 offset:6144
    ds_read_b64_tr_b16 v[100:101], v5 offset:4096
    ds_read_b64_tr_b16 v[102:103], v5 offset:6144
    ds_read_b64_tr_b16 v[104:105], v6 offset:4096
    ds_read_b64_tr_b16 v[106:107], v6 offset:6144
    ds_read_b64_tr_b16 v[108:109], v7 offset:4096
    ds_read_b64_tr_b16 v[110:111], v7 offset:6144
    s_waitcnt lgkmcnt(0)
    v_mfma_f32_16x16x32_bf16 v[16:19], v[132:135], v[96:99], v[16:19]
    v_mfma_f32_16x16x32_bf16 v[36:39], v[132:135], v[100:103], v[36:39]
    v_mfma_f32_16x16x32_bf16 v[56:59], v[132:135], v[104:107], v[56:59]
    v_mfma_f32_16x16x32_bf16 v[76:79], v[132:135], v[108:111], v[76:79]
    v_mfma_f32_16x16x32_bf16 v[20:23], v[136:139], v[96:99], v[20:23]
    v_mfma_f32_16x16x32_bf16 v[40:43], v[136:139], v[100:103], v[40:43]
    v_mfma_f32_16x16x32_bf16 v[60:63], v[136:139], v[104:107], v[60:63]
    v_mfma_f32_16x16x32_bf16 v[80:83], v[136:139], v[108:111], v[80:83]
    v_mfma_f32_16x16x32_bf16 v[24:27], v[140:143], v[96:99], v[24:27]
    v_mfma_f32_16x16x32_bf16 v[44:47], v[140:143], v[100:103], v[44:47]
    v_mfma_f32_16x16x32_bf16 v[64:67], v[140:143], v[104:107], v[64:67]
    v_mfma_f32_16x16x32_bf16 v[84:87], v[140:143], v[108:111], v[84:87]
    v_mfma_f32_16x16x32_bf16 v[28:31], v[144:147], v[96:99], v[28:31]
    v_mfma_f32_16x16x32_bf16 v[48:51], v[144:147], v[100:103], v[48:51]
    v_mfma_f32_16x16x32_bf16 v[68:71], v[144:147], v[104:107], v[68:71]
    v_mfma_f32_16x16x32_bf16 v[88:91], v[144:147], v[108:111], v[88:91]
    v_mfma_f32_16x16x32_bf16 v[32:35], v[148:151], v[96:99], v[32:35]
    v_mfma_f32_16x16x32_bf16 v[52:55], v[148:151], v[100:103], v[52:55]
    v_mfma_f32_16x16x32_bf16 v[72:75], v[148:151], v[104:107], v[72:75]
    v_mfma_f32_16x16x32_bf16 v[92:95], v[148:151], v[108:111], v[92:95]
    s_waitcnt vmcnt(9)
    ds_read_b64_tr_b16 v[96:97], v4 offset:8192
    ds_read_b64_tr_b16 v[98:99], v4 offset:10240
    ds_read_b64_tr_b16 v[100:101], v5 offset:8192
    ds_read_b64_tr_b16 v[102:103], v5 offset:10240
    ds_read_b64_tr_b16 v[104:105], v6 offset:8192
    ds_read_b64_tr_b16 v[106:107], v6 offset:10240
    ds_read_b64_tr_b16 v[108:109], v7 offset:8192
    ds_read_b64_tr_b16 v[110:111], v7 offset:10240
    s_waitcnt lgkmcnt(0)
    v_mfma_f32_16x16x32_bf16 v[16:19], v[152:155], v[96:99], v[16:19]
    v_mfma_f32_16x16x32_bf16 v[36:39], v[152:155], v[100:103], v[36:39]
    v_mfma_f32_16x16x32_bf16 v[56:59], v[152:155], v[104:107], v[56:59]
    v_mfma_f32_16x16x32_bf16 v[76:79], v[152:155], v[108:111], v[76:79]
    v_mfma_f32_16x16x32_bf16 v[20:23], v[156:159], v[96:99], v[20:23]
    v_mfma_f32_16x16x32_bf16 v[40:43], v[156:159], v[100:103], v[40:43]
    v_mfma_f32_16x16x32_bf16 v[60:63], v[156:159], v[104:107], v[60:63]
    v_mfma_f32_16x16x32_bf16 v[80:83], v[156:159], v[108:111], v[80:83]
    v_mfma_f32_16x16x32_bf16 v[24:27], v[160:163], v[96:99], v[24:27]
    v_mfma_f32_16x16x32_bf16 v[44:47], v[160:163], v[100:103], v[44:47]
    v_mfma_f32_16x16x32_bf16 v[64:67], v[160:163], v[104:107], v[64:67]
    v_mfma_f32_16x16x32_bf16 v[84:87], v[160:163], v[108:111], v[84:87]
    v_mfma_f32_16x16x32_bf16 v[28:31], v[164:167], v[96:99], v[28:31]
    v_mfma_f32_16x16x32_bf16 v[48:51], v[164:167], v[100:103], v[48:51]
    v_mfma_f32_16x16x32_bf16 v[68:71], v[164:167], v[104:107], v[68:71]
    v_mfma_f32_16x16x32_bf16 v[88:91], v[164:167], v[108:111], v[88:91]
    v_mfma_f32_16x16x32_bf16 v[32:35], v[168:171], v[96:99], v[32:35]
    v_mfma_f32_16x16x32_bf16 v[52:55], v[168:171], v[100:103], v[52:55]
    v_mfma_f32_16x16x32_bf16 v[72:75], v[168:171], v[104:107], v[72:75]
    v_mfma_f32_16x16x32_bf16 v[92:95], v[168:171], v[108:111], v[92:95]
    s_waitcnt vmcnt(0)
    ds_read_b64_tr_b16 v[96:97], v4 offset:12288
    ds_read_b64_tr_b16 v[98:99], v4 offset:14336
    ds_read_b64_tr_b16 v[100:101], v5 offset:12288
    ds_read_b64_tr_b16 v[102:103], v5 offset:14336
    ds_read_b64_tr_b16 v[104:105], v6 offset:12288
    ds_read_b64_tr_b16 v[106:107], v6 offset:14336
    ds_read_b64_tr_b16 v[108:109], v7 offset:12288
    ds_read_b64_tr_b16 v[110:111], v7 offset:14336
    s_waitcnt lgkmcnt(0)
    v_mfma_f32_16x16x32_bf16 v[16:19], v[172:175], v[96:99], v[16:19]
    v_mfma_f32_16x16x32_bf16 v[36:39], v[172:175], v[100:103], v[36:39]
    v_mfma_f32_16x16x32_bf16 v[56:59], v[172:175], v[104:107], v[56:59]
    v_mfma_f32_16x16x32_bf16 v[76:79], v[172:175], v[108:111], v[76:79]
    v_mfma_f32_16x16x32_bf16 v[20:23], v[176:179], v[96:99], v[20:23]
    v_mfma_f32_16x16x32_bf16 v[40:43], v[176:179], v[100:103], v[40:43]
    v_mfma_f32_16x16x32_bf16 v[60:63], v[176:179], v[104:107], v[60:63]
    v_mfma_f32_16x16x32_bf16 v[80:83], v[176:179], v[108:111], v[80:83]
    v_mfma_f32_16x16x32_bf16 v[24:27], v[180:183], v[96:99], v[24:27]
    v_mfma_f32_16x16x32_bf16 v[44:47], v[180:183], v[100:103], v[44:47]
    v_mfma_f32_16x16x32_bf16 v[64:67], v[180:183], v[104:107], v[64:67]
    v_mfma_f32_16x16x32_bf16 v[84:87], v[180:183], v[108:111], v[84:87]
    v_mfma_f32_16x16x32_bf16 v[28:31], v[184:187], v[96:99], v[28:31]
    v_mfma_f32_16x16x32_bf16 v[48:51], v[184:187], v[100:103], v[48:51]
    v_mfma_f32_16x16x32_bf16 v[68:71], v[184:187], v[104:107], v[68:71]
    v_mfma_f32_16x16x32_bf16 v[88:91], v[184:187], v[108:111], v[88:91]
    v_mfma_f32_16x16x32_bf16 v[32:35], v[188:191], v[96:99], v[32:35]
    v_mfma_f32_16x16x32_bf16 v[52:55], v[188:191], v[100:103], v[52:55]
    v_mfma_f32_16x16x32_bf16 v[72:75], v[188:191], v[104:107], v[72:75]
    v_mfma_f32_16x16x32_bf16 v[92:95], v[188:191], v[108:111], v[92:95]
    v_mov_b32 v2, 163812
    s_mov_b32 s47, 0x80000
lw_48:
    ds_read_b32 v3, v2
    s_sub_u32 s47, s47, 1
    s_cbranch_scc1 lw_48x
    s_waitcnt lgkmcnt(0)
    v_readfirstlane_b32 s60, v3
    s_cmp_ge_u32 s60, 1
    s_cbranch_scc1 lw_48x
    s_sleep 0
    s_branch lw_48
lw_48x:
    buffer_load_dwordx4 v[112:115], v13, s[24:27], s70 offen offset:0 sc1
    buffer_load_dwordx4 v[116:119], v13, s[24:27], s70 offen offset:256 sc1
    buffer_load_dwordx4 v[120:123], v13, s[24:27], s71 offen offset:0 sc1
    buffer_load_dwordx4 v[124:127], v13, s[24:27], s71 offen offset:256 sc1
    buffer_load_dwordx4 v[132:135], v13, s[24:27], s70 offen offset:2048 sc1
    buffer_load_dwordx4 v[136:139], v13, s[24:27], s70 offen offset:2304 sc1
    buffer_load_dwordx4 v[140:143], v13, s[24:27], s71 offen offset:2048 sc1
    buffer_load_dwordx4 v[144:147], v13, s[24:27], s71 offen offset:2304 sc1
    buffer_load_dwordx4 v[152:155], v13, s[24:27], s72 offen offset:0 sc1
    buffer_load_dwordx4 v[156:159], v13, s[24:27], s72 offen offset:256 sc1
    buffer_load_dwordx4 v[160:163], v13, s[24:27], s73 offen offset:0 sc1
    buffer_load_dwordx4 v[164:167], v13, s[24:27], s73 offen offset:256 sc1
    buffer_load_dwordx4 v[172:175], v13, s[24:27], s72 offen offset:2048 sc1
    buffer_load_dwordx4 v[176:179], v13, s[24:27], s72 offen offset:2304 sc1
    buffer_load_dwordx4 v[180:183], v13, s[24:27], s73 offen offset:2048 sc1
    buffer_load_dwordx4 v[184:187], v13, s[24:27], s73 offen offset:2304 sc1
    s_branch L_wo
L_cons:
    s_cmp_lg_u32 s44, 0
    s_cbranch_scc1 ic_49
    v_lshlrev_b32 v6, 2, v1
    v_add_u32 v6, 163584, v6
    v_mov_b32 v7, 0
    ds_write_b32 v6, v7
ic_49:
    s_lshr_b32 s48, s44, 1
    s_and_b32 s49, s44, 1
    v_and_b32 v2, 31, v1
    v_lshrrev_b32 v3, 5, v1
    v_bfe_u32 v4, v1, 1, 3
    s_lshl_b32 s50, s48, 14
    v_lshlrev_b32 v5, 7, v2
    v_add_u32 v5, s50, v5
    v_or_b32 v6, 0, v3
    v_xor_b32 v6, v6, v4
    v_lshl_add_u32 v8, v6, 4, v5
    v_or_b32 v6, 2, v3
    v_xor_b32 v6, v6, v4
    v_lshl_add_u32 v9, v6, 4, v5
    v_or_b32 v6, 4, v3
    v_xor_b32 v6, v6, v4
    v_lshl_add_u32 v10, v6, 4, v5
    v_or_b32 v6, 6, v3
    v_xor_b32 v6, v6, v4
    v_lshl_add_u32 v11, v6, 4, v5
    v_bfe_u32 v4, v1, 2, 2
    v_lshl_add_u32 v5, v3, 3, v4
    v_lshlrev_b32 v5, 8, v5
    v_bfe_u32 v6, v1, 4, 1
    v_lshl_add_u32 v5, v6, 5, v5
    v_and_b32 v6, 3, v1
    v_lshl_add_u32 v5, v6, 3, v5
    v_add_u32 v5, 32768, v5
    s_lshl_b32 s50, s49, 1
    s_xor_b32 s51, s48, 0
    s_add_u32 s51, s50, s51
    v_xor_b32 v6, s51, v4
    v_lshl_add_u32 v12, v6, 6, v5
    s_xor_b32 s51, s48, 1
    s_add_u32 s51, s50, s51
    v_xor_b32 v6, s51, v4
    v_lshl_add_u32 v13, v6, 6, v5
    v_mov_b32 v64, 0
    v_mov_b32 v65, 0
    v_mov_b32 v66, 0
    v_mov_b32 v67, 0
    v_mov_b32 v68, 0
    v_mov_b32 v69, 0
    v_mov_b32 v70, 0
    v_mov_b32 v71, 0
    v_mov_b32 v72, 0
    v_mov_b32 v73, 0
    v_mov_b32 v74, 0
    v_mov_b32 v75, 0
    v_mov_b32 v76, 0
    v_mov_b32 v77, 0
    v_mov_b32 v78, 0
    v_mov_b32 v79, 0
    v_mov_b32 v80, 0
    v_mov_b32 v81, 0
    v_mov_b32 v82, 0
    v_mov_b32 v83, 0
    v_mov_b32 v84, 0
    v_mov_b32 v85, 0
    v_mov_b32 v86, 0
    v_mov_b32 v87, 0
    v_mov_b32 v88, 0
    v_mov_b32 v89, 0
    v_mov_b32 v90, 0
    v_mov_b32 v91, 0
    v_mov_b32 v92, 0
    v_mov_b32 v93, 0
    v_mov_b32 v94, 0
    v_mov_b32 v95, 0
    v_mov_b32 v96, 0
    v_mov_b32 v97, 0
    v_mov_b32 v98, 0
    v_mov_b32 v99, 0
    v_mov_b32 v100, 0
    v_mov_b32 v101, 0
    v_mov_b32 v102, 0
    v_mov_b32 v103, 0
    v_mov_b32 v104, 0
    v_mov_b32 v105, 0
    v_mov_b32 v106, 0
    v_mov_b32 v107, 0
    v_mov_b32 v108, 0
    v_mov_b32 v109, 0
    v_mov_b32 v110, 0
    v_mov_b32 v111, 0
    v_mov_b32 v112, 0
    v_mov_b32 v113, 0
    v_mov_b32 v114, 0
    v_mov_b32 v115, 0
    v_mov_b32 v116, 0
    v_mov_b32 v117, 0
    v_mov_b32 v118, 0
    v_mov_b32 v119, 0
    v_mov_b32 v120, 0
    v_mov_b32 v121, 0
    v_mov_b32 v122, 0
    v_mov_b32 v123, 0
    v_mov_b32 v124, 0
    v_mov_b32 v125, 0
    v_mov_b32 v126, 0
    v_mov_b32 v127, 0
    v_mov_b32 v128, 0
    v_mov_b32 v129, 0
    v_mov_b32 v130, 0
    v_mov_b32 v131, 0
    v_mov_b32 v132, 0
    v_mov_b32 v133, 0
    v_mov_b32 v134, 0
    v_mov_b32 v135, 0
    v_mov_b32 v136, 0
    v_mov_b32 v137, 0
    v_mov_b32 v138, 0
    v_mov_b32 v139, 0
    v_mov_b32 v140, 0
    v_mov_b32 v141, 0
    v_mov_b32 v142, 0
    v_mov_b32 v143, 0
    v_mov_b32 v144, 0
    v_mov_b32 v145, 0
    v_mov_b32 v146, 0
    v_mov_b32 v147, 0
    v_mov_b32 v148, 0
    v_mov_b32 v149, 0
    v_mov_b32 v150, 0
    v_mov_b32 v151, 0
    v_mov_b32 v152, 0
    v_mov_b32 v153, 0
    v_mov_b32 v154, 0
    v_mov_b32 v155, 0
    v_mov_b32 v156, 0
    v_mov_b32 v157, 0
    v_mov_b32 v158, 0
    v_mov_b32 v159, 0
    v_mov_b32 v160, 0
    v_mov_b32 v161, 0
    v_mov_b32 v162, 0
    v_mov_b32 v163, 0
    v_mov_b32 v164, 0
    v_mov_b32 v165, 0
    v_mov_b32 v166, 0
    v_mov_b32 v167, 0
    v_mov_b32 v168, 0
    v_mov_b32 v169, 0
    v_mov_b32 v170, 0
    v_mov_b32 v171, 0
    v_mov_b32 v172, 0
    v_mov_b32 v173, 0
    v_mov_b32 v174, 0
    v_mov_b32 v175, 0
    v_mov_b32 v176, 0
    v_mov_b32 v177, 0
    v_mov_b32 v178, 0
    v_mov_b32 v179, 0
    v_mov_b32 v180, 0
    v_mov_b32 v181, 0
    v_mov_b32 v182, 0
    v_mov_b32 v183, 0
    v_mov_b32 v184, 0
    v_mov_b32 v185, 0
    v_mov_b32 v186, 0
    v_mov_b32 v187, 0
    v_mov_b32 v188, 0
    v_mov_b32 v189, 0
    v_mov_b32 v190, 0
    v_mov_b32 v191, 0
    s_setprio 2
    s_waitcnt lgkmcnt(0)
    s_barrier
    s_cmp_ge_u32 s77, 10
    s_cbranch_scc1 L_consv
    ds_read_b128 v[16:19], v8 offset:0
    ds_read_b64_tr_b16 v[32:33], v12 offset:0
    ds_read_b64_tr_b16 v[34:35], v12 offset:1024
    ds_read_b64_tr_b16 v[36:37], v13 offset:0
    ds_read_b64_tr_b16 v[38:39], v13 offset:1024
    ds_read_b128 v[20:23], v8 offset:4096
    ds_read_b128 v[24:27], v8 offset:8192
    ds_read_b128 v[28:31], v8 offset:12288
    s_mov_b32 s50, 0
    s_mov_b32 s51, 0
    s_mov_b32 s52, 49152
.p2align 3
qloop_50:
    s_waitcnt lgkmcnt(5)
    v_mfma_f32_32x32x16_bf16 v[64:79], v[32:35], v[16:19], v[64:79]
    ds_read_b128 v[40:43], v9 offset:0
    s_waitcnt lgkmcnt(4)
    v_mfma_f32_32x32x16_bf16 v[80:95], v[36:39], v[16:19], v[80:95]
    ds_read_b64_tr_b16 v[56:57], v12 offset:4096
    s_waitcnt lgkmcnt(4)
    v_mfma_f32_32x32x16_bf16 v[96:111], v[32:35], v[20:23], v[96:111]
    ds_read_b64_tr_b16 v[58:59], v12 offset:5120
    v_mfma_f32_32x32x16_bf16 v[112:127], v[36:39], v[20:23], v[112:127]
    ds_read_b64_tr_b16 v[60:61], v13 offset:4096
    s_waitcnt lgkmcnt(5)
    v_mfma_f32_32x32x16_bf16 v[128:143], v[32:35], v[24:27], v[128:143]
    ds_read_b64_tr_b16 v[62:63], v13 offset:5120
    v_mfma_f32_32x32x16_bf16 v[144:159], v[36:39], v[24:27], v[144:159]
    ds_read_b128 v[44:47], v9 offset:4096
    s_waitcnt lgkmcnt(6)
    v_mfma_f32_32x32x16_bf16 v[160:175], v[32:35], v[28:31], v[160:175]
    ds_read_b128 v[48:51], v9 offset:8192
    v_mfma_f32_32x32x16_bf16 v[176:191], v[36:39], v[28:31], v[176:191]
    ds_read_b128 v[52:55], v9 offset:12288
    s_waitcnt lgkmcnt(5)
    v_mfma_f32_32x32x16_bf16 v[64:79], v[56:59], v[40:43], v[64:79]
    ds_read_b128 v[16:19], v10 offset:0
    s_waitcnt lgkmcnt(4)
    v_mfma_f32_32x32x16_bf16 v[80:95], v[60:63], v[40:43], v[80:95]
    ds_read_b64_tr_b16 v[32:33], v12 offset:8192
    s_waitcnt lgkmcnt(4)
    v_mfma_f32_32x32x16_bf16 v[96:111], v[56:59], v[44:47], v[96:111]
    ds_read_b64_tr_b16 v[34:35], v12 offset:9216
    v_mfma_f32_32x32x16_bf16 v[112:127], v[60:63], v[44:47], v[112:127]
    ds_read_b64_tr_b16 v[36:37], v13 offset:8192
    s_waitcnt lgkmcnt(5)
    v_mfma_f32_32x32x16_bf16 v[128:143], v[56:59], v[48:51], v[128:143]
    ds_read_b64_tr_b16 v[38:39], v13 offset:9216
    v_mfma_f32_32x32x16_bf16 v[144:159], v[60:63], v[48:51], v[144:159]
    ds_read_b128 v[20:23], v10 offset:4096
    s_waitcnt lgkmcnt(6)
    v_mfma_f32_32x32x16_bf16 v[160:175], v[56:59], v[52:55], v[160:175]
    ds_read_b128 v[24:27], v10 offset:8192
    v_mfma_f32_32x32x16_bf16 v[176:191], v[60:63], v[52:55], v[176:191]
    ds_read_b128 v[28:31], v10 offset:12288
    s_waitcnt lgkmcnt(5)
    v_mfma_f32_32x32x16_bf16 v[64:79], v[32:35], v[16:19], v[64:79]
    ds_read_b128 v[40:43], v11 offset:0
    s_waitcnt lgkmcnt(4)
    v_mfma_f32_32x32x16_bf16 v[80:95], v[36:39], v[16:19], v[80:95]
    ds_read_b64_tr_b16 v[56:57], v12 offset:12288
    s_waitcnt lgkmcnt(4)
    v_mfma_f32_32x32x16_bf16 v[96:111], v[32:35], v[20:23], v[96:111]
    ds_read_b64_tr_b16 v[58:59], v12 offset:13312
    v_mfma_f32_32x32x16_bf16 v[112:127], v[36:39], v[20:23], v[112:127]
    ds_read_b64_tr_b16 v[60:61], v13 offset:12288
    s_waitcnt lgkmcnt(5)
    v_mfma_f32_32x32x16_bf16 v[128:143], v[32:35], v[24:27], v[128:143]
    ds_read_b64_tr_b16 v[62:63], v13 offset:13312
    v_mfma_f32_32x32x16_bf16 v[144:159], v[36:39], v[24:27], v[144:159]
    ds_read_b128 v[44:47], v11 offset:4096
    s_waitcnt lgkmcnt(6)
    v_mfma_f32_32x32x16_bf16 v[160:175], v[32:35], v[28:31], v[160:175]
    ds_read_b128 v[48:51], v11 offset:8192
    v_mfma_f32_32x32x16_bf16 v[176:191], v[36:39], v[28:31], v[176:191]
    ds_read_b128 v[52:55], v11 offset:12288
    s_waitcnt lgkmcnt(5)
    v_mfma_f32_32x32x16_bf16 v[64:79], v[56:59], v[40:43], v[64:79]
    s_cmp_eq_u32 s50, 9
    s_cbranch_scc1 qlast_51
    s_add_u32 s51, s51, 1
    s_cmp_eq_u32 s51, 3
    s_waitcnt lgkmcnt(3)
    v_mfma_f32_32x32x16_bf16 v[80:95], v[60:63], v[40:43], v[80:95]
    s_cselect_b32 s51, 0, s51
    s_cselect_b32 s53, -98304, s52
    v_add_u32 v8, s53, v8
    v_add_u32 v9, s53, v9
    v_add_u32 v10, s53, v10
    s_waitcnt lgkmcnt(2)
    v_mfma_f32_32x32x16_bf16 v[96:111], v[56:59], v[44:47], v[96:111]
    v_add_u32 v11, s53, v11
    v_add_u32 v12, s53, v12
    v_add_u32 v13, s53, v13
    s_waitcnt lgkmcnt(0)
    v_mfma_f32_32x32x16_bf16 v[112:127], v[60:63], v[44:47], v[112:127]
    s_barrier
    ds_read_b128 v[16:19], v8 offset:0
    ds_read_b64_tr_b16 v[32:33], v12 offset:0
    v_mfma_f32_32x32x16_bf16 v[128:143], v[56:59], v[48:51], v[128:143]
    ds_read_b64_tr_b16 v[34:35], v12 offset:1024
    ds_read_b64_tr_b16 v[36:37], v13 offset:0
    v_mfma_f32_32x32x16_bf16 v[144:159], v[60:63], v[48:51], v[144:159]
    ds_read_b64_tr_b16 v[38:39], v13 offset:1024
    ds_read_b128 v[20:23], v8 offset:4096
    v_mfma_f32_32x32x16_bf16 v[160:175], v[56:59], v[52:55], v[160:175]
    ds_read_b128 v[24:27], v8 offset:8192
    ds_read_b128 v[28:31], v8 offset:12288
    s_add_u32 s50, s50, 1
    v_mfma_f32_32x32x16_bf16 v[176:191], v[60:63], v[52:55], v[176:191]
    s_branch qloop_50
qlast_51:
    s_waitcnt lgkmcnt(0)
    v_mfma_f32_32x32x16_bf16 v[80:95], v[60:63], v[40:43], v[80:95]
    v_mfma_f32_32x32x16_bf16 v[96:111], v[56:59], v[44:47], v[96:111]
    v_mfma_f32_32x32x16_bf16 v[112:127], v[60:63], v[44:47], v[112:127]
    v_mfma_f32_32x32x16_bf16 v[128:143], v[56:59], v[48:51], v[128:143]
    v_mfma_f32_32x32x16_bf16 v[144:159], v[60:63], v[48:51], v[144:159]
    v_mfma_f32_32x32x16_bf16 v[160:175], v[56:59], v[52:55], v[160:175]
    v_mfma_f32_32x32x16_bf16 v[176:191], v[60:63], v[52:55], v[176:191]
    s_setprio 3
    s_lshl_b32 s50, s76, 3
    s_lshl_b32 s51, s48, 2
    s_add_u32 s50, s50, s51
    s_mul_i32 s50, s50, 40960
    s_lshl_b32 s53, s77, 7
    s_lshl_b32 s54, s49, 6
    s_add_u32 s53, s53, s54
    s_lshl_b32 s51, s48, 9
    s_add_u32 s51, s51, 147456
    s_lshl_b32 s54, s49, 8
    s_lshl_b32 s55, s48, 7
    s_add_u32 s54, s54, s55
    s_add_u32 s54, s54, 149504
    v_and_b32 v14, 31, v1
    v_lshrrev_b32 v15, 5, v1
    v_lshlrev_b32 v4, 2, v14
    v_lshlrev_b32 v5, 4, v15
    v_add_u32 v4, s51, v4
    v_add_u32 v5, s54, v5
    v_xor_b32 v8, 128, v5
    ds_read_b128 v[192:195], v5 offset:0
    ds_read_b128 v[32:35], v8 offset:0
    ds_read_b128 v[196:199], v5 offset:32
    ds_read_b128 v[36:39], v8 offset:32
    ds_read_b128 v[200:203], v5 offset:64
    ds_read_b128 v[40:43], v8 offset:64
    ds_read_b128 v[204:207], v5 offset:96
    ds_read_b128 v[44:47], v8 offset:96
    ds_read_b32 v16, v4 offset:0
    ds_read_b32 v24, v4 offset:1024
    ds_read_b32 v18, v4 offset:128
    ds_read_b32 v26, v4 offset:1152
    ds_read_b32 v20, v4 offset:256
    ds_read_b32 v28, v4 offset:1280
    ds_read_b32 v22, v4 offset:384
    ds_read_b32 v30, v4 offset:1408
    s_cmp_lt_u32 s77, 5
    s_cselect_b32 s55, 0x3ea52b5c, 1.0
    s_cselect_b32 s56, 0, 2580480
    s_add_u32 s56, s56, 6193152
    s_add_u32 s56, s56, s50
    s_lshl_b32 s57, s53, 6
    s_add_u32 s56, s56, s57
    v_lshlrev_b32 v4, 3, v14
    v_lshl_add_u32 v4, v15, 8, v4
    s_lshl_b32 s57, s48, 11
    v_add_u32 v4, s57, v4
    v_xor_b32 v5, 2048, v4
    v_lshlrev_b32 v6, 4, v1
    v_add_u32 v6, s57, v6
    v_xor_b32 v7, 2048, v6
    s_waitcnt lgkmcnt(0)
    v_mul_f32 v16, s55, v16
    v_mul_f32 v18, s55, v18
    v_mul_f32 v20, s55, v20
    v_mul_f32 v22, s55, v22
    v_mul_f32 v24, s55, v24
    v_mul_f32 v26, s55, v26
    v_mul_f32 v28, s55, v28
    v_mul_f32 v30, s55, v30
    v_pk_mul_f32 v[64:65], v[64:65], v[16:17] op_sel_hi:[1,0]
    v_pk_mul_f32 v[66:67], v[66:67], v[16:17] op_sel_hi:[1,0]
    v_pk_mul_f32 v[68:69], v[68:69], v[16:17] op_sel_hi:[1,0]
    v_pk_mul_f32 v[70:71], v[70:71], v[16:17] op_sel_hi:[1,0]
    v_pk_mul_f32 v[72:73], v[72:73], v[16:17] op_sel_hi:[1,0]
    v_pk_mul_f32 v[74:75], v[74:75], v[16:17] op_sel_hi:[1,0]
    v_pk_mul_f32 v[76:77], v[76:77], v[16:17] op_sel_hi:[1,0]
    v_pk_mul_f32 v[78:79], v[78:79], v[16:17] op_sel_hi:[1,0]
    v_pk_fma_f32 v[64:65], v[192:193], v[24:25], v[64:65] op_sel_hi:[1,0,1] neg_lo:[0,1,0] neg_hi:[0,1,0]
    v_pk_fma_f32 v[66:67], v[194:195], v[24:25], v[66:67] op_sel_hi:[1,0,1] neg_lo:[0,1,0] neg_hi:[0,1,0]
    v_pk_fma_f32 v[68:69], v[196:197], v[24:25], v[68:69] op_sel_hi:[1,0,1] neg_lo:[0,1,0] neg_hi:[0,1,0]
    v_pk_fma_f32 v[70:71], v[198:199], v[24:25], v[70:71] op_sel_hi:[1,0,1] neg_lo:[0,1,0] neg_hi:[0,1,0]
    v_pk_fma_f32 v[72:73], v[200:201], v[24:25], v[72:73] op_sel_hi:[1,0,1] neg_lo:[0,1,0] neg_hi:[0,1,0]
    v_pk_fma_f32 v[74:75], v[202:203], v[24:25], v[74:75] op_sel_hi:[1,0,1] neg_lo:[0,1,0] neg_hi:[0,1,0]
    v_pk_fma_f32 v[76:77], v[204:205], v[24:25], v[76:77] op_sel_hi:[1,0,1] neg_lo:[0,1,0] neg_hi:[0,1,0]
    v_pk_fma_f32 v[78:79], v[206:207], v[24:25], v[78:79] op_sel_hi:[1,0,1] neg_lo:[0,1,0] neg_hi:[0,1,0]
    v_cvt_pk_bf16_f32 v64, v64, v65
    v_cvt_pk_bf16_f32 v65, v66, v67
    v_cvt_pk_bf16_f32 v66, v68, v69
    v_cvt_pk_bf16_f32 v67, v70, v71
    v_cvt_pk_bf16_f32 v68, v72, v73
    v_cvt_pk_bf16_f32 v69, v74, v75
    v_cvt_pk_bf16_f32 v70, v76, v77
    v_cvt_pk_bf16_f32 v71, v78, v79
    buffer_store_dwordx2 v[64:65], v4, s[24:27], s56 offen offset:0 sc1
    buffer_store_dwordx2 v[66:67], v4, s[24:27], s56 offen offset:512 sc1
    buffer_store_dwordx2 v[68:69], v4, s[24:27], s56 offen offset:1024 sc1
    buffer_store_dwordx2 v[70:71], v4, s[24:27], s56 offen offset:1536 sc1
    v_pk_mul_f32 v[80:81], v[80:81], v[16:17] op_sel_hi:[1,0]
    v_pk_mul_f32 v[82:83], v[82:83], v[16:17] op_sel_hi:[1,0]
    v_pk_mul_f32 v[84:85], v[84:85], v[16:17] op_sel_hi:[1,0]
    v_pk_mul_f32 v[86:87], v[86:87], v[16:17] op_sel_hi:[1,0]
    v_pk_mul_f32 v[88:89], v[88:89], v[16:17] op_sel_hi:[1,0]
    v_pk_mul_f32 v[90:91], v[90:91], v[16:17] op_sel_hi:[1,0]
    v_pk_mul_f32 v[92:93], v[92:93], v[16:17] op_sel_hi:[1,0]
    v_pk_mul_f32 v[94:95], v[94:95], v[16:17] op_sel_hi:[1,0]
    v_pk_fma_f32 v[80:81], v[32:33], v[24:25], v[80:81] op_sel_hi:[1,0,1] neg_lo:[0,1,0] neg_hi:[0,1,0]
    v_pk_fma_f32 v[82:83], v[34:35], v[24:25], v[82:83] op_sel_hi:[1,0,1] neg_lo:[0,1,0] neg_hi:[0,1,0]
    v_pk_fma_f32 v[84:85], v[36:37], v[24:25], v[84:85] op_sel_hi:[1,0,1] neg_lo:[0,1,0] neg_hi:[0,1,0]
    v_pk_fma_f32 v[86:87], v[38:39], v[24:25], v[86:87] op_sel_hi:[1,0,1] neg_lo:[0,1,0] neg_hi:[0,1,0]
    v_pk_fma_f32 v[88:89], v[40:41], v[24:25], v[88:89] op_sel_hi:[1,0,1] neg_lo:[0,1,0] neg_hi:[0,1,0]
    v_pk_fma_f32 v[90:91], v[42:43], v[24:25], v[90:91] op_sel_hi:[1,0,1] neg_lo:[0,1,0] neg_hi:[0,1,0]
    v_pk_fma_f32 v[92:93], v[44:45], v[24:25], v[92:93] op_sel_hi:[1,0,1] neg_lo:[0,1,0] neg_hi:[0,1,0]
    v_pk_fma_f32 v[94:95], v[46:47], v[24:25], v[94:95] op_sel_hi:[1,0,1] neg_lo:[0,1,0] neg_hi:[0,1,0]
    v_cvt_pk_bf16_f32 v80, v80, v81
    v_cvt_pk_bf16_f32 v81, v82, v83
    v_cvt_pk_bf16_f32 v82, v84, v85
    v_cvt_pk_bf16_f32 v83, v86, v87
    v_cvt_pk_bf16_f32 v84, v88, v89
    v_cvt_pk_bf16_f32 v85, v90, v91
    v_cvt_pk_bf16_f32 v86, v92, v93
    v_cvt_pk_bf16_f32 v87, v94, v95
    buffer_store_dwordx2 v[80:81], v5, s[24:27], s56 offen offset:0 sc1
    buffer_store_dwordx2 v[82:83], v5, s[24:27], s56 offen offset:512 sc1
    buffer_store_dwordx2 v[84:85], v5, s[24:27], s56 offen offset:1024 sc1
    buffer_store_dwordx2 v[86:87], v5, s[24:27], s56 offen offset:1536 sc1
    s_add_u32 s56, s56, 40960
    v_pk_mul_f32 v[96:97], v[96:97], v[18:19] op_sel_hi:[1,0]
    v_pk_mul_f32 v[98:99], v[98:99], v[18:19] op_sel_hi:[1,0]
    v_pk_mul_f32 v[100:101], v[100:101], v[18:19] op_sel_hi:[1,0]
    v_pk_mul_f32 v[102:103], v[102:103], v[18:19] op_sel_hi:[1,0]
    v_pk_mul_f32 v[104:105], v[104:105], v[18:19] op_sel_hi:[1,0]
    v_pk_mul_f32 v[106:107], v[106:107], v[18:19] op_sel_hi:[1,0]
    v_pk_mul_f32 v[108:109], v[108:109], v[18:19] op_sel_hi:[1,0]
    v_pk_mul_f32 v[110:111], v[110:111], v[18:19] op_sel_hi:[1,0]
    v_pk_fma_f32 v[96:97], v[192:193], v[26:27], v[96:97] op_sel_hi:[1,0,1] neg_lo:[0,1,0] neg_hi:[0,1,0]
    v_pk_fma_f32 v[98:99], v[194:195], v[26:27], v[98:99] op_sel_hi:[1,0,1] neg_lo:[0,1,0] neg_hi:[0,1,0]
    v_pk_fma_f32 v[100:101], v[196:197], v[26:27], v[100:101] op_sel_hi:[1,0,1] neg_lo:[0,1,0] neg_hi:[0,1,0]
    v_pk_fma_f32 v[102:103], v[198:199], v[26:27], v[102:103] op_sel_hi:[1,0,1] neg_lo:[0,1,0] neg_hi:[0,1,0]
    v_pk_fma_f32 v[104:105], v[200:201], v[26:27], v[104:105] op_sel_hi:[1,0,1] neg_lo:[0,1,0] neg_hi:[0,1,0]
    v_pk_fma_f32 v[106:107], v[202:203], v[26:27], v[106:107] op_sel_hi:[1,0,1] neg_lo:[0,1,0] neg_hi:[0,1,0]
    v_pk_fma_f32 v[108:109], v[204:205], v[26:27], v[108:109] op_sel_hi:[1,0,1] neg_lo:[0,1,0] neg_hi:[0,1,0]
    v_pk_fma_f32 v[110:111], v[206:207], v[26:27], v[110:111] op_sel_hi:[1,0,1] neg_lo:[0,1,0] neg_hi:[0,1,0]
    v_cvt_pk_bf16_f32 v96, v96, v97
    v_cvt_pk_bf16_f32 v97, v98, v99
    v_cvt_pk_bf16_f32 v98, v100, v101
    v_cvt_pk_bf16_f32 v99, v102, v103
    v_cvt_pk_bf16_f32 v100, v104, v105
    v_cvt_pk_bf16_f32 v101, v106, v107
    v_cvt_pk_bf16_f32 v102, v108, v109
    v_cvt_pk_bf16_f32 v103, v110, v111
    buffer_store_dwordx2 v[96:97], v4, s[24:27], s56 offen offset:0 sc1
    buffer_store_dwordx2 v[98:99], v4, s[24:27], s56 offen offset:512 sc1
    buffer_store_dwordx2 v[100:101], v4, s[24:27], s56 offen offset:1024 sc1
    buffer_store_dwordx2 v[102:103], v4, s[24:27], s56 offen offset:1536 sc1
    v_pk_mul_f32 v[112:113], v[112:113], v[18:19] op_sel_hi:[1,0]
    v_pk_mul_f32 v[114:115], v[114:115], v[18:19] op_sel_hi:[1,0]
    v_pk_mul_f32 v[116:117], v[116:117], v[18:19] op_sel_hi:[1,0]
    v_pk_mul_f32 v[118:119], v[118:119], v[18:19] op_sel_hi:[1,0]
    v_pk_mul_f32 v[120:121], v[120:121], v[18:19] op_sel_hi:[1,0]
    v_pk_mul_f32 v[122:123], v[122:123], v[18:19] op_sel_hi:[1,0]
    v_pk_mul_f32 v[124:125], v[124:125], v[18:19] op_sel_hi:[1,0]
    v_pk_mul_f32 v[126:127], v[126:127], v[18:19] op_sel_hi:[1,0]
    v_pk_fma_f32 v[112:113], v[32:33], v[26:27], v[112:113] op_sel_hi:[1,0,1] neg_lo:[0,1,0] neg_hi:[0,1,0]
    v_pk_fma_f32 v[114:115], v[34:35], v[26:27], v[114:115] op_sel_hi:[1,0,1] neg_lo:[0,1,0] neg_hi:[0,1,0]
    v_pk_fma_f32 v[116:117], v[36:37], v[26:27], v[116:117] op_sel_hi:[1,0,1] neg_lo:[0,1,0] neg_hi:[0,1,0]
    v_pk_fma_f32 v[118:119], v[38:39], v[26:27], v[118:119] op_sel_hi:[1,0,1] neg_lo:[0,1,0] neg_hi:[0,1,0]
    v_pk_fma_f32 v[120:121], v[40:41], v[26:27], v[120:121] op_sel_hi:[1,0,1] neg_lo:[0,1,0] neg_hi:[0,1,0]
    v_pk_fma_f32 v[122:123], v[42:43], v[26:27], v[122:123] op_sel_hi:[1,0,1] neg_lo:[0,1,0] neg_hi:[0,1,0]
    v_pk_fma_f32 v[124:125], v[44:45], v[26:27], v[124:125] op_sel_hi:[1,0,1] neg_lo:[0,1,0] neg_hi:[0,1,0]
    v_pk_fma_f32 v[126:127], v[46:47], v[26:27], v[126:127] op_sel_hi:[1,0,1] neg_lo:[0,1,0] neg_hi:[0,1,0]
    v_cvt_pk_bf16_f32 v112, v112, v113
    v_cvt_pk_bf16_f32 v113, v114, v115
    v_cvt_pk_bf16_f32 v114, v116, v117
    v_cvt_pk_bf16_f32 v115, v118, v119
    v_cvt_pk_bf16_f32 v116, v120, v121
    v_cvt_pk_bf16_f32 v117, v122, v123
    v_cvt_pk_bf16_f32 v118, v124, v125
    v_cvt_pk_bf16_f32 v119, v126, v127
    buffer_store_dwordx2 v[112:113], v5, s[24:27], s56 offen offset:0 sc1
    buffer_store_dwordx2 v[114:115], v5, s[24:27], s56 offen offset:512 sc1
    buffer_store_dwordx2 v[116:117], v5, s[24:27], s56 offen offset:1024 sc1
    buffer_store_dwordx2 v[118:119], v5, s[24:27], s56 offen offset:1536 sc1
    s_add_u32 s56, s56, 40960
    v_pk_mul_f32 v[128:129], v[128:129], v[20:21] op_sel_hi:[1,0]
    v_pk_mul_f32 v[130:131], v[130:131], v[20:21] op_sel_hi:[1,0]
    v_pk_mul_f32 v[132:133], v[132:133], v[20:21] op_sel_hi:[1,0]
    v_pk_mul_f32 v[134:135], v[134:135], v[20:21] op_sel_hi:[1,0]
    v_pk_mul_f32 v[136:137], v[136:137], v[20:21] op_sel_hi:[1,0]
    v_pk_mul_f32 v[138:139], v[138:139], v[20:21] op_sel_hi:[1,0]
    v_pk_mul_f32 v[140:141], v[140:141], v[20:21] op_sel_hi:[1,0]
    v_pk_mul_f32 v[142:143], v[142:143], v[20:21] op_sel_hi:[1,0]
    v_pk_fma_f32 v[128:129], v[192:193], v[28:29], v[128:129] op_sel_hi:[1,0,1] neg_lo:[0,1,0] neg_hi:[0,1,0]
    v_pk_fma_f32 v[130:131], v[194:195], v[28:29], v[130:131] op_sel_hi:[1,0,1] neg_lo:[0,1,0] neg_hi:[0,1,0]
    v_pk_fma_f32 v[132:133], v[196:197], v[28:29], v[132:133] op_sel_hi:[1,0,1] neg_lo:[0,1,0] neg_hi:[0,1,0]
    v_pk_fma_f32 v[134:135], v[198:199], v[28:29], v[134:135] op_sel_hi:[1,0,1] neg_lo:[0,1,0] neg_hi:[0,1,0]
    v_pk_fma_f32 v[136:137], v[200:201], v[28:29], v[136:137] op_sel_hi:[1,0,1] neg_lo:[0,1,0] neg_hi:[0,1,0]
    v_pk_fma_f32 v[138:139], v[202:203], v[28:29], v[138:139] op_sel_hi:[1,0,1] neg_lo:[0,1,0] neg_hi:[0,1,0]
    v_pk_fma_f32 v[140:141], v[204:205], v[28:29], v[140:141] op_sel_hi:[1,0,1] neg_lo:[0,1,0] neg_hi:[0,1,0]
    v_pk_fma_f32 v[142:143], v[206:207], v[28:29], v[142:143] op_sel_hi:[1,0,1] neg_lo:[0,1,0] neg_hi:[0,1,0]
    v_cvt_pk_bf16_f32 v128, v128, v129
    v_cvt_pk_bf16_f32 v129, v130, v131
    v_cvt_pk_bf16_f32 v130, v132, v133
    v_cvt_pk_bf16_f32 v131, v134, v135
    v_cvt_pk_bf16_f32 v132, v136, v137
    v_cvt_pk_bf16_f32 v133, v138, v139
    v_cvt_pk_bf16_f32 v134, v140, v141
    v_cvt_pk_bf16_f32 v135, v142, v143
    buffer_store_dwordx2 v[128:129], v4, s[24:27], s56 offen offset:0 sc1
    buffer_store_dwordx2 v[130:131], v4, s[24:27], s56 offen offset:512 sc1
    buffer_store_dwordx2 v[132:133], v4, s[24:27], s56 offen offset:1024 sc1
    buffer_store_dwordx2 v[134:135], v4, s[24:27], s56 offen offset:1536 sc1
    v_pk_mul_f32 v[144:145], v[144:145], v[20:21] op_sel_hi:[1,0]
    v_pk_mul_f32 v[146:147], v[146:147], v[20:21] op_sel_hi:[1,0]
    v_pk_mul_f32 v[148:149], v[148:149], v[20:21] op_sel_hi:[1,0]
    v_pk_mul_f32 v[150:151], v[150:151], v[20:21] op_sel_hi:[1,0]
    v_pk_mul_f32 v[152:153], v[152:153], v[20:21] op_sel_hi:[1,0]
    v_pk_mul_f32 v[154:155], v[154:155], v[20:21] op_sel_hi:[1,0]
    v_pk_mul_f32 v[156:157], v[156:157], v[20:21] op_sel_hi:[1,0]
    v_pk_mul_f32 v[158:159], v[158:159], v[20:21] op_sel_hi:[1,0]
    v_pk_fma_f32 v[144:145], v[32:33], v[28:29], v[144:145] op_sel_hi:[1,0,1] neg_lo:[0,1,0] neg_hi:[0,1,0]
    v_pk_fma_f32 v[146:147], v[34:35], v[28:29], v[146:147] op_sel_hi:[1,0,1] neg_lo:[0,1,0] neg_hi:[0,1,0]
    v_pk_fma_f32 v[148:149], v[36:37], v[28:29], v[148:149] op_sel_hi:[1,0,1] neg_lo:[0,1,0] neg_hi:[0,1,0]
    v_pk_fma_f32 v[150:151], v[38:39], v[28:29], v[150:151] op_sel_hi:[1,0,1] neg_lo:[0,1,0] neg_hi:[0,1,0]
    v_pk_fma_f32 v[152:153], v[40:41], v[28:29], v[152:153] op_sel_hi:[1,0,1] neg_lo:[0,1,0] neg_hi:[0,1,0]
    v_pk_fma_f32 v[154:155], v[42:43], v[28:29], v[154:155] op_sel_hi:[1,0,1] neg_lo:[0,1,0] neg_hi:[0,1,0]
    v_pk_fma_f32 v[156:157], v[44:45], v[28:29], v[156:157] op_sel_hi:[1,0,1] neg_lo:[0,1,0] neg_hi:[0,1,0]
    v_pk_fma_f32 v[158:159], v[46:47], v[28:29], v[158:159] op_sel_hi:[1,0,1] neg_lo:[0,1,0] neg_hi:[0,1,0]
    v_cvt_pk_bf16_f32 v144, v144, v145
    v_cvt_pk_bf16_f32 v145, v146, v147
    v_cvt_pk_bf16_f32 v146, v148, v149
    v_cvt_pk_bf16_f32 v147, v150, v151
    v_cvt_pk_bf16_f32 v148, v152, v153
    v_cvt_pk_bf16_f32 v149, v154, v155
    v_cvt_pk_bf16_f32 v150, v156, v157
    v_cvt_pk_bf16_f32 v151, v158, v159
    buffer_store_dwordx2 v[144:145], v5, s[24:27], s56 offen offset:0 sc1
    buffer_store_dwordx2 v[146:147], v5, s[24:27], s56 offen offset:512 sc1
    buffer_store_dwordx2 v[148:149], v5, s[24:27], s56 offen offset:1024 sc1
    buffer_store_dwordx2 v[150:151], v5, s[24:27], s56 offen offset:1536 sc1
    s_add_u32 s56, s56, 40960
    v_pk_mul_f32 v[160:161], v[160:161], v[22:23] op_sel_hi:[1,0]
    v_pk_mul_f32 v[162:163], v[162:163], v[22:23] op_sel_hi:[1,0]
    v_pk_mul_f32 v[164:165], v[164:165], v[22:23] op_sel_hi:[1,0]
    v_pk_mul_f32 v[166:167], v[166:167], v[22:23] op_sel_hi:[1,0]
    v_pk_mul_f32 v[168:169], v[168:169], v[22:23] op_sel_hi:[1,0]
    v_pk_mul_f32 v[170:171], v[170:171], v[22:23] op_sel_hi:[1,0]
    v_pk_mul_f32 v[172:173], v[172:173], v[22:23] op_sel_hi:[1,0]
    v_pk_mul_f32 v[174:175], v[174:175], v[22:23] op_sel_hi:[1,0]
    v_pk_fma_f32 v[160:161], v[192:193], v[30:31], v[160:161] op_sel_hi:[1,0,1] neg_lo:[0,1,0] neg_hi:[0,1,0]
    v_pk_fma_f32 v[162:163], v[194:195], v[30:31], v[162:163] op_sel_hi:[1,0,1] neg_lo:[0,1,0] neg_hi:[0,1,0]
    v_pk_fma_f32 v[164:165], v[196:197], v[30:31], v[164:165] op_sel_hi:[1,0,1] neg_lo:[0,1,0] neg_hi:[0,1,0]
    v_pk_fma_f32 v[166:167], v[198:199], v[30:31], v[166:167] op_sel_hi:[1,0,1] neg_lo:[0,1,0] neg_hi:[0,1,0]
    v_pk_fma_f32 v[168:169], v[200:201], v[30:31], v[168:169] op_sel_hi:[1,0,1] neg_lo:[0,1,0] neg_hi:[0,1,0]
    v_pk_fma_f32 v[170:171], v[202:203], v[30:31], v[170:171] op_sel_hi:[1,0,1] neg_lo:[0,1,0] neg_hi:[0,1,0]
    v_pk_fma_f32 v[172:173], v[204:205], v[30:31], v[172:173] op_sel_hi:[1,0,1] neg_lo:[0,1,0] neg_hi:[0,1,0]
    v_pk_fma_f32 v[174:175], v[206:207], v[30:31], v[174:175] op_sel_hi:[1,0,1] neg_lo:[0,1,0] neg_hi:[0,1,0]
    v_cvt_pk_bf16_f32 v160, v160, v161
    v_cvt_pk_bf16_f32 v161, v162, v163
    v_cvt_pk_bf16_f32 v162, v164, v165
    v_cvt_pk_bf16_f32 v163, v166, v167
    v_cvt_pk_bf16_f32 v164, v168, v169
    v_cvt_pk_bf16_f32 v165, v170, v171
    v_cvt_pk_bf16_f32 v166, v172, v173
    v_cvt_pk_bf16_f32 v167, v174, v175
    buffer_store_dwordx2 v[160:161], v4, s[24:27], s56 offen offset:0 sc1
    buffer_store_dwordx2 v[162:163], v4, s[24:27], s56 offen offset:512 sc1
    buffer_store_dwordx2 v[164:165], v4, s[24:27], s56 offen offset:1024 sc1
    buffer_store_dwordx2 v[166:167], v4, s[24:27], s56 offen offset:1536 sc1
    v_pk_mul_f32 v[176:177], v[176:177], v[22:23] op_sel_hi:[1,0]
    v_pk_mul_f32 v[178:179], v[178:179], v[22:23] op_sel_hi:[1,0]
    v_pk_mul_f32 v[180:181], v[180:181], v[22:23] op_sel_hi:[1,0]
    v_pk_mul_f32 v[182:183], v[182:183], v[22:23] op_sel_hi:[1,0]
    v_pk_mul_f32 v[184:185], v[184:185], v[22:23] op_sel_hi:[1,0]
    v_pk_mul_f32 v[186:187], v[186:187], v[22:23] op_sel_hi:[1,0]
    v_pk_mul_f32 v[188:189], v[188:189], v[22:23] op_sel_hi:[1,0]
    v_pk_mul_f32 v[190:191], v[190:191], v[22:23] op_sel_hi:[1,0]
    v_pk_fma_f32 v[176:177], v[32:33], v[30:31], v[176:177] op_sel_hi:[1,0,1] neg_lo:[0,1,0] neg_hi:[0,1,0]
    v_pk_fma_f32 v[178:179], v[34:35], v[30:31], v[178:179] op_sel_hi:[1,0,1] neg_lo:[0,1,0] neg_hi:[0,1,0]
    v_pk_fma_f32 v[180:181], v[36:37], v[30:31], v[180:181] op_sel_hi:[1,0,1] neg_lo:[0,1,0] neg_hi:[0,1,0]
    v_pk_fma_f32 v[182:183], v[38:39], v[30:31], v[182:183] op_sel_hi:[1,0,1] neg_lo:[0,1,0] neg_hi:[0,1,0]
    v_pk_fma_f32 v[184:185], v[40:41], v[30:31], v[184:185] op_sel_hi:[1,0,1] neg_lo:[0,1,0] neg_hi:[0,1,0]
    v_pk_fma_f32 v[186:187], v[42:43], v[30:31], v[186:187] op_sel_hi:[1,0,1] neg_lo:[0,1,0] neg_hi:[0,1,0]
    v_pk_fma_f32 v[188:189], v[44:45], v[30:31], v[188:189] op_sel_hi:[1,0,1] neg_lo:[0,1,0] neg_hi:[0,1,0]
    v_pk_fma_f32 v[190:191], v[46:47], v[30:31], v[190:191] op_sel_hi:[1,0,1] neg_lo:[0,1,0] neg_hi:[0,1,0]
    v_cvt_pk_bf16_f32 v176, v176, v177
    v_cvt_pk_bf16_f32 v177, v178, v179
    v_cvt_pk_bf16_f32 v178, v180, v181
    v_cvt_pk_bf16_f32 v179, v182, v183
    v_cvt_pk_bf16_f32 v180, v184, v185
    v_cvt_pk_bf16_f32 v181, v186, v187
    v_cvt_pk_bf16_f32 v182, v188, v189
    v_cvt_pk_bf16_f32 v183, v190, v191
    buffer_store_dwordx2 v[176:177], v5, s[24:27], s56 offen offset:0 sc1
    buffer_store_dwordx2 v[178:179], v5, s[24:27], s56 offen offset:512 sc1
    buffer_store_dwordx2 v[180:181], v5, s[24:27], s56 offen offset:1024 sc1
    buffer_store_dwordx2 v[182:183], v5, s[24:27], s56 offen offset:1536 sc1
    s_branch L_qdone
L_consv:
    ds_read_b128 v[16:19], v8 offset:0
    ds_read_b64_tr_b16 v[32:33], v12 offset:0
    ds_read_b64_tr_b16 v[34:35], v12 offset:1024
    ds_read_b64_tr_b16 v[36:37], v13 offset:0
    ds_read_b64_tr_b16 v[38:39], v13 offset:1024
    ds_read_b128 v[20:23], v8 offset:4096
    ds_read_b128 v[24:27], v8 offset:8192
    ds_read_b128 v[28:31], v8 offset:12288
    s_mov_b32 s50, 0
    s_mov_b32 s51, 0
    s_mov_b32 s52, 49152
.p2align 3
qloop_54:
    s_waitcnt lgkmcnt(5)
    v_mfma_f32_32x32x16_bf16 v[64:79], v[16:19], v[32:35], v[64:79]
    ds_read_b128 v[40:43], v9 offset:0
    s_waitcnt lgkmcnt(4)
    v_mfma_f32_32x32x16_bf16 v[80:95], v[16:19], v[36:39], v[80:95]
    ds_read_b64_tr_b16 v[56:57], v12 offset:4096
    s_waitcnt lgkmcnt(4)
    v_mfma_f32_32x32x16_bf16 v[96:111], v[20:23], v[32:35], v[96:111]
    ds_read_b64_tr_b16 v[58:59], v12 offset:5120
    v_mfma_f32_32x32x16_bf16 v[112:127], v[20:23], v[36:39], v[112:127]
    ds_read_b64_tr_b16 v[60:61], v13 offset:4096
    s_waitcnt lgkmcnt(5)
    v_mfma_f32_32x32x16_bf16 v[128:143], v[24:27], v[32:35], v[128:143]
    ds_read_b64_tr_b16 v[62:63], v13 offset:5120
    v_mfma_f32_32x32x16_bf16 v[144:159], v[24:27], v[36:39], v[144:159]
    ds_read_b128 v[44:47], v9 offset:4096
    s_waitcnt lgkmcnt(6)
    v_mfma_f32_32x32x16_bf16 v[160:175], v[28:31], v[32:35], v[160:175]
    ds_read_b128 v[48:51], v9 offset:8192
    v_mfma_f32_32x32x16_bf16 v[176:191], v[28:31], v[36:39], v[176:191]
    ds_read_b128 v[52:55], v9 offset:12288
    s_waitcnt lgkmcnt(5)
    v_mfma_f32_32x32x16_bf16 v[64:79], v[40:43], v[56:59], v[64:79]
    ds_read_b128 v[16:19], v10 offset:0
    s_waitcnt lgkmcnt(4)
    v_mfma_f32_32x32x16_bf16 v[80:95], v[40:43], v[60:63], v[80:95]
    ds_read_b64_tr_b16 v[32:33], v12 offset:8192
    s_waitcnt lgkmcnt(4)
    v_mfma_f32_32x32x16_bf16 v[96:111], v[44:47], v[56:59], v[96:111]
    ds_read_b64_tr_b16 v[34:35], v12 offset:9216
    v_mfma_f32_32x32x16_bf16 v[112:127], v[44:47], v[60:63], v[112:127]
    ds_read_b64_tr_b16 v[36:37], v13 offset:8192
    s_waitcnt lgkmcnt(5)
    v_mfma_f32_32x32x16_bf16 v[128:143], v[48:51], v[56:59], v[128:143]
    ds_read_b64_tr_b16 v[38:39], v13 offset:9216
    v_mfma_f32_32x32x16_bf16 v[144:159], v[48:51], v[60:63], v[144:159]
    ds_read_b128 v[20:23], v10 offset:4096
    s_waitcnt lgkmcnt(6)
    v_mfma_f32_32x32x16_bf16 v[160:175], v[52:55], v[56:59], v[160:175]
    ds_read_b128 v[24:27], v10 offset:8192
    v_mfma_f32_32x32x16_bf16 v[176:191], v[52:55], v[60:63], v[176:191]
    ds_read_b128 v[28:31], v10 offset:12288
    s_waitcnt lgkmcnt(5)
    v_mfma_f32_32x32x16_bf16 v[64:79], v[16:19], v[32:35], v[64:79]
    ds_read_b128 v[40:43], v11 offset:0
    s_waitcnt lgkmcnt(4)
    v_mfma_f32_32x32x16_bf16 v[80:95], v[16:19], v[36:39], v[80:95]
    ds_read_b64_tr_b16 v[56:57], v12 offset:12288
    s_waitcnt lgkmcnt(4)
    v_mfma_f32_32x32x16_bf16 v[96:111], v[20:23], v[32:35], v[96:111]
    ds_read_b64_tr_b16 v[58:59], v12 offset:13312
    v_mfma_f32_32x32x16_bf16 v[112:127], v[20:23], v[36:39], v[112:127]
    ds_read_b64_tr_b16 v[60:61], v13 offset:12288
    s_waitcnt lgkmcnt(5)
    v_mfma_f32_32x32x16_bf16 v[128:143], v[24:27], v[32:35], v[128:143]
    ds_read_b64_tr_b16 v[62:63], v13 offset:13312
    v_mfma_f32_32x32x16_bf16 v[144:159], v[24:27], v[36:39], v[144:159]
    ds_read_b128 v[44:47], v11 offset:4096
    s_waitcnt lgkmcnt(6)
    v_mfma_f32_32x32x16_bf16 v[160:175], v[28:31], v[32:35], v[160:175]
    ds_read_b128 v[48:51], v11 offset:8192
    v_mfma_f32_32x32x16_bf16 v[176:191], v[28:31], v[36:39], v[176:191]
    ds_read_b128 v[52:55], v11 offset:12288
    s_waitcnt lgkmcnt(5)
    v_mfma_f32_32x32x16_bf16 v[64:79], v[40:43], v[56:59], v[64:79]
    s_cmp_eq_u32 s50, 9
    s_cbranch_scc1 qlast_55
    s_add_u32 s51, s51, 1
    s_cmp_eq_u32 s51, 3
    s_waitcnt lgkmcnt(3)
    v_mfma_f32_32x32x16_bf16 v[80:95], v[40:43], v[60:63], v[80:95]
    s_cselect_b32 s51, 0, s51
    s_cselect_b32 s53, -98304, s52
    v_add_u32 v8, s53, v8
    v_add_u32 v9, s53, v9
    v_add_u32 v10, s53, v10
    s_waitcnt lgkmcnt(2)
    v_mfma_f32_32x32x16_bf16 v[96:111], v[44:47], v[56:59], v[96:111]
    v_add_u32 v11, s53, v11
    v_add_u32 v12, s53, v12
    v_add_u32 v13, s53, v13
    s_waitcnt lgkmcnt(0)
    v_mfma_f32_32x32x16_bf16 v[112:127], v[44:47], v[60:63], v[112:127]
    s_barrier
    ds_read_b128 v[16:19], v8 offset:0
    ds_read_b64_tr_b16 v[32:33], v12 offset:0
    v_mfma_f32_32x32x16_bf16 v[128:143], v[48:51], v[56:59], v[128:143]
    ds_read_b64_tr_b16 v[34:35], v12 offset:1024
    ds_read_b64_tr_b16 v[36:37], v13 offset:0
    v_mfma_f32_32x32x16_bf16 v[144:159], v[48:51], v[60:63], v[144:159]
    ds_read_b64_tr_b16 v[38:39], v13 offset:1024
    ds_read_b128 v[20:23], v8 offset:4096
    v_mfma_f32_32x32x16_bf16 v[160:175], v[52:55], v[56:59], v[160:175]
    ds_read_b128 v[24:27], v8 offset:8192
    ds_read_b128 v[28:31], v8 offset:12288
    s_add_u32 s50, s50, 1
    v_mfma_f32_32x32x16_bf16 v[176:191], v[52:55], v[60:63], v[176:191]
    s_branch qloop_54
qlast_55:
    s_waitcnt lgkmcnt(0)
    v_mfma_f32_32x32x16_bf16 v[80:95], v[40:43], v[60:63], v[80:95]
    v_mfma_f32_32x32x16_bf16 v[96:111], v[44:47], v[56:59], v[96:111]
    v_mfma_f32_32x32x16_bf16 v[112:127], v[44:47], v[60:63], v[112:127]
    v_mfma_f32_32x32x16_bf16 v[128:143], v[48:51], v[56:59], v[128:143]
    v_mfma_f32_32x32x16_bf16 v[144:159], v[48:51], v[60:63], v[144:159]
    v_mfma_f32_32x32x16_bf16 v[160:175], v[52:55], v[56:59], v[160:175]
    v_mfma_f32_32x32x16_bf16 v[176:191], v[52:55], v[60:63], v[176:191]
    s_setprio 3
    s_lshl_b32 s50, s76, 3
    s_lshl_b32 s51, s48, 2
    s_add_u32 s50, s50, s51
    s_mul_i32 s50, s50, 40960
    s_lshl_b32 s53, s77, 7
    s_lshl_b32 s54, s49, 6
    s_add_u32 s53, s53, s54
    s_lshl_b32 s51, s48, 9
    s_add_u32 s51, s51, 147456
    s_lshl_b32 s54, s49, 8
    s_lshl_b32 s55, s48, 7
    s_add_u32 s54, s54, s55
    s_add_u32 s54, s54, 149504
    v_and_b32 v14, 31, v1
    v_lshrrev_b32 v15, 5, v1
    v_lshlrev_b32 v4, 2, v14
    v_lshlrev_b32 v5, 4, v15
    v_add_u32 v4, s54, v4
    v_add_u32 v9, s51, v5
    v_xor_b32 v8, 128, v4
    ds_read_b32 v192, v4
    ds_read_b32 v194, v8
    s_lshl_b32 s56, s53, 4
    s_add_u32 s56, s56, s50
    s_add_u32 s56, s56, 11415552
    s_add_u32 s57, s56, 20480
    v_mul_u32_u24 v4, 10240, v15
    v_lshl_add_u32 v4, v14, 4, v4
    s_lshl_b32 s55, s48, 9
    v_add_u32 v4, s55, v4
    v_xor_b32 v5, 512, v4
    ds_read_b128 v[16:19], v9 offset:0
    ds_read_b128 v[32:35], v9 offset:1024
    ds_read_b128 v[20:23], v9 offset:32
    ds_read_b128 v[36:39], v9 offset:1056
    ds_read_b128 v[24:27], v9 offset:64
    ds_read_b128 v[40:43], v9 offset:1088
    ds_read_b128 v[28:31], v9 offset:96
    ds_read_b128 v[44:47], v9 offset:1120
    ds_read_b128 v[212:215], v9 offset:128
    ds_read_b128 v[228:231], v9 offset:1152
    ds_read_b128 v[216:219], v9 offset:160
    ds_read_b128 v[232:235], v9 offset:1184
    ds_read_b128 v[220:223], v9 offset:192
    ds_read_b128 v[236:239], v9 offset:1216
    ds_read_b128 v[224:227], v9 offset:224
    ds_read_b128 v[240:243], v9 offset:1248
    s_waitcnt lgkmcnt(8)
    v_pk_mul_f32 v[64:65], v[64:65], v[16:17]
    v_pk_mul_f32 v[66:67], v[66:67], v[18:19]
    v_pk_mul_f32 v[68:69], v[68:69], v[20:21]
    v_pk_mul_f32 v[70:71], v[70:71], v[22:23]
    v_pk_mul_f32 v[72:73], v[72:73], v[24:25]
    v_pk_mul_f32 v[74:75], v[74:75], v[26:27]
    v_pk_mul_f32 v[76:77], v[76:77], v[28:29]
    v_pk_mul_f32 v[78:79], v[78:79], v[30:31]
    v_pk_fma_f32 v[64:65], v[32:33], v[192:193], v[64:65] op_sel_hi:[1,0,1] neg_lo:[0,1,0] neg_hi:[0,1,0]
    v_pk_fma_f32 v[66:67], v[34:35], v[192:193], v[66:67] op_sel_hi:[1,0,1] neg_lo:[0,1,0] neg_hi:[0,1,0]
    v_pk_fma_f32 v[68:69], v[36:37], v[192:193], v[68:69] op_sel_hi:[1,0,1] neg_lo:[0,1,0] neg_hi:[0,1,0]
    v_pk_fma_f32 v[70:71], v[38:39], v[192:193], v[70:71] op_sel_hi:[1,0,1] neg_lo:[0,1,0] neg_hi:[0,1,0]
    v_pk_fma_f32 v[72:73], v[40:41], v[192:193], v[72:73] op_sel_hi:[1,0,1] neg_lo:[0,1,0] neg_hi:[0,1,0]
    v_pk_fma_f32 v[74:75], v[42:43], v[192:193], v[74:75] op_sel_hi:[1,0,1] neg_lo:[0,1,0] neg_hi:[0,1,0]
    v_pk_fma_f32 v[76:77], v[44:45], v[192:193], v[76:77] op_sel_hi:[1,0,1] neg_lo:[0,1,0] neg_hi:[0,1,0]
    v_pk_fma_f32 v[78:79], v[46:47], v[192:193], v[78:79] op_sel_hi:[1,0,1] neg_lo:[0,1,0] neg_hi:[0,1,0]
    v_cvt_pk_bf16_f32 v64, v64, v65
    v_cvt_pk_bf16_f32 v65, v66, v67
    v_cvt_pk_bf16_f32 v66, v68, v69
    v_cvt_pk_bf16_f32 v67, v70, v71
    v_cvt_pk_bf16_f32 v68, v72, v73
    v_cvt_pk_bf16_f32 v69, v74, v75
    v_cvt_pk_bf16_f32 v70, v76, v77
    v_cvt_pk_bf16_f32 v71, v78, v79
    buffer_store_dwordx4 v[64:67], v4, s[24:27], s56 offen sc1
    buffer_store_dwordx4 v[68:71], v4, s[24:27], s57 offen sc1
    v_pk_mul_f32 v[80:81], v[80:81], v[16:17]
    v_pk_mul_f32 v[82:83], v[82:83], v[18:19]
    v_pk_mul_f32 v[84:85], v[84:85], v[20:21]
    v_pk_mul_f32 v[86:87], v[86:87], v[22:23]
    v_pk_mul_f32 v[88:89], v[88:89], v[24:25]
    v_pk_mul_f32 v[90:91], v[90:91], v[26:27]
    v_pk_mul_f32 v[92:93], v[92:93], v[28:29]
    v_pk_mul_f32 v[94:95], v[94:95], v[30:31]
    v_pk_fma_f32 v[80:81], v[32:33], v[194:195], v[80:81] op_sel_hi:[1,0,1] neg_lo:[0,1,0] neg_hi:[0,1,0]
    v_pk_fma_f32 v[82:83], v[34:35], v[194:195], v[82:83] op_sel_hi:[1,0,1] neg_lo:[0,1,0] neg_hi:[0,1,0]
    v_pk_fma_f32 v[84:85], v[36:37], v[194:195], v[84:85] op_sel_hi:[1,0,1] neg_lo:[0,1,0] neg_hi:[0,1,0]
    v_pk_fma_f32 v[86:87], v[38:39], v[194:195], v[86:87] op_sel_hi:[1,0,1] neg_lo:[0,1,0] neg_hi:[0,1,0]
    v_pk_fma_f32 v[88:89], v[40:41], v[194:195], v[88:89] op_sel_hi:[1,0,1] neg_lo:[0,1,0] neg_hi:[0,1,0]
    v_pk_fma_f32 v[90:91], v[42:43], v[194:195], v[90:91] op_sel_hi:[1,0,1] neg_lo:[0,1,0] neg_hi:[0,1,0]
    v_pk_fma_f32 v[92:93], v[44:45], v[194:195], v[92:93] op_sel_hi:[1,0,1] neg_lo:[0,1,0] neg_hi:[0,1,0]
    v_pk_fma_f32 v[94:95], v[46:47], v[194:195], v[94:95] op_sel_hi:[1,0,1] neg_lo:[0,1,0] neg_hi:[0,1,0]
    v_cvt_pk_bf16_f32 v80, v80, v81
    v_cvt_pk_bf16_f32 v81, v82, v83
    v_cvt_pk_bf16_f32 v82, v84, v85
    v_cvt_pk_bf16_f32 v83, v86, v87
    v_cvt_pk_bf16_f32 v84, v88, v89
    v_cvt_pk_bf16_f32 v85, v90, v91
    v_cvt_pk_bf16_f32 v86, v92, v93
    v_cvt_pk_bf16_f32 v87, v94, v95
    buffer_store_dwordx4 v[80:83], v5, s[24:27], s56 offen sc1
    buffer_store_dwordx4 v[84:87], v5, s[24:27], s57 offen sc1
    s_add_u32 s56, s56, 40960
    s_add_u32 s57, s57, 40960
    ds_read_b128 v[16:19], v9 offset:256
    ds_read_b128 v[32:35], v9 offset:1280
    ds_read_b128 v[20:23], v9 offset:288
    ds_read_b128 v[36:39], v9 offset:1312
    ds_read_b128 v[24:27], v9 offset:320
    ds_read_b128 v[40:43], v9 offset:1344
    ds_read_b128 v[28:31], v9 offset:352
    ds_read_b128 v[44:47], v9 offset:1376
    s_waitcnt lgkmcnt(8)
    v_pk_mul_f32 v[96:97], v[96:97], v[212:213]
    v_pk_mul_f32 v[98:99], v[98:99], v[214:215]
    v_pk_mul_f32 v[100:101], v[100:101], v[216:217]
    v_pk_mul_f32 v[102:103], v[102:103], v[218:219]
    v_pk_mul_f32 v[104:105], v[104:105], v[220:221]
    v_pk_mul_f32 v[106:107], v[106:107], v[222:223]
    v_pk_mul_f32 v[108:109], v[108:109], v[224:225]
    v_pk_mul_f32 v[110:111], v[110:111], v[226:227]
    v_pk_fma_f32 v[96:97], v[228:229], v[192:193], v[96:97] op_sel_hi:[1,0,1] neg_lo:[0,1,0] neg_hi:[0,1,0]
    v_pk_fma_f32 v[98:99], v[230:231], v[192:193], v[98:99] op_sel_hi:[1,0,1] neg_lo:[0,1,0] neg_hi:[0,1,0]
    v_pk_fma_f32 v[100:101], v[232:233], v[192:193], v[100:101] op_sel_hi:[1,0,1] neg_lo:[0,1,0] neg_hi:[0,1,0]
    v_pk_fma_f32 v[102:103], v[234:235], v[192:193], v[102:103] op_sel_hi:[1,0,1] neg_lo:[0,1,0] neg_hi:[0,1,0]
    v_pk_fma_f32 v[104:105], v[236:237], v[192:193], v[104:105] op_sel_hi:[1,0,1] neg_lo:[0,1,0] neg_hi:[0,1,0]
    v_pk_fma_f32 v[106:107], v[238:239], v[192:193], v[106:107] op_sel_hi:[1,0,1] neg_lo:[0,1,0] neg_hi:[0,1,0]
    v_pk_fma_f32 v[108:109], v[240:241], v[192:193], v[108:109] op_sel_hi:[1,0,1] neg_lo:[0,1,0] neg_hi:[0,1,0]
    v_pk_fma_f32 v[110:111], v[242:243], v[192:193], v[110:111] op_sel_hi:[1,0,1] neg_lo:[0,1,0] neg_hi:[0,1,0]
    v_cvt_pk_bf16_f32 v96, v96, v97
    v_cvt_pk_bf16_f32 v97, v98, v99
    v_cvt_pk_bf16_f32 v98, v100, v101
    v_cvt_pk_bf16_f32 v99, v102, v103
    v_cvt_pk_bf16_f32 v100, v104, v105
    v_cvt_pk_bf16_f32 v101, v106, v107
    v_cvt_pk_bf16_f32 v102, v108, v109
    v_cvt_pk_bf16_f32 v103, v110, v111
    buffer_store_dwordx4 v[96:99], v4, s[24:27], s56 offen sc1
    buffer_store_dwordx4 v[100:103], v4, s[24:27], s57 offen sc1
    v_pk_mul_f32 v[112:113], v[112:113], v[212:213]
    v_pk_mul_f32 v[114:115], v[114:115], v[214:215]
    v_pk_mul_f32 v[116:117], v[116:117], v[216:217]
    v_pk_mul_f32 v[118:119], v[118:119], v[218:219]
    v_pk_mul_f32 v[120:121], v[120:121], v[220:221]
    v_pk_mul_f32 v[122:123], v[122:123], v[222:223]
    v_pk_mul_f32 v[124:125], v[124:125], v[224:225]
    v_pk_mul_f32 v[126:127], v[126:127], v[226:227]
    v_pk_fma_f32 v[112:113], v[228:229], v[194:195], v[112:113] op_sel_hi:[1,0,1] neg_lo:[0,1,0] neg_hi:[0,1,0]
    v_pk_fma_f32 v[114:115], v[230:231], v[194:195], v[114:115] op_sel_hi:[1,0,1] neg_lo:[0,1,0] neg_hi:[0,1,0]
    v_pk_fma_f32 v[116:117], v[232:233], v[194:195], v[116:117] op_sel_hi:[1,0,1] neg_lo:[0,1,0] neg_hi:[0,1,0]
    v_pk_fma_f32 v[118:119], v[234:235], v[194:195], v[118:119] op_sel_hi:[1,0,1] neg_lo:[0,1,0] neg_hi:[0,1,0]
    v_pk_fma_f32 v[120:121], v[236:237], v[194:195], v[120:121] op_sel_hi:[1,0,1] neg_lo:[0,1,0] neg_hi:[0,1,0]
    v_pk_fma_f32 v[122:123], v[238:239], v[194:195], v[122:123] op_sel_hi:[1,0,1] neg_lo:[0,1,0] neg_hi:[0,1,0]
    v_pk_fma_f32 v[124:125], v[240:241], v[194:195], v[124:125] op_sel_hi:[1,0,1] neg_lo:[0,1,0] neg_hi:[0,1,0]
    v_pk_fma_f32 v[126:127], v[242:243], v[194:195], v[126:127] op_sel_hi:[1,0,1] neg_lo:[0,1,0] neg_hi:[0,1,0]
    v_cvt_pk_bf16_f32 v112, v112, v113
    v_cvt_pk_bf16_f32 v113, v114, v115
    v_cvt_pk_bf16_f32 v114, v116, v117
    v_cvt_pk_bf16_f32 v115, v118, v119
    v_cvt_pk_bf16_f32 v116, v120, v121
    v_cvt_pk_bf16_f32 v117, v122, v123
    v_cvt_pk_bf16_f32 v118, v124, v125
    v_cvt_pk_bf16_f32 v119, v126, v127
    buffer_store_dwordx4 v[112:115], v5, s[24:27], s56 offen sc1
    buffer_store_dwordx4 v[116:119], v5, s[24:27], s57 offen sc1
    s_add_u32 s56, s56, 40960
    s_add_u32 s57, s57, 40960
    ds_read_b128 v[212:215], v9 offset:384
    ds_read_b128 v[228:231], v9 offset:1408
    ds_read_b128 v[216:219], v9 offset:416
    ds_read_b128 v[232:235], v9 offset:1440
    ds_read_b128 v[220:223], v9 offset:448
    ds_read_b128 v[236:239], v9 offset:1472
    ds_read_b128 v[224:227], v9 offset:480
    ds_read_b128 v[240:243], v9 offset:1504
    s_waitcnt lgkmcnt(8)
    v_pk_mul_f32 v[128:129], v[128:129], v[16:17]
    v_pk_mul_f32 v[130:131], v[130:131], v[18:19]
    v_pk_mul_f32 v[132:133], v[132:133], v[20:21]
    v_pk_mul_f32 v[134:135], v[134:135], v[22:23]
    v_pk_mul_f32 v[136:137], v[136:137], v[24:25]
    v_pk_mul_f32 v[138:139], v[138:139], v[26:27]
    v_pk_mul_f32 v[140:141], v[140:141], v[28:29]
    v_pk_mul_f32 v[142:143], v[142:143], v[30:31]
    v_pk_fma_f32 v[128:129], v[32:33], v[192:193], v[128:129] op_sel_hi:[1,0,1] neg_lo:[0,1,0] neg_hi:[0,1,0]
    v_pk_fma_f32 v[130:131], v[34:35], v[192:193], v[130:131] op_sel_hi:[1,0,1] neg_lo:[0,1,0] neg_hi:[0,1,0]
    v_pk_fma_f32 v[132:133], v[36:37], v[192:193], v[132:133] op_sel_hi:[1,0,1] neg_lo:[0,1,0] neg_hi:[0,1,0]
    v_pk_fma_f32 v[134:135], v[38:39], v[192:193], v[134:135] op_sel_hi:[1,0,1] neg_lo:[0,1,0] neg_hi:[0,1,0]
    v_pk_fma_f32 v[136:137], v[40:41], v[192:193], v[136:137] op_sel_hi:[1,0,1] neg_lo:[0,1,0] neg_hi:[0,1,0]
    v_pk_fma_f32 v[138:139], v[42:43], v[192:193], v[138:139] op_sel_hi:[1,0,1] neg_lo:[0,1,0] neg_hi:[0,1,0]
    v_pk_fma_f32 v[140:141], v[44:45], v[192:193], v[140:141] op_sel_hi:[1,0,1] neg_lo:[0,1,0] neg_hi:[0,1,0]
    v_pk_fma_f32 v[142:143], v[46:47], v[192:193], v[142:143] op_sel_hi:[1,0,1] neg_lo:[0,1,0] neg_hi:[0,1,0]
    v_cvt_pk_bf16_f32 v128, v128, v129
    v_cvt_pk_bf16_f32 v129, v130, v131
    v_cvt_pk_bf16_f32 v130, v132, v133
    v_cvt_pk_bf16_f32 v131, v134, v135
    v_cvt_pk_bf16_f32 v132, v136, v137
    v_cvt_pk_bf16_f32 v133, v138, v139
    v_cvt_pk_bf16_f32 v134, v140, v141
    v_cvt_pk_bf16_f32 v135, v142, v143
    buffer_store_dwordx4 v[128:131], v4, s[24:27], s56 offen sc1
    buffer_store_dwordx4 v[132:135], v4, s[24:27], s57 offen sc1
    v_pk_mul_f32 v[144:145], v[144:145], v[16:17]
    v_pk_mul_f32 v[146:147], v[146:147], v[18:19]
    v_pk_mul_f32 v[148:149], v[148:149], v[20:21]
    v_pk_mul_f32 v[150:151], v[150:151], v[22:23]
    v_pk_mul_f32 v[152:153], v[152:153], v[24:25]
    v_pk_mul_f32 v[154:155], v[154:155], v[26:27]
    v_pk_mul_f32 v[156:157], v[156:157], v[28:29]
    v_pk_mul_f32 v[158:159], v[158:159], v[30:31]
    v_pk_fma_f32 v[144:145], v[32:33], v[194:195], v[144:145] op_sel_hi:[1,0,1] neg_lo:[0,1,0] neg_hi:[0,1,0]
    v_pk_fma_f32 v[146:147], v[34:35], v[194:195], v[146:147] op_sel_hi:[1,0,1] neg_lo:[0,1,0] neg_hi:[0,1,0]
    v_pk_fma_f32 v[148:149], v[36:37], v[194:195], v[148:149] op_sel_hi:[1,0,1] neg_lo:[0,1,0] neg_hi:[0,1,0]
    v_pk_fma_f32 v[150:151], v[38:39], v[194:195], v[150:151] op_sel_hi:[1,0,1] neg_lo:[0,1,0] neg_hi:[0,1,0]
    v_pk_fma_f32 v[152:153], v[40:41], v[194:195], v[152:153] op_sel_hi:[1,0,1] neg_lo:[0,1,0] neg_hi:[0,1,0]
    v_pk_fma_f32 v[154:155], v[42:43], v[194:195], v[154:155] op_sel_hi:[1,0,1] neg_lo:[0,1,0] neg_hi:[0,1,0]
    v_pk_fma_f32 v[156:157], v[44:45], v[194:195], v[156:157] op_sel_hi:[1,0,1] neg_lo:[0,1,0] neg_hi:[0,1,0]
    v_pk_fma_f32 v[158:159], v[46:47], v[194:195], v[158:159] op_sel_hi:[1,0,1] neg_lo:[0,1,0] neg_hi:[0,1,0]
    v_cvt_pk_bf16_f32 v144, v144, v145
    v_cvt_pk_bf16_f32 v145, v146, v147
    v_cvt_pk_bf16_f32 v146, v148, v149
    v_cvt_pk_bf16_f32 v147, v150, v151
    v_cvt_pk_bf16_f32 v148, v152, v153
    v_cvt_pk_bf16_f32 v149, v154, v155
    v_cvt_pk_bf16_f32 v150, v156, v157
    v_cvt_pk_bf16_f32 v151, v158, v159
    buffer_store_dwordx4 v[144:147], v5, s[24:27], s56 offen sc1
    buffer_store_dwordx4 v[148:151], v5, s[24:27], s57 offen sc1
    s_add_u32 s56, s56, 40960
    s_add_u32 s57, s57, 40960
    s_waitcnt lgkmcnt(0)
    v_pk_mul_f32 v[160:161], v[160:161], v[212:213]
    v_pk_mul_f32 v[162:163], v[162:163], v[214:215]
    v_pk_mul_f32 v[164:165], v[164:165], v[216:217]
    v_pk_mul_f32 v[166:167], v[166:167], v[218:219]
    v_pk_mul_f32 v[168:169], v[168:169], v[220:221]
    v_pk_mul_f32 v[170:171], v[170:171], v[222:223]
    v_pk_mul_f32 v[172:173], v[172:173], v[224:225]
    v_pk_mul_f32 v[174:175], v[174:175], v[226:227]
    v_pk_fma_f32 v[160:161], v[228:229], v[192:193], v[160:161] op_sel_hi:[1,0,1] neg_lo:[0,1,0] neg_hi:[0,1,0]
    v_pk_fma_f32 v[162:163], v[230:231], v[192:193], v[162:163] op_sel_hi:[1,0,1] neg_lo:[0,1,0] neg_hi:[0,1,0]
    v_pk_fma_f32 v[164:165], v[232:233], v[192:193], v[164:165] op_sel_hi:[1,0,1] neg_lo:[0,1,0] neg_hi:[0,1,0]
    v_pk_fma_f32 v[166:167], v[234:235], v[192:193], v[166:167] op_sel_hi:[1,0,1] neg_lo:[0,1,0] neg_hi:[0,1,0]
    v_pk_fma_f32 v[168:169], v[236:237], v[192:193], v[168:169] op_sel_hi:[1,0,1] neg_lo:[0,1,0] neg_hi:[0,1,0]
    v_pk_fma_f32 v[170:171], v[238:239], v[192:193], v[170:171] op_sel_hi:[1,0,1] neg_lo:[0,1,0] neg_hi:[0,1,0]
    v_pk_fma_f32 v[172:173], v[240:241], v[192:193], v[172:173] op_sel_hi:[1,0,1] neg_lo:[0,1,0] neg_hi:[0,1,0]
    v_pk_fma_f32 v[174:175], v[242:243], v[192:193], v[174:175] op_sel_hi:[1,0,1] neg_lo:[0,1,0] neg_hi:[0,1,0]
    v_cvt_pk_bf16_f32 v160, v160, v161
    v_cvt_pk_bf16_f32 v161, v162, v163
    v_cvt_pk_bf16_f32 v162, v164, v165
    v_cvt_pk_bf16_f32 v163, v166, v167
    v_cvt_pk_bf16_f32 v164, v168, v169
    v_cvt_pk_bf16_f32 v165, v170, v171
    v_cvt_pk_bf16_f32 v166, v172, v173
    v_cvt_pk_bf16_f32 v167, v174, v175
    buffer_store_dwordx4 v[160:163], v4, s[24:27], s56 offen sc1
    buffer_store_dwordx4 v[164:167], v4, s[24:27], s57 offen sc1
    v_pk_mul_f32 v[176:177], v[176:177], v[212:213]
    v_pk_mul_f32 v[178:179], v[178:179], v[214:215]
    v_pk_mul_f32 v[180:181], v[180:181], v[216:217]
    v_pk_mul_f32 v[182:183], v[182:183], v[218:219]
    v_pk_mul_f32 v[184:185], v[184:185], v[220:221]
    v_pk_mul_f32 v[186:187], v[186:187], v[222:223]
    v_pk_mul_f32 v[188:189], v[188:189], v[224:225]
    v_pk_mul_f32 v[190:191], v[190:191], v[226:227]
    v_pk_fma_f32 v[176:177], v[228:229], v[194:195], v[176:177] op_sel_hi:[1,0,1] neg_lo:[0,1,0] neg_hi:[0,1,0]
    v_pk_fma_f32 v[178:179], v[230:231], v[194:195], v[178:179] op_sel_hi:[1,0,1] neg_lo:[0,1,0] neg_hi:[0,1,0]
    v_pk_fma_f32 v[180:181], v[232:233], v[194:195], v[180:181] op_sel_hi:[1,0,1] neg_lo:[0,1,0] neg_hi:[0,1,0]
    v_pk_fma_f32 v[182:183], v[234:235], v[194:195], v[182:183] op_sel_hi:[1,0,1] neg_lo:[0,1,0] neg_hi:[0,1,0]
    v_pk_fma_f32 v[184:185], v[236:237], v[194:195], v[184:185] op_sel_hi:[1,0,1] neg_lo:[0,1,0] neg_hi:[0,1,0]
    v_pk_fma_f32 v[186:187], v[238:239], v[194:195], v[186:187] op_sel_hi:[1,0,1] neg_lo:[0,1,0] neg_hi:[0,1,0]
    v_pk_fma_f32 v[188:189], v[240:241], v[194:195], v[188:189] op_sel_hi:[1,0,1] neg_lo:[0,1,0] neg_hi:[0,1,0]
    v_pk_fma_f32 v[190:191], v[242:243], v[194:195], v[190:191] op_sel_hi:[1,0,1] neg_lo:[0,1,0] neg_hi:[0,1,0]
    v_cvt_pk_bf16_f32 v176, v176, v177
    v_cvt_pk_bf16_f32 v177, v178, v179
    v_cvt_pk_bf16_f32 v178, v180, v181
    v_cvt_pk_bf16_f32 v179, v182, v183
    v_cvt_pk_bf16_f32 v180, v184, v185
    v_cvt_pk_bf16_f32 v181, v186, v187
    v_cvt_pk_bf16_f32 v182, v188, v189
    v_cvt_pk_bf16_f32 v183, v190, v191
    buffer_store_dwordx4 v[176:179], v5, s[24:27], s56 offen sc1
    buffer_store_dwordx4 v[180:183], v5, s[24:27], s57 offen sc1
L_qdone:
    s_mul_i32 s57, s45, 17
    s_add_u32 s57, s57, s46
    s_sub_u32 s57, s57, 15
    s_mul_i32 s80, s57, 205
    s_lshr_b32 s80, s80, 10
    s_mul_i32 s58, s80, 5
    s_sub_u32 s79, s57, s58
    s_and_b32 s56, s45, 1
    s_lshl_b32 s56, s56, 2
    s_lshr_b32 s58, s45, 1
    s_and_b32 s57, s46, 3
    s_add_u32 s82, s56, s57
    s_lshl_b32 s58, s58, 3
    s_lshr_b32 s57, s46, 2
    s_xor_b32 s57, s57, 0
    s_add_u32 s83, s58, s57
    s_mov_b32 s81, 0
    s_lshl_b32 s61, s76, 8
    s_add_u32 s61, s61, 32768
    s_waitcnt vmcnt(0)
    v_mov_b32 v2, 163776
    v_mov_b32 v3, 1
    s_mov_b64 exec, 1
    ds_add_rtn_u32 v14, v2, v3
    s_waitcnt lgkmcnt(0)
    v_readfirstlane_b32 s60, v14
    s_cmp_lg_u32 s60, 3
    s_cbranch_scc1 arr_58
    v_mov_b32 v3, 1
    buffer_atomic_add v3, off, s[24:27], s61 sc0 sc1
    s_waitcnt vmcnt(0)
    v_readfirstlane_b32 s60, v3
    s_cmp_lg_u32 s60, 14
    s_cbranch_scc1 arr_58f
    v_mov_b32 v3, 1
    buffer_store_dword v3, off, s[24:27], s61 offset:128 sc1
arr_58f:
    v_mov_b32 v2, 163724
    v_mov_b32 v3, 1
    ds_write_b32 v2, v3
arr_58:
    s_mov_b64 exec, -1
L_attn:
    s_lshl_b32 s48, s45, 2
    s_and_b32 s47, s46, 3
    s_add_u32 s48, s48, s47
    s_lshr_b32 s49, s46, 2
    s_lshl_b32 s50, s49, 3
    s_sub_u32 s51, s50, 8
    s_cmp_eq_u32 s49, 0
    s_cselect_b32 s52, 0, s51
    s_cmp_ge_u32 s44, 2
    s_cselect_b32 s51, s51, s52
    s_lshl_b32 s52, s44, 2
    s_add_u32 s51, s51, s52
    s_mul_i32 s51, s51, 40960
    v_and_b32 v2, 31, v1
    v_lshrrev_b32 v3, 5, v1
    v_lshlrev_b32 v3, 2, v3
    v_sub_u32 v2, v2, v3
    v_mov_b32 v3, 0xff800000
    v_cmp_le_i32 s[66:67], 0, v2
    v_cmp_le_i32 s[68:69], 1, v2
    v_cmp_le_i32 s[70:71], 2, v2
    v_cmp_le_i32 s[72:73], 3, v2
    v_cndmask_b32 v160, v3, 0, s[66:67]
    v_cndmask_b32 v176, 0, v3, s[66:67]
    v_cndmask_b32 v161, v3, 0, s[68:69]
    v_cndmask_b32 v177, 0, v3, s[68:69]
    v_cndmask_b32 v162, v3, 0, s[70:71]
    v_cndmask_b32 v178, 0, v3, s[70:71]
    v_cndmask_b32 v163, v3, 0, s[72:73]
    v_cndmask_b32 v179, 0, v3, s[72:73]
    v_cmp_le_i32 s[66:67], 8, v2
    v_cmp_le_i32 s[68:69], 9, v2
    v_cmp_le_i32 s[70:71], 10, v2
    v_cmp_le_i32 s[72:73], 11, v2
    v_cndmask_b32 v164, v3, 0, s[66:67]
    v_cndmask_b32 v180, 0, v3, s[66:67]
    v_cndmask_b32 v165, v3, 0, s[68:69]
    v_cndmask_b32 v181, 0, v3, s[68:69]
    v_cndmask_b32 v166, v3, 0, s[70:71]
    v_cndmask_b32 v182, 0, v3, s[70:71]
    v_cndmask_b32 v167, v3, 0, s[72:73]
    v_cndmask_b32 v183, 0, v3, s[72:73]
    v_cmp_le_i32 s[66:67], 16, v2
    v_cmp_le_i32 s[68:69], 17, v2
    v_cmp_le_i32 s[70:71], 18, v2
    v_cmp_le_i32 s[72:73], 19, v2
    v_cndmask_b32 v168, v3, 0, s[66:67]
    v_cndmask_b32 v184, 0, v3, s[66:67]
    v_cndmask_b32 v169, v3, 0, s[68:69]
    v_cndmask_b32 v185, 0, v3, s[68:69]
    v_cndmask_b32 v170, v3, 0, s[70:71]
    v_cndmask_b32 v186, 0, v3, s[70:71]
    v_cndmask_b32 v171, v3, 0, s[72:73]
    v_cndmask_b32 v187, 0, v3, s[72:73]
    v_cmp_le_i32 s[66:67], 24, v2
    v_cmp_le_i32 s[68:69], 25, v2
    v_cmp_le_i32 s[70:71], 26, v2
    v_cmp_le_i32 s[72:73], 27, v2
    v_cndmask_b32 v172, v3, 0, s[66:67]
    v_cndmask_b32 v188, 0, v3, s[66:67]
    v_cndmask_b32 v173, v3, 0, s[68:69]
    v_cndmask_b32 v189, 0, v3, s[68:69]
    v_cndmask_b32 v174, v3, 0, s[70:71]
    v_cndmask_b32 v190, 0, v3, s[70:71]
    v_cndmask_b32 v175, v3, 0, s[72:73]
    v_cndmask_b32 v191, 0, v3, s[72:73]
    v_and_b32 v2, 31, v1
    v_lshrrev_b32 v3, 5, v1
    v_lshlrev_b32 v4, 3, v2
    v_lshl_add_u32 v5, v3, 9, v4
    v_mov_b32 v6, 0x7fff0000
    v_cmp_eq_u32 vcc, 0, v3
    s_nop 1
    v_cndmask_b32 v6, v6, v4, vcc
    s_add_u32 s52, s50, s44
    s_mul_i32 s53, s52, 40960
    s_mul_i32 s54, s48, 1280
    s_add_u32 s53, s53, s54
    s_add_u32 s62, s53, 6193152
    s_add_u32 s63, s62, 163840
    s_lshl_b32 s56, s52, 15
    s_lshl_b32 s53, s48, 10
    s_add_u32 s56, s56, s53
    s_add_u32 s56, s56, 14061568
    s_lshl_b32 s61, s52, 13
    s_lshl_b32 s53, s48, 8
    s_add_u32 s61, s61, s53
    s_add_u32 s61, s61, 16158720
    s_add_u32 s64, s54, s51
    s_add_u32 s64, s64, 8814592
    s_mov_b32 s55, 39680
    v_add_u32 v16, 0, v1
    v_mul_u32_u24 v16, 205, v16
    v_lshrrev_b32 v16, 14, v16
    v_mul_u32_u24 v16, s55, v16
    v_lshl_add_u32 v16, v1, 4, v16
    v_add_u32 v17, 64, v1
    v_mul_u32_u24 v17, 205, v17
    v_lshrrev_b32 v17, 14, v17
    v_mul_u32_u24 v17, s55, v17
    v_lshl_add_u32 v17, v1, 4, v17
    v_add_u32 v18, 128, v1
    v_mul_u32_u24 v18, 205, v18
    v_lshrrev_b32 v18, 14, v18
    v_mul_u32_u24 v18, s55, v18
    v_lshl_add_u32 v18, v1, 4, v18
    v_add_u32 v19, 192, v1
    v_mul_u32_u24 v19, 205, v19
    v_lshrrev_b32 v19, 14, v19
    v_mul_u32_u24 v19, s55, v19
    v_lshl_add_u32 v19, v1, 4, v19
    v_add_u32 v20, 256, v1
    v_mul_u32_u24 v20, 205, v20
    v_lshrrev_b32 v20, 14, v20
    v_mul_u32_u24 v20, s55, v20
    v_lshl_add_u32 v20, v1, 4, v20
    v_add_u32 v20, 4096, v20
    v_mul_u32_u24 v7, 49, v1
    v_lshrrev_b32 v7, 10, v7
    v_mul_u32_u24 v7, 9904, v7
    v_lshl_add_u32 v7, v1, 4, v7
    s_mul_i32 s65, s48, 320
    s_add_u32 s65, s65, s51
    s_add_u32 s65, s65, 11436032
    s_mul_i32 s54, s44, 5376
    s_add_u32 s54, s54, 20480
    s_mul_i32 s66, s44, 5120
    s_mul_i32 s53, s44, 1280
    s_add_u32 s53, s53, 0
    v_add_u32 v8, s53, v5
    v_add_u32 v9, s53, v4
    v_min_u32 v10, 20, v2
    v_cmp_lt_u32 vcc, 27, v2
    v_mul_u32_u24 v13, 336, v3
    s_nop 0
    v_cndmask_b32_e64 v10, v10, 4, vcc
    s_mul_i32 s53, s44, 1344
    s_add_u32 s53, s53, 20480
    v_lshl_add_u32 v10, v10, 4, v13
    v_add_u32 v10, s53, v10
    v_lshlrev_b32 v11, 4, v2
    v_lshl_add_u32 v11, v3, 9, v11
    v_mov_b32 v12, v6
    v_and_b32 v13, 15, v1
    v_mul_u32_u24 v13, 336, v13
    v_add_u32 v13, s54, v13
    v_mov_b32 v24, 0x3f803f80
    v_mov_b32 v25, v24
    v_mov_b32 v26, v24
    v_mov_b32 v27, v24
    s_sub_u32 s57, 8, s44
    s_cmp_eq_u32 s49, 0
    s_cselect_b32 s57, s57, 0
    s_cselect_b32 s58, 4, 0
    s_cmp_lg_u32 s44, 0
    s_cbranch_scc1 aw_59
    v_mov_b32 v2, 163776
    s_mov_b32 s47, 0x80000
lw_61:
    ds_read_b32 v3, v2
    s_sub_u32 s47, s47, 1
    s_cbranch_scc1 lw_61x
    s_waitcnt lgkmcnt(0)
    v_readfirstlane_b32 s60, v3
    s_cmp_ge_u32 s60, 4
    s_cbranch_scc1 lw_61x
    s_sleep 3
    s_branch lw_61
lw_61x:
    s_cmp_eq_u32 s81, 0
    s_cbranch_scc1 al_62
    v_mov_b32 v2, 163720
    s_mov_b32 s47, 0x80000
lw_63:
    ds_read_b32 v3, v2
    s_sub_u32 s47, s47, 1
    s_cbranch_scc1 lw_63x
    s_waitcnt lgkmcnt(0)
    v_readfirstlane_b32 s60, v3
    s_cmp_ge_u32 s60, 4
    s_cbranch_scc1 lw_63x
    s_sleep 3
    s_branch lw_63
lw_63x:
al_62:
    s_sub_u32 s53, s49, 1
    v_add_u32 v2, s53, v1
    v_max_i32 v2, 0, v2
    v_lshlrev_b32 v2, 8, v2
    s_mov_b32 s53, 32896
    s_mov_b64 exec, 3
    s_mov_b32 s47, 0x8000
gp_64:
    buffer_load_dword v3, v2, s[24:27], s53 offen sc1
    s_sub_u32 s47, s47, 1
    s_cbranch_scc1 gp_64x
    s_waitcnt vmcnt(0)
    v_cmp_ne_u32 vcc, 1, v3
    s_cbranch_vccz gp_64x
    s_sleep 2
    s_branch gp_64
gp_64x:
    s_mov_b64 exec, -1
    v_mov_b32 v2, 163780
    v_mov_b32 v3, 1
    ds_write_b32 v2, v3
    s_branch ag_60
aw_59:
    v_mov_b32 v2, 163780
    s_mov_b32 s47, 0x80000
lw_65:
    ds_read_b32 v3, v2
    s_sub_u32 s47, s47, 1
    s_cbranch_scc1 lw_65x
    s_waitcnt lgkmcnt(0)
    v_readfirstlane_b32 s60, v3
    s_cmp_ge_u32 s60, 1
    s_cbranch_scc1 lw_65x
    s_sleep 1
    s_branch lw_65
lw_65x:
ag_60:
    s_mov_b32 m0, s66
    buffer_load_dwordx2 v[242:243], v5, s[24:27], s62 offen sc1
    buffer_load_dwordx2 v[244:245], v5, s[24:27], s62 offen offset:256 sc1
    buffer_load_dwordx2 v[246:247], v6, s[24:27], s62 offen offset:1024 sc1
    buffer_load_dwordx4 v16, s[24:27], s64 offen offset:0 sc1 lds
    buffer_load_dwordx4 v17, s[24:27], s64 offen offset:1024 sc1 lds
    buffer_load_dwordx4 v18, s[24:27], s64 offen offset:2048 sc1 lds
    buffer_load_dwordx4 v19, s[24:27], s64 offen offset:3072 sc1 lds
    s_add_u32 m0, s66, 4096
    s_nop 0
    buffer_load_dwordx4 v20, s[24:27], s64 offen offset:0 sc1 lds
    s_add_u32 m0, s54, 0
    s_nop 0
    buffer_load_dwordx4 v7, s[24:27], s65 offen sc1 lds
    s_add_u32 s65, s65, 30720
    s_add_u32 m0, s54, 1008
    s_nop 0
    buffer_load_dwordx4 v7, s[24:27], s65 offen sc1 lds
    s_add_u32 s65, s65, 30720
    s_add_u32 m0, s54, 2016
    s_nop 0
    buffer_load_dwordx4 v7, s[24:27], s65 offen sc1 lds
    s_add_u32 s65, s65, 30720
    s_add_u32 m0, s54, 3024
    s_nop 0
    buffer_load_dwordx4 v7, s[24:27], s65 offen sc1 lds
    s_add_u32 s65, s65, 30720
    s_add_u32 m0, s54, 4032
    s_nop 0
    buffer_load_dwordx4 v7, s[24:27], s65 offen sc1 lds
    s_add_u32 s65, s65, 30720
    s_add_u32 m0, s54, 5040
    s_mov_b64 exec, 0x1fffff
    buffer_load_dwordx4 v7, s[24:27], s65 offen sc1 lds
    s_add_u32 s65, s65, 30720
    s_mov_b64 exec, -1
    buffer_load_dwordx2 v[248:249], v5, s[24:27], s63 offen sc1
    buffer_load_dwordx2 v[250:251], v5, s[24:27], s63 offen offset:256 sc1
    buffer_load_dwordx2 v[252:253], v6, s[24:27], s63 offen offset:1024 sc1
    s_setprio 0
    v_and_b32 v2, 31, v1
    v_lshrrev_b32 v3, 5, v1
    v_mul_u32_u24 v3, 1280, v3
    v_lshl_add_u32 v2, v2, 3, v3
    v_add_u32 v2, s66, v2
    s_waitcnt vmcnt(9)
    ds_read_b64 v[28:29], v2 offset:0
    ds_read_b64 v[30:31], v2 offset:256
    ds_read_b64 v[32:33], v2 offset:512
    ds_read_b64 v[34:35], v2 offset:768
    ds_read_b64 v[36:37], v2 offset:1024
    ds_read_b64 v[38:39], v2 offset:2560
    ds_read_b64 v[40:41], v2 offset:2816
    ds_read_b64 v[42:43], v2 offset:3072
    ds_read_b64 v[44:45], v2 offset:3328
    ds_read_b64 v[46:47], v2 offset:3584
    s_waitcnt lgkmcnt(5)
    v_mov_b32 v14, 0
    v_dot2_f32_bf16 v14, v28, v28, v14
    v_dot2_f32_bf16 v14, v29, v29, v14
    v_dot2_f32_bf16 v14, v30, v30, v14
    v_dot2_f32_bf16 v14, v31, v31, v14
    v_dot2_f32_bf16 v14, v32, v32, v14
    v_dot2_f32_bf16 v14, v33, v33, v14
    v_dot2_f32_bf16 v14, v34, v34, v14
    v_dot2_f32_bf16 v14, v35, v35, v14
    v_dot2_f32_bf16 v14, v36, v36, v14
    v_dot2_f32_bf16 v14, v37, v37, v14
    s_waitcnt lgkmcnt(0)
    v_mov_b32 v15, 0
    v_dot2_f32_bf16 v15, v38, v38, v15
    v_dot2_f32_bf16 v15, v39, v39, v15
    v_dot2_f32_bf16 v15, v40, v40, v15
    v_dot2_f32_bf16 v15, v41, v41, v15
    v_dot2_f32_bf16 v15, v42, v42, v15
    v_dot2_f32_bf16 v15, v43, v43, v15
    v_dot2_f32_bf16 v15, v44, v44, v15
    v_dot2_f32_bf16 v15, v45, v45, v15
    v_dot2_f32_bf16 v15, v46, v46, v15
    v_dot2_f32_bf16 v15, v47, v47, v15
    s_nop 2
    v_max_f32 v14, v14, v15
    s_nop 1
    v_max_f32_dpp v14, v14, v14 row_ror:8 row_mask:0xf bank_mask:0xf
    s_nop 1
    v_max_f32_dpp v14, v14, v14 row_ror:4 row_mask:0xf bank_mask:0xf
    s_nop 1
    v_max_f32_dpp v14, v14, v14 row_ror:2 row_mask:0xf bank_mask:0xf
    s_nop 1
    v_max_f32_dpp v14, v14, v14 row_ror:1 row_mask:0xf bank_mask:0xf
    v_mov_b32 v15, v14
    s_nop 1
    v_permlane16_swap_b32 v14, v15
    v_max_f32 v14, v14, v15
    v_mov_b32 v15, v14
    s_nop 1
    v_permlane32_swap_b32 v14, v15
    v_max_f32 v14, v14, v15
    s_lshl_b32 s53, s44, 2
    s_add_u32 s53, s53, 163568
    v_mov_b32 v15, s53
    ds_write_b32 v15, v14
    s_waitcnt lgkmcnt(0)
    v_mov_b32 v2, 163784
    v_mov_b32 v3, 1
    s_mov_b64 exec, 1
    ds_add_u32 v2, v3
    s_mov_b64 exec, -1
    s_mov_b32 s47, 0x80000
sync_66:
    ds_read_b32 v3, v2
    s_sub_u32 s47, s47, 1
    s_cbranch_scc1 sync_66x
    s_waitcnt lgkmcnt(0)
    v_readfirstlane_b32 s60, v3
    s_cmp_ge_u32 s60, 4
    s_cbranch_scc1 sync_66x
    s_sleep 0
    s_branch sync_66
sync_66x:
    v_mov_b32 v2, 163568
    ds_read_b128 v[28:31], v2
    s_waitcnt lgkmcnt(0)
    v_max3_f32 v28, v28, v29, v30
    v_max_f32 v254, v28, v31
    s_mov_b32 s59, 0
.p2align 3
atask_68:
    ds_read_b64 v[208:209], v8 offset:0
    ds_read_b64 v[210:211], v8 offset:256
    ds_read_b64 v[212:213], v9 offset:1024
    ds_read_b64 v[214:215], v8 offset:1280
    ds_read_b64 v[216:217], v8 offset:1536
    ds_read_b64 v[218:219], v9 offset:2304
    ds_read_b64 v[220:221], v8 offset:2560
    ds_read_b64 v[222:223], v8 offset:2816
    ds_read_b64 v[224:225], v9 offset:3584
    v_mov_b32 v2, 0
    v_dot2_f32_bf16 v2, v242, v242, v2
    v_dot2_f32_bf16 v2, v243, v243, v2
    v_dot2_f32_bf16 v2, v244, v244, v2
    v_dot2_f32_bf16 v2, v245, v245, v2
    v_dot2_f32_bf16 v2, v246, v246, v2
    v_dot2_f32_bf16 v2, v247, v247, v2
    s_nop 2
    v_mov_b32 v3, v2
    s_nop 1
    v_permlane32_swap_b32 v2, v3
    v_add_f32 v2, v2, v3
    v_mul_f32 v2, v2, v254
    v_cmp_nge_f32 vcc, 0x45610000, v2
    s_cbranch_vccnz aslow_88
    s_waitcnt lgkmcnt(6)
    v_mfma_f32_32x32x16_bf16 v[16:31], v[208:211], v[242:245], v[176:191]
    v_mfma_f32_32x32x8bf16_1k v[16:31], v[212:213], v[246:247], v[16:31]
    s_cmp_eq_u32 s59, 0
    s_cbranch_scc1 afv_89
afb_90:
    ds_read_b128 v[226:229], v10 offset:0
    ds_read_b128 v[230:233], v10 offset:672
    ds_read_b64 v[208:209], v8 offset:3840
    ds_read_b64 v[210:211], v8 offset:4096
    ds_read_b64 v[212:213], v9 offset:4864
    s_waitcnt lgkmcnt(8)
    v_mfma_f32_32x32x16_bf16 v[32:47], v[214:217], v[242:245], 0
    v_mfma_f32_32x32x8bf16_1k v[32:47], v[218:219], v[246:247], v[32:47]
    s_nop 7
    s_cmp_gt_u32 s57, 0
    s_cbranch_scc1 finv_91
finvb_99:
    v_exp_f32 v16, v16
    v_exp_f32 v17, v17
    v_exp_f32 v18, v18
    v_exp_f32 v19, v19
    v_exp_f32 v20, v20
    v_exp_f32 v21, v21
    v_exp_f32 v22, v22
    v_exp_f32 v23, v23
    ds_read_b128 v[234:237], v10 offset:1344
    ds_read_b128 v[238:241], v10 offset:2016
    v_exp_f32 v24, v24
    v_exp_f32 v25, v25
    v_exp_f32 v26, v26
    v_exp_f32 v27, v27
    s_waitcnt lgkmcnt(7)
    v_mfma_f32_32x32x16_bf16 v[48:63], v[220:223], v[242:245], 0
    v_exp_f32 v28, v28
    v_exp_f32 v29, v29
    v_exp_f32 v30, v30
    v_exp_f32 v31, v31
    v_mfma_f32_32x32x8bf16_1k v[48:63], v[224:225], v[246:247], v[48:63]
    ds_read_b64 v[214:215], v8 offset:5120
    ds_read_b64 v[216:217], v8 offset:5376
    ds_read_b64 v[218:219], v9 offset:6144
    v_cvt_pk_bf16_f32 v16, v16, v17
    v_cvt_pk_bf16_f32 v17, v18, v19
    v_cvt_pk_bf16_f32 v18, v20, v21
    v_cvt_pk_bf16_f32 v19, v22, v23
    v_cvt_pk_bf16_f32 v20, v24, v25
    v_cvt_pk_bf16_f32 v21, v26, v27
    v_cvt_pk_bf16_f32 v22, v28, v29
    v_cvt_pk_bf16_f32 v23, v30, v31
    s_waitcnt lgkmcnt(8)
    s_cmp_gt_u32 s57, 1
    s_cbranch_scc1 finv_92
finvb_100:
    v_exp_f32 v32, v32
    v_exp_f32 v33, v33
    v_exp_f32 v34, v34
    v_exp_f32 v35, v35
    v_mfma_f32_32x32x16_bf16 v[192:207], v[226:229], v[16:19], 0
    v_exp_f32 v36, v36
    v_exp_f32 v37, v37
    v_exp_f32 v38, v38
    v_exp_f32 v39, v39
    v_mfma_f32_32x32x16_bf16 v[192:207], v[230:233], v[20:23], v[192:207]
    ds_read_b128 v[226:229], v10 offset:2688
    ds_read_b128 v[230:233], v10 offset:3360
    v_exp_f32 v40, v40
    v_exp_f32 v41, v41
    v_exp_f32 v42, v42
    v_exp_f32 v43, v43
    s_waitcnt lgkmcnt(7)
    v_mfma_f32_32x32x16_bf16 v[16:31], v[208:211], v[242:245], 0
    v_exp_f32 v44, v44
    v_exp_f32 v45, v45
    v_exp_f32 v46, v46
    v_exp_f32 v47, v47
    v_mfma_f32_32x32x8bf16_1k v[16:31], v[212:213], v[246:247], v[16:31]
    ds_read_b64 v[220:221], v8 offset:6400
    ds_read_b64 v[222:223], v8 offset:6656
    ds_read_b64 v[224:225], v9 offset:7424
    v_cvt_pk_bf16_f32 v32, v32, v33
    v_cvt_pk_bf16_f32 v33, v34, v35
    v_cvt_pk_bf16_f32 v34, v36, v37
    v_cvt_pk_bf16_f32 v35, v38, v39
    v_cvt_pk_bf16_f32 v36, v40, v41
    v_cvt_pk_bf16_f32 v37, v42, v43
    v_cvt_pk_bf16_f32 v38, v44, v45
    v_cvt_pk_bf16_f32 v39, v46, v47
    s_waitcnt lgkmcnt(8)
    s_cmp_gt_u32 s57, 2
    s_cbranch_scc1 finv_93
finvb_101:
    v_exp_f32 v48, v48
    v_exp_f32 v49, v49
    v_exp_f32 v50, v50
    v_exp_f32 v51, v51
    v_mfma_f32_32x32x16_bf16 v[192:207], v[234:237], v[32:35], v[192:207]
    v_exp_f32 v52, v52
    v_exp_f32 v53, v53
    v_exp_f32 v54, v54
    v_exp_f32 v55, v55
    v_mfma_f32_32x32x16_bf16 v[192:207], v[238:241], v[36:39], v[192:207]
    ds_read_b128 v[234:237], v10 offset:4032
    ds_read_b128 v[238:241], v10 offset:4704
    v_exp_f32 v56, v56
    v_exp_f32 v57, v57
    v_exp_f32 v58, v58
    v_exp_f32 v59, v59
    s_waitcnt lgkmcnt(7)
    v_mfma_f32_32x32x16_bf16 v[32:47], v[214:217], v[242:245], 0
    v_exp_f32 v60, v60
    v_exp_f32 v61, v61
    v_exp_f32 v62, v62
    v_exp_f32 v63, v63
    v_mfma_f32_32x32x8bf16_1k v[32:47], v[218:219], v[246:247], v[32:47]
    ds_read_b64 v[208:209], v8 offset:7680
    ds_read_b64 v[210:211], v8 offset:7936
    ds_read_b64 v[212:213], v9 offset:8704
    v_cvt_pk_bf16_f32 v48, v48, v49
    v_cvt_pk_bf16_f32 v49, v50, v51
    v_cvt_pk_bf16_f32 v50, v52, v53
    v_cvt_pk_bf16_f32 v51, v54, v55
    v_cvt_pk_bf16_f32 v52, v56, v57
    v_cvt_pk_bf16_f32 v53, v58, v59
    v_cvt_pk_bf16_f32 v54, v60, v61
    v_cvt_pk_bf16_f32 v55, v62, v63
    s_waitcnt lgkmcnt(8)
    s_cmp_gt_u32 s57, 3
    s_cbranch_scc1 finv_94
finvb_102:
    v_exp_f32 v16, v16
    v_exp_f32 v17, v17
    v_exp_f32 v18, v18
    v_exp_f32 v19, v19
    v_mfma_f32_32x32x16_bf16 v[192:207], v[226:229], v[48:51], v[192:207]
    v_exp_f32 v20, v20
    v_exp_f32 v21, v21
    v_exp_f32 v22, v22
    v_exp_f32 v23, v23
    v_mfma_f32_32x32x16_bf16 v[192:207], v[230:233], v[52:55], v[192:207]
    ds_read_b128 v[226:229], v10 offset:5376
    ds_read_b128 v[230:233], v10 offset:6048
    v_exp_f32 v24, v24
    v_exp_f32 v25, v25
    v_exp_f32 v26, v26
    v_exp_f32 v27, v27
    s_waitcnt lgkmcnt(7)
    v_mfma_f32_32x32x16_bf16 v[48:63], v[220:223], v[242:245], 0
    v_exp_f32 v28, v28
    v_exp_f32 v29, v29
    v_exp_f32 v30, v30
    v_exp_f32 v31, v31
    v_mfma_f32_32x32x8bf16_1k v[48:63], v[224:225], v[246:247], v[48:63]
    ds_read_b64 v[214:215], v8 offset:8960
    ds_read_b64 v[216:217], v8 offset:9216
    ds_read_b64 v[218:219], v9 offset:9984
    v_cvt_pk_bf16_f32 v16, v16, v17
    v_cvt_pk_bf16_f32 v17, v18, v19
    v_cvt_pk_bf16_f32 v18, v20, v21
    v_cvt_pk_bf16_f32 v19, v22, v23
    v_cvt_pk_bf16_f32 v20, v24, v25
    v_cvt_pk_bf16_f32 v21, v26, v27
    v_cvt_pk_bf16_f32 v22, v28, v29
    v_cvt_pk_bf16_f32 v23, v30, v31
    s_waitcnt lgkmcnt(8)
    s_cmp_gt_u32 s57, 4
    s_cbranch_scc1 finv_95
finvb_103:
    v_exp_f32 v32, v32
    v_exp_f32 v33, v33
    v_exp_f32 v34, v34
    v_exp_f32 v35, v35
    v_mfma_f32_32x32x16_bf16 v[192:207], v[234:237], v[16:19], v[192:207]
    v_exp_f32 v36, v36
    v_exp_f32 v37, v37
    v_exp_f32 v38, v38
    v_exp_f32 v39, v39
    v_mfma_f32_32x32x16_bf16 v[192:207], v[238:241], v[20:23], v[192:207]
    ds_read_b128 v[234:237], v10 offset:6720
    ds_read_b128 v[238:241], v10 offset:7392
    v_exp_f32 v40, v40
    v_exp_f32 v41, v41
    v_exp_f32 v42, v42
    v_exp_f32 v43, v43
    s_waitcnt lgkmcnt(7)
    v_mfma_f32_32x32x16_bf16 v[16:31], v[208:211], v[242:245], 0
    v_exp_f32 v44, v44
    v_exp_f32 v45, v45
    v_exp_f32 v46, v46
    v_exp_f32 v47, v47
    v_mfma_f32_32x32x8bf16_1k v[16:31], v[212:213], v[246:247], v[16:31]
    ds_read_b64 v[220:221], v8 offset:10240
    ds_read_b64 v[222:223], v8 offset:10496
    ds_read_b64 v[224:225], v9 offset:11264
    v_cvt_pk_bf16_f32 v32, v32, v33
    v_cvt_pk_bf16_f32 v33, v34, v35
    v_cvt_pk_bf16_f32 v34, v36, v37
    v_cvt_pk_bf16_f32 v35, v38, v39
    v_cvt_pk_bf16_f32 v36, v40, v41
    v_cvt_pk_bf16_f32 v37, v42, v43
    v_cvt_pk_bf16_f32 v38, v44, v45
    v_cvt_pk_bf16_f32 v39, v46, v47
    s_waitcnt lgkmcnt(8)
    s_cmp_gt_u32 s57, 5
    s_cbranch_scc1 finv_96
finvb_104:
    v_exp_f32 v48, v48
    v_exp_f32 v49, v49
    v_exp_f32 v50, v50
    v_exp_f32 v51, v51
    v_mfma_f32_32x32x16_bf16 v[192:207], v[226:229], v[32:35], v[192:207]
    v_exp_f32 v52, v52
    v_exp_f32 v53, v53
    v_exp_f32 v54, v54
    v_exp_f32 v55, v55
    v_mfma_f32_32x32x16_bf16 v[192:207], v[230:233], v[36:39], v[192:207]
    ds_read_b128 v[226:229], v10 offset:8064
    ds_read_b128 v[230:233], v10 offset:8736
    v_exp_f32 v56, v56
    v_exp_f32 v57, v57
    v_exp_f32 v58, v58
    v_exp_f32 v59, v59
    s_waitcnt lgkmcnt(7)
    v_mfma_f32_32x32x16_bf16 v[32:47], v[214:217], v[242:245], 0
    v_exp_f32 v60, v60
    v_exp_f32 v61, v61
    v_exp_f32 v62, v62
    v_exp_f32 v63, v63
    v_mfma_f32_32x32x8bf16_1k v[32:47], v[218:219], v[246:247], v[32:47]
    v_cvt_pk_bf16_f32 v48, v48, v49
    v_cvt_pk_bf16_f32 v49, v50, v51
    v_cvt_pk_bf16_f32 v50, v52, v53
    v_cvt_pk_bf16_f32 v51, v54, v55
    v_cvt_pk_bf16_f32 v52, v56, v57
    v_cvt_pk_bf16_f32 v53, v58, v59
    v_cvt_pk_bf16_f32 v54, v60, v61
    v_cvt_pk_bf16_f32 v55, v62, v63
    s_waitcnt lgkmcnt(5)
    s_cmp_gt_u32 s57, 6
    s_cbranch_scc1 finv_97
finvb_105:
    v_exp_f32 v16, v16
    v_exp_f32 v17, v17
    v_exp_f32 v18, v18
    v_exp_f32 v19, v19
    v_mfma_f32_32x32x16_bf16 v[192:207], v[234:237], v[48:51], v[192:207]
    v_exp_f32 v20, v20
    v_exp_f32 v21, v21
    v_exp_f32 v22, v22
    v_exp_f32 v23, v23
    v_mfma_f32_32x32x16_bf16 v[192:207], v[238:241], v[52:55], v[192:207]
    ds_read_b128 v[234:237], v10 offset:9408
    ds_read_b128 v[238:241], v10 offset:10080
    v_exp_f32 v24, v24
    v_exp_f32 v25, v25
    v_exp_f32 v26, v26
    v_exp_f32 v27, v27
    s_waitcnt lgkmcnt(4)
    v_mfma_f32_32x32x16_bf16 v[48:63], v[220:223], v[242:245], v[160:175]
    v_exp_f32 v28, v28
    v_exp_f32 v29, v29
    v_exp_f32 v30, v30
    v_exp_f32 v31, v31
    v_mfma_f32_32x32x8bf16_1k v[48:63], v[224:225], v[246:247], v[48:63]
    v_cvt_pk_bf16_f32 v16, v16, v17
    v_cvt_pk_bf16_f32 v17, v18, v19
    v_cvt_pk_bf16_f32 v18, v20, v21
    v_cvt_pk_bf16_f32 v19, v22, v23
    v_cvt_pk_bf16_f32 v20, v24, v25
    v_cvt_pk_bf16_f32 v21, v26, v27
    v_cvt_pk_bf16_f32 v22, v28, v29
    v_cvt_pk_bf16_f32 v23, v30, v31
    s_waitcnt lgkmcnt(2)
    s_cmp_gt_u32 s57, 7
    s_cbranch_scc1 finv_98
finvb_106:
    v_exp_f32 v32, v32
    v_exp_f32 v33, v33
    v_exp_f32 v34, v34
    v_exp_f32 v35, v35
    v_mfma_f32_32x32x16_bf16 v[192:207], v[226:229], v[16:19], v[192:207]
    v_exp_f32 v36, v36
    v_exp_f32 v37, v37
    v_exp_f32 v38, v38
    v_exp_f32 v39, v39
    v_mfma_f32_32x32x16_bf16 v[192:207], v[230:233], v[20:23], v[192:207]
    ds_read_b128 v[226:229], v10 offset:10752
    ds_read_b128 v[230:233], v10 offset:11424
    v_exp_f32 v40, v40
    v_exp_f32 v41, v41
    v_exp_f32 v42, v42
    v_exp_f32 v43, v43
    v_exp_f32 v44, v44
    v_exp_f32 v45, v45
    v_exp_f32 v46, v46
    v_exp_f32 v47, v47
    s_nop 0
    v_cvt_pk_bf16_f32 v32, v32, v33
    v_cvt_pk_bf16_f32 v33, v34, v35
    v_cvt_pk_bf16_f32 v34, v36, v37
    v_cvt_pk_bf16_f32 v35, v38, v39
    v_cvt_pk_bf16_f32 v36, v40, v41
    v_cvt_pk_bf16_f32 v37, v42, v43
    v_cvt_pk_bf16_f32 v38, v44, v45
    v_cvt_pk_bf16_f32 v39, v46, v47
    s_waitcnt lgkmcnt(2)
    v_exp_f32 v48, v48
    v_exp_f32 v49, v49
    v_exp_f32 v50, v50
    v_exp_f32 v51, v51
    v_mfma_f32_32x32x16_bf16 v[192:207], v[234:237], v[32:35], v[192:207]
    v_exp_f32 v52, v52
    v_exp_f32 v53, v53
    v_exp_f32 v54, v54
    v_exp_f32 v55, v55
    v_mfma_f32_32x32x16_bf16 v[192:207], v[238:241], v[36:39], v[192:207]
    v_exp_f32 v56, v56
    v_exp_f32 v57, v57
    v_exp_f32 v58, v58
    v_exp_f32 v59, v59
    v_exp_f32 v60, v60
    v_exp_f32 v61, v61
    v_exp_f32 v62, v62
    v_exp_f32 v63, v63
    s_nop 0
    v_cvt_pk_bf16_f32 v48, v48, v49
    v_cvt_pk_bf16_f32 v49, v50, v51
    v_cvt_pk_bf16_f32 v50, v52, v53
    v_cvt_pk_bf16_f32 v51, v54, v55
    v_cvt_pk_bf16_f32 v52, v56, v57
    v_cvt_pk_bf16_f32 v53, v58, v59
    v_cvt_pk_bf16_f32 v54, v60, v61
    v_cvt_pk_bf16_f32 v55, v62, v63
    s_waitcnt lgkmcnt(0)
    s_nop 0
    v_mfma_f32_32x32x16_bf16 v[192:207], v[226:229], v[48:51], v[192:207]
    v_mfma_f32_32x32x16_bf16 v[192:207], v[230:233], v[52:55], v[192:207]
    s_branch ajoin_87
finv_91:
    v_mov_b32 v16, 0xff800000
    v_mov_b32 v17, 0xff800000
    v_mov_b32 v18, 0xff800000
    v_mov_b32 v19, 0xff800000
    v_mov_b32 v20, 0xff800000
    v_mov_b32 v21, 0xff800000
    v_mov_b32 v22, 0xff800000
    v_mov_b32 v23, 0xff800000
    v_mov_b32 v24, 0xff800000
    v_mov_b32 v25, 0xff800000
    v_mov_b32 v26, 0xff800000
    v_mov_b32 v27, 0xff800000
    v_mov_b32 v28, 0xff800000
    v_mov_b32 v29, 0xff800000
    v_mov_b32 v30, 0xff800000
    v_mov_b32 v31, 0xff800000
    s_branch finvb_99
finv_92:
    v_mov_b32 v32, 0xff800000
    v_mov_b32 v33, 0xff800000
    v_mov_b32 v34, 0xff800000
    v_mov_b32 v35, 0xff800000
    v_mov_b32 v36, 0xff800000
    v_mov_b32 v37, 0xff800000
    v_mov_b32 v38, 0xff800000
    v_mov_b32 v39, 0xff800000
    v_mov_b32 v40, 0xff800000
    v_mov_b32 v41, 0xff800000
    v_mov_b32 v42, 0xff800000
    v_mov_b32 v43, 0xff800000
    v_mov_b32 v44, 0xff800000
    v_mov_b32 v45, 0xff800000
    v_mov_b32 v46, 0xff800000
    v_mov_b32 v47, 0xff800000
    s_branch finvb_100
finv_93:
    v_mov_b32 v48, 0xff800000
    v_mov_b32 v49, 0xff800000
    v_mov_b32 v50, 0xff800000
    v_mov_b32 v51, 0xff800000
    v_mov_b32 v52, 0xff800000
    v_mov_b32 v53, 0xff800000
    v_mov_b32 v54, 0xff800000
    v_mov_b32 v55, 0xff800000
    v_mov_b32 v56, 0xff800000
    v_mov_b32 v57, 0xff800000
    v_mov_b32 v58, 0xff800000
    v_mov_b32 v59, 0xff800000
    v_mov_b32 v60, 0xff800000
    v_mov_b32 v61, 0xff800000
    v_mov_b32 v62, 0xff800000
    v_mov_b32 v63, 0xff800000
    s_branch finvb_101
finv_94:
    v_mov_b32 v16, 0xff800000
    v_mov_b32 v17, 0xff800000
    v_mov_b32 v18, 0xff800000
    v_mov_b32 v19, 0xff800000
    v_mov_b32 v20, 0xff800000
    v_mov_b32 v21, 0xff800000
    v_mov_b32 v22, 0xff800000
    v_mov_b32 v23, 0xff800000
    v_mov_b32 v24, 0xff800000
    v_mov_b32 v25, 0xff800000
    v_mov_b32 v26, 0xff800000
    v_mov_b32 v27, 0xff800000
    v_mov_b32 v28, 0xff800000
    v_mov_b32 v29, 0xff800000
    v_mov_b32 v30, 0xff800000
    v_mov_b32 v31, 0xff800000
    s_branch finvb_102
finv_95:
    v_mov_b32 v32, 0xff800000
    v_mov_b32 v33, 0xff800000
    v_mov_b32 v34, 0xff800000
    v_mov_b32 v35, 0xff800000
    v_mov_b32 v36, 0xff800000
    v_mov_b32 v37, 0xff800000
    v_mov_b32 v38, 0xff800000
    v_mov_b32 v39, 0xff800000
    v_mov_b32 v40, 0xff800000
    v_mov_b32 v41, 0xff800000
    v_mov_b32 v42, 0xff800000
    v_mov_b32 v43, 0xff800000
    v_mov_b32 v44, 0xff800000
    v_mov_b32 v45, 0xff800000
    v_mov_b32 v46, 0xff800000
    v_mov_b32 v47, 0xff800000
    s_branch finvb_103
finv_96:
    v_mov_b32 v48, 0xff800000
    v_mov_b32 v49, 0xff800000
    v_mov_b32 v50, 0xff800000
    v_mov_b32 v51, 0xff800000
    v_mov_b32 v52, 0xff800000
    v_mov_b32 v53, 0xff800000
    v_mov_b32 v54, 0xff800000
    v_mov_b32 v55, 0xff800000
    v_mov_b32 v56, 0xff800000
    v_mov_b32 v57, 0xff800000
    v_mov_b32 v58, 0xff800000
    v_mov_b32 v59, 0xff800000
    v_mov_b32 v60, 0xff800000
    v_mov_b32 v61, 0xff800000
    v_mov_b32 v62, 0xff800000
    v_mov_b32 v63, 0xff800000
    s_branch finvb_104
finv_97:
    v_mov_b32 v16, 0xff800000
    v_mov_b32 v17, 0xff800000
    v_mov_b32 v18, 0xff800000
    v_mov_b32 v19, 0xff800000
    v_mov_b32 v20, 0xff800000
    v_mov_b32 v21, 0xff800000
    v_mov_b32 v22, 0xff800000
    v_mov_b32 v23, 0xff800000
    v_mov_b32 v24, 0xff800000
    v_mov_b32 v25, 0xff800000
    v_mov_b32 v26, 0xff800000
    v_mov_b32 v27, 0xff800000
    v_mov_b32 v28, 0xff800000
    v_mov_b32 v29, 0xff800000
    v_mov_b32 v30, 0xff800000
    v_mov_b32 v31, 0xff800000
    s_branch finvb_105
finv_98:
    v_mov_b32 v32, 0xff800000
    v_mov_b32 v33, 0xff800000
    v_mov_b32 v34, 0xff800000
    v_mov_b32 v35, 0xff800000
    v_mov_b32 v36, 0xff800000
    v_mov_b32 v37, 0xff800000
    v_mov_b32 v38, 0xff800000
    v_mov_b32 v39, 0xff800000
    v_mov_b32 v40, 0xff800000
    v_mov_b32 v41, 0xff800000
    v_mov_b32 v42, 0xff800000
    v_mov_b32 v43, 0xff800000
    v_mov_b32 v44, 0xff800000
    v_mov_b32 v45, 0xff800000
    v_mov_b32 v46, 0xff800000
    v_mov_b32 v47, 0xff800000
    s_branch finvb_106
afv_89:
    s_waitcnt vmcnt(0)
    v_mov_b32 v4, 0x3f803f80
    v_mov_b32 v5, v4
    v_mov_b32 v6, v4
    v_mov_b32 v7, v4
    ds_write_b128 v13, v[4:7] offset:320
    s_waitcnt lgkmcnt(0)
    v_mov_b32 v14, 163816
    v_mov_b32 v15, 1
    s_mov_b64 exec, 1
    ds_add_u32 v14, v15
    s_mov_b64 exec, -1
    s_mov_b32 s47, 0x80000
sync_107:
    ds_read_b32 v15, v14
    s_sub_u32 s47, s47, 1
    s_cbranch_scc1 sync_107x
    s_waitcnt lgkmcnt(0)
    v_readfirstlane_b32 s60, v15
    s_cmp_ge_u32 s60, 4
    s_cbranch_scc1 sync_107x
    s_sleep 0
    s_branch sync_107
sync_107x:
    s_branch afb_90
aslow_88:
    s_waitcnt lgkmcnt(6)
    v_mfma_f32_32x32x16_bf16 v[16:31], v[208:211], v[242:245], v[176:191]
    s_waitcnt lgkmcnt(3)
    v_mfma_f32_32x32x16_bf16 v[32:47], v[214:217], v[242:245], 0
    v_mfma_f32_32x32x8bf16_1k v[16:31], v[212:213], v[246:247], v[16:31]
    ds_read_b64 v[208:209], v8 offset:3840
    ds_read_b64 v[210:211], v8 offset:4096
    ds_read_b64 v[212:213], v9 offset:4864
    s_waitcnt lgkmcnt(3)
    v_mfma_f32_32x32x16_bf16 v[48:63], v[220:223], v[242:245], 0
    v_mfma_f32_32x32x8bf16_1k v[32:47], v[218:219], v[246:247], v[32:47]
    ds_read_b64 v[214:215], v8 offset:5120
    ds_read_b64 v[216:217], v8 offset:5376
    ds_read_b64 v[218:219], v9 offset:6144
    s_waitcnt lgkmcnt(3)
    v_mfma_f32_32x32x16_bf16 v[64:79], v[208:211], v[242:245], 0
    v_mfma_f32_32x32x8bf16_1k v[48:63], v[224:225], v[246:247], v[48:63]
    ds_read_b64 v[220:221], v8 offset:6400
    ds_read_b64 v[222:223], v8 offset:6656
    ds_read_b64 v[224:225], v9 offset:7424
    s_cmp_gt_u32 s57, 0
    s_cbranch_scc1 inv_71
invb_79:
    v_max_f32 v2, v16, v17
    v_max_f32 v3, v18, v19
    v_max3_f32 v2, v2, v20, v21
    v_max3_f32 v3, v3, v22, v23
    v_max3_f32 v2, v2, v24, v25
    v_max3_f32 v3, v3, v26, v27
    v_max3_f32 v2, v2, v28, v29
    v_max3_f32 v3, v3, v30, v31
    s_waitcnt lgkmcnt(3)
    v_mfma_f32_32x32x16_bf16 v[80:95], v[214:217], v[242:245], 0
    v_mfma_f32_32x32x8bf16_1k v[64:79], v[212:213], v[246:247], v[64:79]
    ds_read_b64 v[208:209], v8 offset:7680
    ds_read_b64 v[210:211], v8 offset:7936
    ds_read_b64 v[212:213], v9 offset:8704
    s_cmp_gt_u32 s57, 1
    s_cbranch_scc1 inv_72
invb_80:
    v_max3_f32 v2, v2, v32, v33
    v_max3_f32 v3, v3, v34, v35
    v_max3_f32 v2, v2, v36, v37
    v_max3_f32 v3, v3, v38, v39
    v_max3_f32 v2, v2, v40, v41
    v_max3_f32 v3, v3, v42, v43
    v_max3_f32 v2, v2, v44, v45
    v_max3_f32 v3, v3, v46, v47
    s_waitcnt lgkmcnt(3)
    v_mfma_f32_32x32x16_bf16 v[96:111], v[220:223], v[242:245], 0
    v_mfma_f32_32x32x8bf16_1k v[80:95], v[218:219], v[246:247], v[80:95]
    ds_read_b64 v[214:215], v8 offset:8960
    ds_read_b64 v[216:217], v8 offset:9216
    ds_read_b64 v[218:219], v9 offset:9984
    s_cmp_gt_u32 s57, 2
    s_cbranch_scc1 inv_73
invb_81:
    v_max3_f32 v2, v2, v48, v49
    v_max3_f32 v3, v3, v50, v51
    v_max3_f32 v2, v2, v52, v53
    v_max3_f32 v3, v3, v54, v55
    v_max3_f32 v2, v2, v56, v57
    v_max3_f32 v3, v3, v58, v59
    v_max3_f32 v2, v2, v60, v61
    v_max3_f32 v3, v3, v62, v63
    s_waitcnt lgkmcnt(3)
    v_mfma_f32_32x32x16_bf16 v[112:127], v[208:211], v[242:245], 0
    v_mfma_f32_32x32x8bf16_1k v[96:111], v[224:225], v[246:247], v[96:111]
    ds_read_b64 v[220:221], v8 offset:10240
    ds_read_b64 v[222:223], v8 offset:10496
    ds_read_b64 v[224:225], v9 offset:11264
    s_cmp_gt_u32 s57, 3
    s_cbranch_scc1 inv_74
invb_82:
    v_max3_f32 v2, v2, v64, v65
    v_max3_f32 v3, v3, v66, v67
    v_max3_f32 v2, v2, v68, v69
    v_max3_f32 v3, v3, v70, v71
    v_max3_f32 v2, v2, v72, v73
    v_max3_f32 v3, v3, v74, v75
    v_max3_f32 v2, v2, v76, v77
    v_max3_f32 v3, v3, v78, v79
    s_waitcnt lgkmcnt(3)
    v_mfma_f32_32x32x16_bf16 v[128:143], v[214:217], v[242:245], 0
    v_mfma_f32_32x32x8bf16_1k v[112:127], v[212:213], v[246:247], v[112:127]
    s_cmp_gt_u32 s57, 4
    s_cbranch_scc1 inv_75
invb_83:
    v_max3_f32 v2, v2, v80, v81
    v_max3_f32 v3, v3, v82, v83
    v_max3_f32 v2, v2, v84, v85
    v_max3_f32 v3, v3, v86, v87
    v_max3_f32 v2, v2, v88, v89
    v_max3_f32 v3, v3, v90, v91
    v_max3_f32 v2, v2, v92, v93
    v_max3_f32 v3, v3, v94, v95
    s_waitcnt lgkmcnt(0)
    v_mfma_f32_32x32x16_bf16 v[144:159], v[220:223], v[242:245], v[160:175]
    v_mfma_f32_32x32x8bf16_1k v[128:143], v[218:219], v[246:247], v[128:143]
    s_cmp_gt_u32 s57, 5
    s_cbranch_scc1 inv_76
invb_84:
    v_max3_f32 v2, v2, v96, v97
    v_max3_f32 v3, v3, v98, v99
    v_max3_f32 v2, v2, v100, v101
    v_max3_f32 v3, v3, v102, v103
    v_max3_f32 v2, v2, v104, v105
    v_max3_f32 v3, v3, v106, v107
    v_max3_f32 v2, v2, v108, v109
    v_max3_f32 v3, v3, v110, v111
    v_mfma_f32_32x32x8bf16_1k v[144:159], v[224:225], v[246:247], v[144:159]
    s_cmp_gt_u32 s57, 6
    s_cbranch_scc1 inv_77
invb_85:
    v_max3_f32 v2, v2, v112, v113
    v_max3_f32 v3, v3, v114, v115
    v_max3_f32 v2, v2, v116, v117
    v_max3_f32 v3, v3, v118, v119
    v_max3_f32 v2, v2, v120, v121
    v_max3_f32 v3, v3, v122, v123
    v_max3_f32 v2, v2, v124, v125
    v_max3_f32 v3, v3, v126, v127
    s_cmp_eq_u32 s59, 0
    s_cbranch_scc1 avw_69
avb_70:
    ds_read_b128 v[226:229], v10 offset:0
    ds_read_b128 v[230:233], v10 offset:672
    s_cmp_gt_u32 s57, 7
    s_cbranch_scc1 inv_78
invb_86:
    v_max3_f32 v2, v2, v128, v129
    v_max3_f32 v3, v3, v130, v131
    v_max3_f32 v2, v2, v132, v133
    v_max3_f32 v3, v3, v134, v135
    v_max3_f32 v2, v2, v136, v137
    v_max3_f32 v3, v3, v138, v139
    v_max3_f32 v2, v2, v140, v141
    v_max3_f32 v3, v3, v142, v143
    s_nop 0
    v_max3_f32 v2, v2, v144, v145
    v_max3_f32 v3, v3, v146, v147
    v_max3_f32 v2, v2, v148, v149
    v_max3_f32 v3, v3, v150, v151
    v_max3_f32 v2, v2, v152, v153
    v_max3_f32 v3, v3, v154, v155
    v_max3_f32 v2, v2, v156, v157
    v_max3_f32 v3, v3, v158, v159
    v_max_f32 v2, v2, v3
    v_mov_b32 v3, v2
    s_nop 1
    v_permlane32_swap_b32 v2, v3
    v_max_f32 v2, v2, v3
    v_pk_add_f32 v[16:17], v[16:17], v[2:3] op_sel_hi:[1,0] neg_lo:[0,1] neg_hi:[0,1]
    v_pk_add_f32 v[18:19], v[18:19], v[2:3] op_sel_hi:[1,0] neg_lo:[0,1] neg_hi:[0,1]
    v_pk_add_f32 v[20:21], v[20:21], v[2:3] op_sel_hi:[1,0] neg_lo:[0,1] neg_hi:[0,1]
    v_pk_add_f32 v[22:23], v[22:23], v[2:3] op_sel_hi:[1,0] neg_lo:[0,1] neg_hi:[0,1]
    v_pk_add_f32 v[24:25], v[24:25], v[2:3] op_sel_hi:[1,0] neg_lo:[0,1] neg_hi:[0,1]
    v_pk_add_f32 v[26:27], v[26:27], v[2:3] op_sel_hi:[1,0] neg_lo:[0,1] neg_hi:[0,1]
    v_pk_add_f32 v[28:29], v[28:29], v[2:3] op_sel_hi:[1,0] neg_lo:[0,1] neg_hi:[0,1]
    v_pk_add_f32 v[30:31], v[30:31], v[2:3] op_sel_hi:[1,0] neg_lo:[0,1] neg_hi:[0,1]
    ds_read_b128 v[234:237], v10 offset:1344
    ds_read_b128 v[238:241], v10 offset:2016
    v_exp_f32 v16, v16
    v_exp_f32 v17, v17
    v_exp_f32 v18, v18
    v_exp_f32 v19, v19
    v_exp_f32 v20, v20
    v_exp_f32 v21, v21
    v_exp_f32 v22, v22
    v_exp_f32 v23, v23
    v_exp_f32 v24, v24
    v_exp_f32 v25, v25
    v_exp_f32 v26, v26
    v_exp_f32 v27, v27
    v_exp_f32 v28, v28
    v_exp_f32 v29, v29
    v_exp_f32 v30, v30
    v_exp_f32 v31, v31
    s_nop 0
    v_cvt_pk_bf16_f32 v16, v16, v17
    v_cvt_pk_bf16_f32 v17, v18, v19
    v_cvt_pk_bf16_f32 v18, v20, v21
    v_cvt_pk_bf16_f32 v19, v22, v23
    v_cvt_pk_bf16_f32 v20, v24, v25
    v_cvt_pk_bf16_f32 v21, v26, v27
    v_cvt_pk_bf16_f32 v22, v28, v29
    v_cvt_pk_bf16_f32 v23, v30, v31
    v_pk_add_f32 v[32:33], v[32:33], v[2:3] op_sel_hi:[1,0] neg_lo:[0,1] neg_hi:[0,1]
    v_pk_add_f32 v[34:35], v[34:35], v[2:3] op_sel_hi:[1,0] neg_lo:[0,1] neg_hi:[0,1]
    v_pk_add_f32 v[36:37], v[36:37], v[2:3] op_sel_hi:[1,0] neg_lo:[0,1] neg_hi:[0,1]
    v_pk_add_f32 v[38:39], v[38:39], v[2:3] op_sel_hi:[1,0] neg_lo:[0,1] neg_hi:[0,1]
    v_pk_add_f32 v[40:41], v[40:41], v[2:3] op_sel_hi:[1,0] neg_lo:[0,1] neg_hi:[0,1]
    v_pk_add_f32 v[42:43], v[42:43], v[2:3] op_sel_hi:[1,0] neg_lo:[0,1] neg_hi:[0,1]
    v_pk_add_f32 v[44:45], v[44:45], v[2:3] op_sel_hi:[1,0] neg_lo:[0,1] neg_hi:[0,1]
    v_pk_add_f32 v[46:47], v[46:47], v[2:3] op_sel_hi:[1,0] neg_lo:[0,1] neg_hi:[0,1]
    s_waitcnt lgkmcnt(0)
    v_mfma_f32_32x32x16_bf16 v[192:207], v[226:229], v[16:19], 0
    v_mfma_f32_32x32x16_bf16 v[192:207], v[230:233], v[20:23], v[192:207]
    ds_read_b128 v[226:229], v10 offset:2688
    ds_read_b128 v[230:233], v10 offset:3360
    v_exp_f32 v32, v32
    v_exp_f32 v33, v33
    v_exp_f32 v34, v34
    v_exp_f32 v35, v35
    v_exp_f32 v36, v36
    v_exp_f32 v37, v37
    v_exp_f32 v38, v38
    v_exp_f32 v39, v39
    v_exp_f32 v40, v40
    v_exp_f32 v41, v41
    v_exp_f32 v42, v42
    v_exp_f32 v43, v43
    v_exp_f32 v44, v44
    v_exp_f32 v45, v45
    v_exp_f32 v46, v46
    v_exp_f32 v47, v47
    s_nop 0
    v_cvt_pk_bf16_f32 v32, v32, v33
    v_cvt_pk_bf16_f32 v33, v34, v35
    v_cvt_pk_bf16_f32 v34, v36, v37
    v_cvt_pk_bf16_f32 v35, v38, v39
    v_cvt_pk_bf16_f32 v36, v40, v41
    v_cvt_pk_bf16_f32 v37, v42, v43
    v_cvt_pk_bf16_f32 v38, v44, v45
    v_cvt_pk_bf16_f32 v39, v46, v47
    v_pk_add_f32 v[48:49], v[48:49], v[2:3] op_sel_hi:[1,0] neg_lo:[0,1] neg_hi:[0,1]
    v_pk_add_f32 v[50:51], v[50:51], v[2:3] op_sel_hi:[1,0] neg_lo:[0,1] neg_hi:[0,1]
    v_pk_add_f32 v[52:53], v[52:53], v[2:3] op_sel_hi:[1,0] neg_lo:[0,1] neg_hi:[0,1]
    v_pk_add_f32 v[54:55], v[54:55], v[2:3] op_sel_hi:[1,0] neg_lo:[0,1] neg_hi:[0,1]
    v_pk_add_f32 v[56:57], v[56:57], v[2:3] op_sel_hi:[1,0] neg_lo:[0,1] neg_hi:[0,1]
    v_pk_add_f32 v[58:59], v[58:59], v[2:3] op_sel_hi:[1,0] neg_lo:[0,1] neg_hi:[0,1]
    v_pk_add_f32 v[60:61], v[60:61], v[2:3] op_sel_hi:[1,0] neg_lo:[0,1] neg_hi:[0,1]
    v_pk_add_f32 v[62:63], v[62:63], v[2:3] op_sel_hi:[1,0] neg_lo:[0,1] neg_hi:[0,1]
    s_waitcnt lgkmcnt(0)
    v_mfma_f32_32x32x16_bf16 v[192:207], v[234:237], v[32:35], v[192:207]
    v_mfma_f32_32x32x16_bf16 v[192:207], v[238:241], v[36:39], v[192:207]
    ds_read_b128 v[234:237], v10 offset:4032
    ds_read_b128 v[238:241], v10 offset:4704
    v_exp_f32 v48, v48
    v_exp_f32 v49, v49
    v_exp_f32 v50, v50
    v_exp_f32 v51, v51
    v_exp_f32 v52, v52
    v_exp_f32 v53, v53
    v_exp_f32 v54, v54
    v_exp_f32 v55, v55
    v_exp_f32 v56, v56
    v_exp_f32 v57, v57
    v_exp_f32 v58, v58
    v_exp_f32 v59, v59
    v_exp_f32 v60, v60
    v_exp_f32 v61, v61
    v_exp_f32 v62, v62
    v_exp_f32 v63, v63
    s_nop 0
    v_cvt_pk_bf16_f32 v48, v48, v49
    v_cvt_pk_bf16_f32 v49, v50, v51
    v_cvt_pk_bf16_f32 v50, v52, v53
    v_cvt_pk_bf16_f32 v51, v54, v55
    v_cvt_pk_bf16_f32 v52, v56, v57
    v_cvt_pk_bf16_f32 v53, v58, v59
    v_cvt_pk_bf16_f32 v54, v60, v61
    v_cvt_pk_bf16_f32 v55, v62, v63
    v_pk_add_f32 v[64:65], v[64:65], v[2:3] op_sel_hi:[1,0] neg_lo:[0,1] neg_hi:[0,1]
    v_pk_add_f32 v[66:67], v[66:67], v[2:3] op_sel_hi:[1,0] neg_lo:[0,1] neg_hi:[0,1]
    v_pk_add_f32 v[68:69], v[68:69], v[2:3] op_sel_hi:[1,0] neg_lo:[0,1] neg_hi:[0,1]
    v_pk_add_f32 v[70:71], v[70:71], v[2:3] op_sel_hi:[1,0] neg_lo:[0,1] neg_hi:[0,1]
    v_pk_add_f32 v[72:73], v[72:73], v[2:3] op_sel_hi:[1,0] neg_lo:[0,1] neg_hi:[0,1]
    v_pk_add_f32 v[74:75], v[74:75], v[2:3] op_sel_hi:[1,0] neg_lo:[0,1] neg_hi:[0,1]
    v_pk_add_f32 v[76:77], v[76:77], v[2:3] op_sel_hi:[1,0] neg_lo:[0,1] neg_hi:[0,1]
    v_pk_add_f32 v[78:79], v[78:79], v[2:3] op_sel_hi:[1,0] neg_lo:[0,1] neg_hi:[0,1]
    s_waitcnt lgkmcnt(0)
    v_mfma_f32_32x32x16_bf16 v[192:207], v[226:229], v[48:51], v[192:207]
    v_mfma_f32_32x32x16_bf16 v[192:207], v[230:233], v[52:55], v[192:207]
    ds_read_b128 v[226:229], v10 offset:5376
    ds_read_b128 v[230:233], v10 offset:6048
    v_exp_f32 v64, v64
    v_exp_f32 v65, v65
    v_exp_f32 v66, v66
    v_exp_f32 v67, v67
    v_exp_f32 v68, v68
    v_exp_f32 v69, v69
    v_exp_f32 v70, v70
    v_exp_f32 v71, v71
    v_exp_f32 v72, v72
    v_exp_f32 v73, v73
    v_exp_f32 v74, v74
    v_exp_f32 v75, v75
    v_exp_f32 v76, v76
    v_exp_f32 v77, v77
    v_exp_f32 v78, v78
    v_exp_f32 v79, v79
    s_nop 0
    v_cvt_pk_bf16_f32 v64, v64, v65
    v_cvt_pk_bf16_f32 v65, v66, v67
    v_cvt_pk_bf16_f32 v66, v68, v69
    v_cvt_pk_bf16_f32 v67, v70, v71
    v_cvt_pk_bf16_f32 v68, v72, v73
    v_cvt_pk_bf16_f32 v69, v74, v75
    v_cvt_pk_bf16_f32 v70, v76, v77
    v_cvt_pk_bf16_f32 v71, v78, v79
    v_pk_add_f32 v[80:81], v[80:81], v[2:3] op_sel_hi:[1,0] neg_lo:[0,1] neg_hi:[0,1]
    v_pk_add_f32 v[82:83], v[82:83], v[2:3] op_sel_hi:[1,0] neg_lo:[0,1] neg_hi:[0,1]
    v_pk_add_f32 v[84:85], v[84:85], v[2:3] op_sel_hi:[1,0] neg_lo:[0,1] neg_hi:[0,1]
    v_pk_add_f32 v[86:87], v[86:87], v[2:3] op_sel_hi:[1,0] neg_lo:[0,1] neg_hi:[0,1]
    v_pk_add_f32 v[88:89], v[88:89], v[2:3] op_sel_hi:[1,0] neg_lo:[0,1] neg_hi:[0,1]
    v_pk_add_f32 v[90:91], v[90:91], v[2:3] op_sel_hi:[1,0] neg_lo:[0,1] neg_hi:[0,1]
    v_pk_add_f32 v[92:93], v[92:93], v[2:3] op_sel_hi:[1,0] neg_lo:[0,1] neg_hi:[0,1]
    v_pk_add_f32 v[94:95], v[94:95], v[2:3] op_sel_hi:[1,0] neg_lo:[0,1] neg_hi:[0,1]
    s_waitcnt lgkmcnt(0)
    v_mfma_f32_32x32x16_bf16 v[192:207], v[234:237], v[64:67], v[192:207]
    v_mfma_f32_32x32x16_bf16 v[192:207], v[238:241], v[68:71], v[192:207]
    ds_read_b128 v[234:237], v10 offset:6720
    ds_read_b128 v[238:241], v10 offset:7392
    v_exp_f32 v80, v80
    v_exp_f32 v81, v81
    v_exp_f32 v82, v82
    v_exp_f32 v83, v83
    v_exp_f32 v84, v84
    v_exp_f32 v85, v85
    v_exp_f32 v86, v86
    v_exp_f32 v87, v87
    v_exp_f32 v88, v88
    v_exp_f32 v89, v89
    v_exp_f32 v90, v90
    v_exp_f32 v91, v91
    v_exp_f32 v92, v92
    v_exp_f32 v93, v93
    v_exp_f32 v94, v94
    v_exp_f32 v95, v95
    s_nop 0
    v_cvt_pk_bf16_f32 v80, v80, v81
    v_cvt_pk_bf16_f32 v81, v82, v83
    v_cvt_pk_bf16_f32 v82, v84, v85
    v_cvt_pk_bf16_f32 v83, v86, v87
    v_cvt_pk_bf16_f32 v84, v88, v89
    v_cvt_pk_bf16_f32 v85, v90, v91
    v_cvt_pk_bf16_f32 v86, v92, v93
    v_cvt_pk_bf16_f32 v87, v94, v95
    v_pk_add_f32 v[96:97], v[96:97], v[2:3] op_sel_hi:[1,0] neg_lo:[0,1] neg_hi:[0,1]
    v_pk_add_f32 v[98:99], v[98:99], v[2:3] op_sel_hi:[1,0] neg_lo:[0,1] neg_hi:[0,1]
    v_pk_add_f32 v[100:101], v[100:101], v[2:3] op_sel_hi:[1,0] neg_lo:[0,1] neg_hi:[0,1]
    v_pk_add_f32 v[102:103], v[102:103], v[2:3] op_sel_hi:[1,0] neg_lo:[0,1] neg_hi:[0,1]
    v_pk_add_f32 v[104:105], v[104:105], v[2:3] op_sel_hi:[1,0] neg_lo:[0,1] neg_hi:[0,1]
    v_pk_add_f32 v[106:107], v[106:107], v[2:3] op_sel_hi:[1,0] neg_lo:[0,1] neg_hi:[0,1]
    v_pk_add_f32 v[108:109], v[108:109], v[2:3] op_sel_hi:[1,0] neg_lo:[0,1] neg_hi:[0,1]
    v_pk_add_f32 v[110:111], v[110:111], v[2:3] op_sel_hi:[1,0] neg_lo:[0,1] neg_hi:[0,1]
    s_waitcnt lgkmcnt(0)
    v_mfma_f32_32x32x16_bf16 v[192:207], v[226:229], v[80:83], v[192:207]
    v_mfma_f32_32x32x16_bf16 v[192:207], v[230:233], v[84:87], v[192:207]
    ds_read_b128 v[226:229], v10 offset:8064
    ds_read_b128 v[230:233], v10 offset:8736
    v_exp_f32 v96, v96
    v_exp_f32 v97, v97
    v_exp_f32 v98, v98
    v_exp_f32 v99, v99
    v_exp_f32 v100, v100
    v_exp_f32 v101, v101
    v_exp_f32 v102, v102
    v_exp_f32 v103, v103
    v_exp_f32 v104, v104
    v_exp_f32 v105, v105
    v_exp_f32 v106, v106
    v_exp_f32 v107, v107
    v_exp_f32 v108, v108
    v_exp_f32 v109, v109
    v_exp_f32 v110, v110
    v_exp_f32 v111, v111
    s_nop 0
    v_cvt_pk_bf16_f32 v96, v96, v97
    v_cvt_pk_bf16_f32 v97, v98, v99
    v_cvt_pk_bf16_f32 v98, v100, v101
    v_cvt_pk_bf16_f32 v99, v102, v103
    v_cvt_pk_bf16_f32 v100, v104, v105
    v_cvt_pk_bf16_f32 v101, v106, v107
    v_cvt_pk_bf16_f32 v102, v108, v109
    v_cvt_pk_bf16_f32 v103, v110, v111
    v_pk_add_f32 v[112:113], v[112:113], v[2:3] op_sel_hi:[1,0] neg_lo:[0,1] neg_hi:[0,1]
    v_pk_add_f32 v[114:115], v[114:115], v[2:3] op_sel_hi:[1,0] neg_lo:[0,1] neg_hi:[0,1]
    v_pk_add_f32 v[116:117], v[116:117], v[2:3] op_sel_hi:[1,0] neg_lo:[0,1] neg_hi:[0,1]
    v_pk_add_f32 v[118:119], v[118:119], v[2:3] op_sel_hi:[1,0] neg_lo:[0,1] neg_hi:[0,1]
    v_pk_add_f32 v[120:121], v[120:121], v[2:3] op_sel_hi:[1,0] neg_lo:[0,1] neg_hi:[0,1]
    v_pk_add_f32 v[122:123], v[122:123], v[2:3] op_sel_hi:[1,0] neg_lo:[0,1] neg_hi:[0,1]
    v_pk_add_f32 v[124:125], v[124:125], v[2:3] op_sel_hi:[1,0] neg_lo:[0,1] neg_hi:[0,1]
    v_pk_add_f32 v[126:127], v[126:127], v[2:3] op_sel_hi:[1,0] neg_lo:[0,1] neg_hi:[0,1]
    s_waitcnt lgkmcnt(0)
    v_mfma_f32_32x32x16_bf16 v[192:207], v[234:237], v[96:99], v[192:207]
    v_mfma_f32_32x32x16_bf16 v[192:207], v[238:241], v[100:103], v[192:207]
    ds_read_b128 v[234:237], v10 offset:9408
    ds_read_b128 v[238:241], v10 offset:10080
    v_exp_f32 v112, v112
    v_exp_f32 v113, v113
    v_exp_f32 v114, v114
    v_exp_f32 v115, v115
    v_exp_f32 v116, v116
    v_exp_f32 v117, v117
    v_exp_f32 v118, v118
    v_exp_f32 v119, v119
    v_exp_f32 v120, v120
    v_exp_f32 v121, v121
    v_exp_f32 v122, v122
    v_exp_f32 v123, v123
    v_exp_f32 v124, v124
    v_exp_f32 v125, v125
    v_exp_f32 v126, v126
    v_exp_f32 v127, v127
    s_nop 0
    v_cvt_pk_bf16_f32 v112, v112, v113
    v_cvt_pk_bf16_f32 v113, v114, v115
    v_cvt_pk_bf16_f32 v114, v116, v117
    v_cvt_pk_bf16_f32 v115, v118, v119
    v_cvt_pk_bf16_f32 v116, v120, v121
    v_cvt_pk_bf16_f32 v117, v122, v123
    v_cvt_pk_bf16_f32 v118, v124, v125
    v_cvt_pk_bf16_f32 v119, v126, v127
    v_pk_add_f32 v[128:129], v[128:129], v[2:3] op_sel_hi:[1,0] neg_lo:[0,1] neg_hi:[0,1]
    v_pk_add_f32 v[130:131], v[130:131], v[2:3] op_sel_hi:[1,0] neg_lo:[0,1] neg_hi:[0,1]
    v_pk_add_f32 v[132:133], v[132:133], v[2:3] op_sel_hi:[1,0] neg_lo:[0,1] neg_hi:[0,1]
    v_pk_add_f32 v[134:135], v[134:135], v[2:3] op_sel_hi:[1,0] neg_lo:[0,1] neg_hi:[0,1]
    v_pk_add_f32 v[136:137], v[136:137], v[2:3] op_sel_hi:[1,0] neg_lo:[0,1] neg_hi:[0,1]
    v_pk_add_f32 v[138:139], v[138:139], v[2:3] op_sel_hi:[1,0] neg_lo:[0,1] neg_hi:[0,1]
    v_pk_add_f32 v[140:141], v[140:141], v[2:3] op_sel_hi:[1,0] neg_lo:[0,1] neg_hi:[0,1]
    v_pk_add_f32 v[142:143], v[142:143], v[2:3] op_sel_hi:[1,0] neg_lo:[0,1] neg_hi:[0,1]
    s_waitcnt lgkmcnt(0)
    v_mfma_f32_32x32x16_bf16 v[192:207], v[226:229], v[112:115], v[192:207]
    v_mfma_f32_32x32x16_bf16 v[192:207], v[230:233], v[116:119], v[192:207]
    ds_read_b128 v[226:229], v10 offset:10752
    ds_read_b128 v[230:233], v10 offset:11424
    v_exp_f32 v128, v128
    v_exp_f32 v129, v129
    v_exp_f32 v130, v130
    v_exp_f32 v131, v131
    v_exp_f32 v132, v132
    v_exp_f32 v133, v133
    v_exp_f32 v134, v134
    v_exp_f32 v135, v135
    v_exp_f32 v136, v136
    v_exp_f32 v137, v137
    v_exp_f32 v138, v138
    v_exp_f32 v139, v139
    v_exp_f32 v140, v140
    v_exp_f32 v141, v141
    v_exp_f32 v142, v142
    v_exp_f32 v143, v143
    s_nop 0
    v_cvt_pk_bf16_f32 v128, v128, v129
    v_cvt_pk_bf16_f32 v129, v130, v131
    v_cvt_pk_bf16_f32 v130, v132, v133
    v_cvt_pk_bf16_f32 v131, v134, v135
    v_cvt_pk_bf16_f32 v132, v136, v137
    v_cvt_pk_bf16_f32 v133, v138, v139
    v_cvt_pk_bf16_f32 v134, v140, v141
    v_cvt_pk_bf16_f32 v135, v142, v143
    v_pk_add_f32 v[144:145], v[144:145], v[2:3] op_sel_hi:[1,0] neg_lo:[0,1] neg_hi:[0,1]
    v_pk_add_f32 v[146:147], v[146:147], v[2:3] op_sel_hi:[1,0] neg_lo:[0,1] neg_hi:[0,1]
    v_pk_add_f32 v[148:149], v[148:149], v[2:3] op_sel_hi:[1,0] neg_lo:[0,1] neg_hi:[0,1]
    v_pk_add_f32 v[150:151], v[150:151], v[2:3] op_sel_hi:[1,0] neg_lo:[0,1] neg_hi:[0,1]
    v_pk_add_f32 v[152:153], v[152:153], v[2:3] op_sel_hi:[1,0] neg_lo:[0,1] neg_hi:[0,1]
    v_pk_add_f32 v[154:155], v[154:155], v[2:3] op_sel_hi:[1,0] neg_lo:[0,1] neg_hi:[0,1]
    v_pk_add_f32 v[156:157], v[156:157], v[2:3] op_sel_hi:[1,0] neg_lo:[0,1] neg_hi:[0,1]
    v_pk_add_f32 v[158:159], v[158:159], v[2:3] op_sel_hi:[1,0] neg_lo:[0,1] neg_hi:[0,1]
    s_waitcnt lgkmcnt(0)
    v_mfma_f32_32x32x16_bf16 v[192:207], v[234:237], v[128:131], v[192:207]
    v_mfma_f32_32x32x16_bf16 v[192:207], v[238:241], v[132:135], v[192:207]
    v_exp_f32 v144, v144
    v_exp_f32 v145, v145
    v_exp_f32 v146, v146
    v_exp_f32 v147, v147
    v_exp_f32 v148, v148
    v_exp_f32 v149, v149
    v_exp_f32 v150, v150
    v_exp_f32 v151, v151
    v_exp_f32 v152, v152
    v_exp_f32 v153, v153
    v_exp_f32 v154, v154
    v_exp_f32 v155, v155
    v_exp_f32 v156, v156
    v_exp_f32 v157, v157
    v_exp_f32 v158, v158
    v_exp_f32 v159, v159
    s_nop 0
    v_cvt_pk_bf16_f32 v144, v144, v145
    v_cvt_pk_bf16_f32 v145, v146, v147
    v_cvt_pk_bf16_f32 v146, v148, v149
    v_cvt_pk_bf16_f32 v147, v150, v151
    v_cvt_pk_bf16_f32 v148, v152, v153
    v_cvt_pk_bf16_f32 v149, v154, v155
    v_cvt_pk_bf16_f32 v150, v156, v157
    v_cvt_pk_bf16_f32 v151, v158, v159
    s_waitcnt lgkmcnt(0)
    s_nop 0
    v_mfma_f32_32x32x16_bf16 v[192:207], v[226:229], v[144:147], v[192:207]
    v_mfma_f32_32x32x16_bf16 v[192:207], v[230:233], v[148:151], v[192:207]
ajoin_87:
    v_mov_b32 v242, v248
    v_mov_b32 v243, v249
    v_mov_b32 v244, v250
    v_mov_b32 v245, v251
    v_mov_b32 v246, v252
    v_mov_b32 v247, v253
    v_add_u32 v8, 5120, v8
    v_add_u32 v9, 5120, v9
    v_add_u32 v10, 5376, v10
    s_sub_u32 s57, s57, s58
    s_nop 2
    v_mov_b32 v2, v200
    v_mov_b32 v3, v200
    s_nop 1
    v_permlane32_swap_b32 v2, v3
    v_rcp_f32 v2, v3
    s_nop 0
    v_pk_mul_f32 v[192:193], v[192:193], v[2:3] op_sel_hi:[1,0]
    v_pk_mul_f32 v[194:195], v[194:195], v[2:3] op_sel_hi:[1,0]
    v_pk_mul_f32 v[196:197], v[196:197], v[2:3] op_sel_hi:[1,0]
    v_pk_mul_f32 v[198:199], v[198:199], v[2:3] op_sel_hi:[1,0]
    v_pk_mul_f32 v[200:201], v[200:201], v[2:3] op_sel_hi:[1,0]
    v_pk_mul_f32 v[202:203], v[202:203], v[2:3] op_sel_hi:[1,0]
    v_cvt_pk_bf16_f32 v4, v192, v193
    v_cvt_pk_bf16_f32 v5, v194, v195
    v_cvt_pk_bf16_f32 v6, v196, v197
    v_cvt_pk_bf16_f32 v7, v198, v199
    v_cvt_pk_bf16_f32 v14, v200, v201
    v_cvt_pk_bf16_f32 v15, v202, v203
    s_setprio 2
    buffer_store_dwordx4 v[4:7], v11, s[24:27], s56 offen sc1
    buffer_store_dwordx2 v[14:15], v12, s[24:27], s61 offen sc1
    s_setprio 0
    s_add_u32 s56, s56, 131072
    s_add_u32 s61, s61, 32768
    s_add_u32 s59, s59, 1
    s_cmp_lt_u32 s59, 2
    s_cbranch_scc1 atask_68
    s_branch afin_67
inv_71:
    v_mov_b32 v16, 0xff800000
    v_mov_b32 v17, 0xff800000
    v_mov_b32 v18, 0xff800000
    v_mov_b32 v19, 0xff800000
    v_mov_b32 v20, 0xff800000
    v_mov_b32 v21, 0xff800000
    v_mov_b32 v22, 0xff800000
    v_mov_b32 v23, 0xff800000
    v_mov_b32 v24, 0xff800000
    v_mov_b32 v25, 0xff800000
    v_mov_b32 v26, 0xff800000
    v_mov_b32 v27, 0xff800000
    v_mov_b32 v28, 0xff800000
    v_mov_b32 v29, 0xff800000
    v_mov_b32 v30, 0xff800000
    v_mov_b32 v31, 0xff800000
    s_branch invb_79
inv_72:
    v_mov_b32 v32, 0xff800000
    v_mov_b32 v33, 0xff800000
    v_mov_b32 v34, 0xff800000
    v_mov_b32 v35, 0xff800000
    v_mov_b32 v36, 0xff800000
    v_mov_b32 v37, 0xff800000
    v_mov_b32 v38, 0xff800000
    v_mov_b32 v39, 0xff800000
    v_mov_b32 v40, 0xff800000
    v_mov_b32 v41, 0xff800000
    v_mov_b32 v42, 0xff800000
    v_mov_b32 v43, 0xff800000
    v_mov_b32 v44, 0xff800000
    v_mov_b32 v45, 0xff800000
    v_mov_b32 v46, 0xff800000
    v_mov_b32 v47, 0xff800000
    s_branch invb_80
inv_73:
    v_mov_b32 v48, 0xff800000
    v_mov_b32 v49, 0xff800000
    v_mov_b32 v50, 0xff800000
    v_mov_b32 v51, 0xff800000
    v_mov_b32 v52, 0xff800000
    v_mov_b32 v53, 0xff800000
    v_mov_b32 v54, 0xff800000
    v_mov_b32 v55, 0xff800000
    v_mov_b32 v56, 0xff800000
    v_mov_b32 v57, 0xff800000
    v_mov_b32 v58, 0xff800000
    v_mov_b32 v59, 0xff800000
    v_mov_b32 v60, 0xff800000
    v_mov_b32 v61, 0xff800000
    v_mov_b32 v62, 0xff800000
    v_mov_b32 v63, 0xff800000
    s_branch invb_81
inv_74:
    v_mov_b32 v64, 0xff800000
    v_mov_b32 v65, 0xff800000
    v_mov_b32 v66, 0xff800000
    v_mov_b32 v67, 0xff800000
    v_mov_b32 v68, 0xff800000
    v_mov_b32 v69, 0xff800000
    v_mov_b32 v70, 0xff800000
    v_mov_b32 v71, 0xff800000
    v_mov_b32 v72, 0xff800000
    v_mov_b32 v73, 0xff800000
    v_mov_b32 v74, 0xff800000
    v_mov_b32 v75, 0xff800000
    v_mov_b32 v76, 0xff800000
    v_mov_b32 v77, 0xff800000
    v_mov_b32 v78, 0xff800000
    v_mov_b32 v79, 0xff800000
    s_branch invb_82
inv_75:
    v_mov_b32 v80, 0xff800000
    v_mov_b32 v81, 0xff800000
    v_mov_b32 v82, 0xff800000
    v_mov_b32 v83, 0xff800000
    v_mov_b32 v84, 0xff800000
    v_mov_b32 v85, 0xff800000
    v_mov_b32 v86, 0xff800000
    v_mov_b32 v87, 0xff800000
    v_mov_b32 v88, 0xff800000
    v_mov_b32 v89, 0xff800000
    v_mov_b32 v90, 0xff800000
    v_mov_b32 v91, 0xff800000
    v_mov_b32 v92, 0xff800000
    v_mov_b32 v93, 0xff800000
    v_mov_b32 v94, 0xff800000
    v_mov_b32 v95, 0xff800000
    s_branch invb_83
inv_76:
    v_mov_b32 v96, 0xff800000
    v_mov_b32 v97, 0xff800000
    v_mov_b32 v98, 0xff800000
    v_mov_b32 v99, 0xff800000
    v_mov_b32 v100, 0xff800000
    v_mov_b32 v101, 0xff800000
    v_mov_b32 v102, 0xff800000
    v_mov_b32 v103, 0xff800000
    v_mov_b32 v104, 0xff800000
    v_mov_b32 v105, 0xff800000
    v_mov_b32 v106, 0xff800000
    v_mov_b32 v107, 0xff800000
    v_mov_b32 v108, 0xff800000
    v_mov_b32 v109, 0xff800000
    v_mov_b32 v110, 0xff800000
    v_mov_b32 v111, 0xff800000
    s_branch invb_84
inv_77:
    v_mov_b32 v112, 0xff800000
    v_mov_b32 v113, 0xff800000
    v_mov_b32 v114, 0xff800000
    v_mov_b32 v115, 0xff800000
    v_mov_b32 v116, 0xff800000
    v_mov_b32 v117, 0xff800000
    v_mov_b32 v118, 0xff800000
    v_mov_b32 v119, 0xff800000
    v_mov_b32 v120, 0xff800000
    v_mov_b32 v121, 0xff800000
    v_mov_b32 v122, 0xff800000
    v_mov_b32 v123, 0xff800000
    v_mov_b32 v124, 0xff800000
    v_mov_b32 v125, 0xff800000
    v_mov_b32 v126, 0xff800000
    v_mov_b32 v127, 0xff800000
    s_branch invb_85
inv_78:
    v_mov_b32 v128, 0xff800000
    v_mov_b32 v129, 0xff800000
    v_mov_b32 v130, 0xff800000
    v_mov_b32 v131, 0xff800000
    v_mov_b32 v132, 0xff800000
    v_mov_b32 v133, 0xff800000
    v_mov_b32 v134, 0xff800000
    v_mov_b32 v135, 0xff800000
    v_mov_b32 v136, 0xff800000
    v_mov_b32 v137, 0xff800000
    v_mov_b32 v138, 0xff800000
    v_mov_b32 v139, 0xff800000
    v_mov_b32 v140, 0xff800000
    v_mov_b32 v141, 0xff800000
    v_mov_b32 v142, 0xff800000
    v_mov_b32 v143, 0xff800000
    s_branch invb_86
avw_69:
    s_waitcnt vmcnt(0)
    v_mov_b32 v4, 0x3f803f80
    v_mov_b32 v5, v4
    v_mov_b32 v6, v4
    v_mov_b32 v7, v4
    ds_write_b128 v13, v[4:7] offset:320
    s_waitcnt lgkmcnt(0)
    v_mov_b32 v14, 163816
    v_mov_b32 v15, 1
    s_mov_b64 exec, 1
    ds_add_u32 v14, v15
    s_mov_b64 exec, -1
    s_mov_b32 s47, 0x80000
sync_108:
    ds_read_b32 v15, v14
    s_sub_u32 s47, s47, 1
    s_cbranch_scc1 sync_108x
    s_waitcnt lgkmcnt(0)
    v_readfirstlane_b32 s60, v15
    s_cmp_ge_u32 s60, 4
    s_cbranch_scc1 sync_108x
    s_sleep 0
    s_branch sync_108
sync_108x:
    s_branch avb_70
afin_67:
L_adone:
    s_setprio 2
    s_lshl_b32 s61, s49, 8
    s_add_u32 s61, s61, 34816
    s_waitcnt vmcnt(0)
    v_mov_b32 v2, 163788
    v_mov_b32 v3, 1
    s_mov_b64 exec, 1
    ds_add_rtn_u32 v14, v2, v3
    s_waitcnt lgkmcnt(0)
    v_readfirstlane_b32 s60, v14
    s_cmp_lg_u32 s60, 3
    s_cbranch_scc1 arr_109
    v_mov_b32 v3, 1
    buffer_atomic_add v3, off, s[24:27], s61 sc0 sc1
    s_waitcnt vmcnt(0)
    v_readfirstlane_b32 s60, v3
    s_cmp_lg_u32 s60, 31
    s_cbranch_scc1 arr_109
    v_mov_b32 v3, 1
    buffer_store_dword v3, off, s[24:27], s61 offset:128 sc1
arr_109:
    s_mov_b64 exec, -1
    s_mov_b32 s75, s44
    s_setprio 2
    s_lshl_b32 s65, s83, 6
    s_lshl_b32 s68, s44, 4
    s_add_u32 s65, s65, s68
    s_mul_i32 s74, s65, 1280
    s_mul_i32 s68, s82, 160
    s_add_u32 s74, s74, s68
    s_lshl_b32 s65, s65, 1
    v_lshlrev_b32 v2, 1, v1
    s_mov_b64 exec, 0xffff
    buffer_load_ushort v16, v2, s[36:39], s65 offen
    s_mov_b64 exec, -1
    v_add_u32 v2, 0, v1
    v_mul_u32_u24 v3, 205, v2
    v_lshrrev_b32 v3, 11, v3
    v_mul_u32_u24 v4, 1120, v3
    v_lshl_add_u32 v207, v2, 4, v4
    v_min_u32 v3, 15, v3
    v_lshlrev_b32 v17, 2, v3
    buffer_load_dwordx4 v[192:195], v207, s[4:7], s74 offen
    v_add_u32 v2, 64, v1
    v_mul_u32_u24 v3, 205, v2
    v_lshrrev_b32 v3, 11, v3
    v_mul_u32_u24 v4, 1120, v3
    v_lshl_add_u32 v208, v2, 4, v4
    v_min_u32 v3, 15, v3
    v_lshlrev_b32 v18, 2, v3
    buffer_load_dwordx4 v[196:199], v208, s[4:7], s74 offen
    v_add_u32 v2, 128, v1
    v_mul_u32_u24 v3, 205, v2
    v_lshrrev_b32 v3, 11, v3
    v_mul_u32_u24 v4, 1120, v3
    v_lshl_add_u32 v209, v2, 4, v4
    v_min_u32 v3, 15, v3
    v_lshlrev_b32 v19, 2, v3
    v_cmp_gt_u32 vcc, 32, v1
    v_mov_b32 v4, 0x7fff0000
    s_nop 0
    v_cndmask_b32 v209, v4, v209, vcc
    buffer_load_dwordx4 v[200:203], v209, s[4:7], s74 offen
    s_cmp_lg_u32 s44, 0
    s_cbranch_scc1 og_110
    s_lshr_b32 s51, s83, 2
    s_lshl_b32 s51, s51, 8
    s_add_u32 s51, s51, 34944
    v_mov_b32 v2, 0
    s_mov_b64 exec, 1
    s_mov_b32 s47, 0x8000
gp_111:
    buffer_load_dword v3, v2, s[24:27], s51 offen sc1
    s_sub_u32 s47, s47, 1
    s_cbranch_scc1 gp_111x
    s_waitcnt vmcnt(0)
    v_cmp_ne_u32 vcc, 1, v3
    s_cbranch_vccz gp_111x
    s_sleep 8
    s_branch gp_111
gp_111x:
    s_mov_b64 exec, -1
    v_mov_b32 v2, 163812
    v_mov_b32 v3, 1
    ds_write_b32 v2, v3
og_110:
    s_mul_i32 s65, s44, 5120
    s_add_u32 s65, s65, 65536
    v_add_u32 v2, 0, v1
    v_min_u32 v2, 159, v2
    v_mul_u32_u24 v3, 205, v2
    v_bfe_u32 v4, v3, 13, 1
    v_xor_b32 v2, v2, v4
    v_lshlrev_b32 v2, 4, v2
    v_add_u32 v210, s65, v2
    v_add_u32 v211, 2560, v210
    v_add_u32 v2, 64, v1
    v_min_u32 v2, 159, v2
    v_mul_u32_u24 v3, 205, v2
    v_bfe_u32 v4, v3, 13, 1
    v_xor_b32 v2, v2, v4
    v_lshlrev_b32 v2, 4, v2
    v_add_u32 v212, s65, v2
    v_add_u32 v213, 2560, v212
    v_add_u32 v2, 128, v1
    v_min_u32 v2, 159, v2
    v_mul_u32_u24 v3, 205, v2
    v_bfe_u32 v4, v3, 13, 1
    v_xor_b32 v2, v2, v4
    v_lshlrev_b32 v2, 4, v2
    v_add_u32 v214, s65, v2
    v_add_u32 v215, 2560, v214
    s_waitcnt vmcnt(0)
    ds_bpermute_b32 v204, v17, v16
    ds_bpermute_b32 v205, v18, v16
    ds_bpermute_b32 v206, v19, v16
    s_waitcnt lgkmcnt(0)
    v_lshlrev_b32 v204, 16, v204
    v_lshlrev_b32 v40, 16, v192
    v_and_b32 v41, 0xffff0000, v192
    v_lshlrev_b32 v42, 16, v193
    v_and_b32 v43, 0xffff0000, v193
    v_lshlrev_b32 v44, 16, v194
    v_and_b32 v45, 0xffff0000, v194
    v_lshlrev_b32 v46, 16, v195
    v_and_b32 v47, 0xffff0000, v195
    v_add_f32 v40, v40, v204
    v_add_f32 v41, v41, v204
    v_add_f32 v42, v42, v204
    v_add_f32 v43, v43, v204
    v_add_f32 v44, v44, v204
    v_add_f32 v45, v45, v204
    v_add_f32 v46, v46, v204
    v_add_f32 v47, v47, v204
    v_lshlrev_b32 v205, 16, v205
    v_lshlrev_b32 v48, 16, v196
    v_and_b32 v49, 0xffff0000, v196
    v_lshlrev_b32 v50, 16, v197
    v_and_b32 v51, 0xffff0000, v197
    v_lshlrev_b32 v52, 16, v198
    v_and_b32 v53, 0xffff0000, v198
    v_lshlrev_b32 v54, 16, v199
    v_and_b32 v55, 0xffff0000, v199
    v_add_f32 v48, v48, v205
    v_add_f32 v49, v49, v205
    v_add_f32 v50, v50, v205
    v_add_f32 v51, v51, v205
    v_add_f32 v52, v52, v205
    v_add_f32 v53, v53, v205
    v_add_f32 v54, v54, v205
    v_add_f32 v55, v55, v205
    v_lshlrev_b32 v206, 16, v206
    v_lshlrev_b32 v56, 16, v200
    v_and_b32 v57, 0xffff0000, v200
    v_lshlrev_b32 v58, 16, v201
    v_and_b32 v59, 0xffff0000, v201
    v_lshlrev_b32 v60, 16, v202
    v_and_b32 v61, 0xffff0000, v202
    v_lshlrev_b32 v62, 16, v203
    v_and_b32 v63, 0xffff0000, v203
    v_add_f32 v56, v56, v206
    v_add_f32 v57, v57, v206
    v_add_f32 v58, v58, v206
    v_add_f32 v59, v59, v206
    v_add_f32 v60, v60, v206
    v_add_f32 v61, v61, v206
    v_add_f32 v62, v62, v206
    v_add_f32 v63, v63, v206
    s_setprio 3
    s_barrier
    ds_read_b128 v[96:99], v210 offset:0
    ds_read_b128 v[100:103], v211 offset:0
    ds_read_b128 v[104:107], v210 offset:20480
    ds_read_b128 v[108:111], v211 offset:20480
    ds_read_b128 v[112:115], v210 offset:40960
    ds_read_b128 v[116:119], v211 offset:40960
    ds_read_b128 v[120:123], v210 offset:61440
    ds_read_b128 v[124:127], v211 offset:61440
    ds_read_b128 v[128:131], v212 offset:0
    ds_read_b128 v[132:135], v213 offset:0
    ds_read_b128 v[136:139], v212 offset:20480
    ds_read_b128 v[140:143], v213 offset:20480
    ds_read_b128 v[144:147], v212 offset:40960
    ds_read_b128 v[148:151], v213 offset:40960
    ds_read_b128 v[152:155], v212 offset:61440
    ds_read_b128 v[156:159], v213 offset:61440
    s_waitcnt lgkmcnt(8)
    v_pk_add_f32 v[40:41], v[40:41], v[96:97]
    v_pk_add_f32 v[42:43], v[42:43], v[98:99]
    v_pk_add_f32 v[44:45], v[44:45], v[100:101]
    v_pk_add_f32 v[46:47], v[46:47], v[102:103]
    v_pk_add_f32 v[40:41], v[40:41], v[104:105]
    v_pk_add_f32 v[42:43], v[42:43], v[106:107]
    v_pk_add_f32 v[44:45], v[44:45], v[108:109]
    v_pk_add_f32 v[46:47], v[46:47], v[110:111]
    v_pk_add_f32 v[40:41], v[40:41], v[112:113]
    v_pk_add_f32 v[42:43], v[42:43], v[114:115]
    v_pk_add_f32 v[44:45], v[44:45], v[116:117]
    v_pk_add_f32 v[46:47], v[46:47], v[118:119]
    v_pk_add_f32 v[40:41], v[40:41], v[120:121]
    v_pk_add_f32 v[42:43], v[42:43], v[122:123]
    v_pk_add_f32 v[44:45], v[44:45], v[124:125]
    v_pk_add_f32 v[46:47], v[46:47], v[126:127]
    v_cvt_pk_bf16_f32 v16, v40, v41
    v_cvt_pk_bf16_f32 v17, v42, v43
    v_cvt_pk_bf16_f32 v18, v44, v45
    v_cvt_pk_bf16_f32 v19, v46, v47
    buffer_store_dwordx4 v[16:19], v207, s[28:31], s74 offen sc1
    ds_read_b128 v[160:163], v214 offset:0
    ds_read_b128 v[164:167], v215 offset:0
    ds_read_b128 v[168:171], v214 offset:20480
    ds_read_b128 v[172:175], v215 offset:20480
    ds_read_b128 v[176:179], v214 offset:40960
    ds_read_b128 v[180:183], v215 offset:40960
    ds_read_b128 v[184:187], v214 offset:61440
    ds_read_b128 v[188:191], v215 offset:61440
    s_waitcnt lgkmcnt(8)
    v_pk_add_f32 v[48:49], v[48:49], v[128:129]
    v_pk_add_f32 v[50:51], v[50:51], v[130:131]
    v_pk_add_f32 v[52:53], v[52:53], v[132:133]
    v_pk_add_f32 v[54:55], v[54:55], v[134:135]
    v_pk_add_f32 v[48:49], v[48:49], v[136:137]
    v_pk_add_f32 v[50:51], v[50:51], v[138:139]
    v_pk_add_f32 v[52:53], v[52:53], v[140:141]
    v_pk_add_f32 v[54:55], v[54:55], v[142:143]
    v_pk_add_f32 v[48:49], v[48:49], v[144:145]
    v_pk_add_f32 v[50:51], v[50:51], v[146:147]
    v_pk_add_f32 v[52:53], v[52:53], v[148:149]
    v_pk_add_f32 v[54:55], v[54:55], v[150:151]
    v_pk_add_f32 v[48:49], v[48:49], v[152:153]
    v_pk_add_f32 v[50:51], v[50:51], v[154:155]
    v_pk_add_f32 v[52:53], v[52:53], v[156:157]
    v_pk_add_f32 v[54:55], v[54:55], v[158:159]
    v_cvt_pk_bf16_f32 v20, v48, v49
    v_cvt_pk_bf16_f32 v21, v50, v51
    v_cvt_pk_bf16_f32 v22, v52, v53
    v_cvt_pk_bf16_f32 v23, v54, v55
    buffer_store_dwordx4 v[20:23], v208, s[28:31], s74 offen sc1
    s_waitcnt lgkmcnt(0)
    v_pk_add_f32 v[56:57], v[56:57], v[160:161]
    v_pk_add_f32 v[58:59], v[58:59], v[162:163]
    v_pk_add_f32 v[60:61], v[60:61], v[164:165]
    v_pk_add_f32 v[62:63], v[62:63], v[166:167]
    v_pk_add_f32 v[56:57], v[56:57], v[168:169]
    v_pk_add_f32 v[58:59], v[58:59], v[170:171]
    v_pk_add_f32 v[60:61], v[60:61], v[172:173]
    v_pk_add_f32 v[62:63], v[62:63], v[174:175]
    v_pk_add_f32 v[56:57], v[56:57], v[176:177]
    v_pk_add_f32 v[58:59], v[58:59], v[178:179]
    v_pk_add_f32 v[60:61], v[60:61], v[180:181]
    v_pk_add_f32 v[62:63], v[62:63], v[182:183]
    v_pk_add_f32 v[56:57], v[56:57], v[184:185]
    v_pk_add_f32 v[58:59], v[58:59], v[186:187]
    v_pk_add_f32 v[60:61], v[60:61], v[188:189]
    v_pk_add_f32 v[62:63], v[62:63], v[190:191]
    v_cvt_pk_bf16_f32 v24, v56, v57
    v_cvt_pk_bf16_f32 v25, v58, v59
    v_cvt_pk_bf16_f32 v26, v60, v61
    v_cvt_pk_bf16_f32 v27, v62, v63
    buffer_store_dwordx4 v[24:27], v209, s[28:31], s74 offen sc1
    s_endpgm
L_end:
    s_endpgm
.section .rodata,"a"
.p2align 6
.amdhsa_kernel parallel_sum__sliding_block__mixer_token_mlp__prompt_kernel
  .amdhsa_next_free_vgpr 256
  .amdhsa_next_free_sgpr 102
  .amdhsa_accum_offset 256
  .amdhsa_group_segment_fixed_size 0
  .amdhsa_kernarg_size 88
  .amdhsa_user_sgpr_count 2
  .amdhsa_user_sgpr_kernarg_segment_ptr 1
  .amdhsa_system_sgpr_workgroup_id_x 1
.end_amdhsa_kernel
```
